```python
import torch

def _softmax(x, axis=-1):
    return torch.softmax(x, dim=axis)
def _gelu(x):
    return torch.nn.functional.gelu(x, approximate="tanh")
def _silu(x):
    return torch.nn.functional.silu(x)
def _sigmoid(x):
    return torch.sigmoid(x)
def _layernorm(x, axis=-1, eps=1e-5):
    m = x.mean(dim=axis, keepdim=True)
    v = x.var(dim=axis, keepdim=True, unbiased=False)
    return (x - m) / torch.sqrt(v + eps)
def _scatter_add(tgt, idx, src, axis=0):
    return tgt.clone().index_add_(axis, idx, src)
def _segment_sum(src, seg, n):
    out = torch.zeros((n,) + src.shape[1:], dtype=src.dtype)
    return out.index_add_(0, seg, src)
def _pad(x, pw):
    flat = tuple(v for pair in reversed(pw) for v in pair)
    return torch.nn.functional.pad(x, flat)

kernel_name = 'interleave_layers__ssm_conv_h3__dense_activation_silu__prompt'

def setup_inputs():

    _w = (lambda a: (lambda t: t.to(torch.bfloat16) if t.is_floating_point() else t)(torch.as_tensor(a)))
    def _A_setup():
        B, S, D = 1, 2048, 448
        ks = 4
        return {
            "q": _w((lambda *s: torch.randn(*s, dtype=torch.bfloat16) * 0.05)(B, S, D)),
            "k": _w((lambda *s: torch.randn(*s, dtype=torch.bfloat16) * 0.2)(B, S, D)),
            "v": _w((lambda *s: torch.randn(*s, dtype=torch.bfloat16) * 0.2)(B, S, D)),
            "shift_k": _w((lambda *s: torch.randn(*s, dtype=torch.bfloat16) * 0.2)(D, ks) * 0.5),
            "ssm_k": _w((lambda *s: torch.randn(*s, dtype=torch.bfloat16) * 0.4)(D, S) * (1.0 / S ** 0.5)),
            "ssm_D": _w((lambda *s: torch.randn(*s, dtype=torch.bfloat16) * 0.2)(D)),
        }
    _A_in = _A_setup()

    def _B_setup():
        B, S, D, F = 1, 2048, 448, 1792
        return {
            "x": _w((lambda *s: torch.randn(*s, dtype=torch.bfloat16) * 0.05)(B, S, D)),
            "w1": _w((lambda *s: torch.randn(*s, dtype=torch.bfloat16) * 0.4)(D, F) * (D ** -0.5)),
            "w2": _w((lambda *s: torch.randn(*s, dtype=torch.bfloat16) * 0.1)(F, D) * (F ** -0.5)),
        }
    _B_in = _B_setup()

    return {
        "A_q": _A_in["q"],
        "A_k": _A_in["k"],
        "A_v": _A_in["v"],
        "A_shift_k": _A_in["shift_k"],
        "A_ssm_k": _A_in["ssm_k"],
        "A_ssm_D": _A_in["ssm_D"],
        "B_x": _B_in["x"],
        "B_w1": _B_in["w1"],
        "B_w2": _B_in["w2"],
    }

def reference(A_q, A_k, A_v, A_shift_k, A_ssm_k, A_ssm_D, B_x, B_w1, B_w2):
    def _A_ref(q, k, v, shift_k, ssm_k, ssm_D):
        B, S, D = q.shape
        ks = shift_k.shape[-1]
        k_pad = _pad(k, ((0, 0), (ks - 1, 0), (0, 0)))
        k_shift = torch.zeros_like(k)
        for t in range(ks):
            k_shift = k_shift + k_pad[:, t:t + S, :] * shift_k[:, ks - 1 - t][None, None, :]
        kv = k_shift * v
        L = 2 * S
        kv_pad = _pad(kv, ((0, 0), (0, S), (0, 0)))
        kf_pad = _pad(ssm_k, ((0, 0), (0, S)))
        kv_f = (lambda x, axes=(-2,-1): torch.fft.rfft2(x.float(), dim=axes))(kv_pad[:, None, :, :], axes=(1, 2))
        kf_f = (lambda x, axes=(-2,-1): torch.fft.rfft2(x.float(), dim=axes))(kf_pad[:, None, :], axes=(1, 2))
        kf_f = (lambda x, *d: x.permute(*d))(kf_f, 1, 2, 0)
        y_f = kv_f * kf_f[None, :, :, :]
        y = (lambda x, s, axes=(-2,-1): torch.fft.irfft2(x, s=s, dim=axes).to(torch.bfloat16))(y_f, (1, L), axes=(1, 2))[:, 0, :S, :]
        y = y + kv * ssm_D[None, None, :]
        return q * y

    def _B_ref(x, w1, w2):
        h = torch.einsum("bsd,df->bsf", x, w1)
        h = _silu(h)
        out = torch.einsum("bsf,fd->bsd", h, w2)
        return out

    x = A_q
    x = x + _A_ref(_layernorm(x, axis=-1), A_k, A_v, A_shift_k, A_ssm_k, A_ssm_D)
    x = x + _B_ref(_layernorm(x, axis=-1), B_w1, B_w2)
    x = x + _A_ref(_layernorm(x, axis=-1), A_k, A_v, A_shift_k, A_ssm_k, A_ssm_D)
    x = x + _B_ref(_layernorm(x, axis=-1), B_w1, B_w2)
    return x
```

```asm
; @launch grid=(256,1,1) block=(256,1,1) lds=163840
.amdgcn_target "amdgcn-amd-amdhsa--gfx950"
.text
.globl interleave_layers__ssm_conv_h3__dense_activation_silu__prompt_kernel
.p2align 8
.type interleave_layers__ssm_conv_h3__dense_activation_silu__prompt_kernel,@function
interleave_layers__ssm_conv_h3__dense_activation_silu__prompt_kernel:
L_code0:
    s_cmp_ge_u32 s2, 256
    s_cbranch_scc1 L_end
    s_load_dwordx16 s[64:79], s[0:1], 0
    s_load_dwordx8 s[80:87], s[0:1], 64
    s_getreg_b32 s88, hwreg(HW_REG_XCC_ID, 0, 4)
    v_mov_b32 v175, v0
    v_and_b32 v171, 63, v0
    v_lshrrev_b32 v1, 6, v0
    s_and_b32 s62, s2, 7
    s_lshr_b32 s63, s2, 3
    v_readfirstlane_b32 s24, v1
    s_add_u32 s88, s88, 1
    s_cmp_ge_u32 s63, 14
    s_cselect_b32 s31, 1, 0
    s_lshl_b32 s25, s62, 1
    s_add_u32 s25, s25, s31
    s_mul_i32 s31, s31, 14
    s_sub_u32 s26, s63, s31
    s_cmp_ge_u32 s26, 7
    s_cselect_b32 s27, 1, 0
    s_mul_i32 s31, s27, 7
    s_sub_u32 s28, s26, s31
    s_mul_i32 s90, s62, 28
    s_add_u32 s90, s90, s63
    s_lshl_b32 s91, s90, 13
    s_lshr_b32 s94, s24, 1
    s_and_b32 s95, s24, 1
    v_mov_b32 v9, 0x7ffffff0
    v_lshlrev_b32 v144, 4, v0
    v_add_u32 v145, 16, v144
    v_cmp_eq_u32 vcc, 255, v0
    s_nop 1
    v_cndmask_b32 v144, v144, v9, vcc
    v_cndmask_b32 v145, v145, 0, vcc
    v_and_b32 v149, 7, v171
    s_lshl_b32 s98, s25, 7
    s_lshl_b32 s99, s27, 5
    s_add_u32 s98, s98, s99
    s_lshl_b32 s99, s24, 3
    s_add_u32 s98, s98, s99
    v_add_u32 v149, s98, v149
    v_mul_u32_u24 v149, 896, v149
    v_lshrrev_b32 v146, 3, v171
    v_lshl_add_u32 v149, v146, 4, v149
    s_lshl_b32 s99, s28, 7
    v_add_u32 v149, s99, v149
    v_mul_u32_u24 v1, 9363, v0
    v_lshrrev_b32 v1, 16, v1
    v_mul_u32_u24 v2, 7, v1
    v_sub_u32 v2, v0, v2
    s_mul_i32 s96, s62, 112
    s_lshl_b32 s97, s63, 7
    v_lshlrev_b32 v3, 2, v1
    v_add_u32 v3, s97, v3
    v_lshlrev_b32 v4, 4, v2
    v_add_u32 v4, s96, v4
    v_mul_u32_u24 v5, 896, v3
    v_add_u32 v5, v5, v4
    v_cmp_gt_u32 vcc, 224, v0
    v_add_u32 v6, 0xfffff580, v5
    v_add_u32 v7, 0xfffff900, v5
    v_add_u32 v8, 0xfffffc80, v5
    v_cndmask_b32 v5, v9, v5, vcc
    v_cndmask_b32 v6, v9, v6, vcc
    v_cndmask_b32 v7, v9, v7, vcc
    v_cndmask_b32 v8, v9, v8, vcc
    v_cmp_le_u32 vcc, 4, v3
    s_nop 1
    v_cndmask_b32 v6, v9, v6, vcc
    v_cndmask_b32 v7, v9, v7, vcc
    v_cndmask_b32 v8, v9, v8, vcc
    v_lshlrev_b32 v10, 6, v2
    s_mul_i32 s98, s62, 448
    v_add_u32 v10, s98, v10
    s_waitcnt lgkmcnt(0)
    s_mov_b32 s98, 26218496
    s_load_dword s3, s[86:87], s98
    s_min_u32 s98, s90, 223
    s_lshl_b32 s98, s98, 2
    s_load_dword s92, s[74:75], s98
    s_cmp_ge_u32 s63, 16
    s_cbranch_scc1 L_T
    s_mov_b32 s8, s66
    s_mov_b32 s9, s67
    s_mov_b32 s10, 0x1c0000
    s_mov_b32 s11, 0x20000
    buffer_load_dwordx4 v[24:27], v5, s[8:11], 0 offen offset:0
    buffer_load_dwordx4 v[28:31], v5, s[8:11], 0 offen offset:896
    buffer_load_dwordx4 v[32:35], v5, s[8:11], 0 offen offset:1792
    buffer_load_dwordx4 v[36:39], v5, s[8:11], 0 offen offset:2688
    buffer_load_dwordx4 v[12:15], v6, s[8:11], 0 offen
    buffer_load_dwordx4 v[16:19], v7, s[8:11], 0 offen
    buffer_load_dwordx4 v[20:23], v8, s[8:11], 0 offen
    s_mov_b32 s12, s68
    s_mov_b32 s13, s69
    s_mov_b32 s14, 0x1c0000
    s_mov_b32 s15, 0x20000
    buffer_load_dwordx4 v[40:43], v5, s[12:15], 0 offen offset:0
    buffer_load_dwordx4 v[44:47], v5, s[12:15], 0 offen offset:896
    buffer_load_dwordx4 v[48:51], v5, s[12:15], 0 offen offset:1792
    buffer_load_dwordx4 v[52:55], v5, s[12:15], 0 offen offset:2688
    s_mov_b32 s16, s70
    s_mov_b32 s17, s71
    s_mov_b32 s18, 0xe00
    s_mov_b32 s19, 0x20000
    buffer_load_dwordx4 v[56:59], v10, s[16:19], 0 offen offset:0
    buffer_load_dwordx4 v[60:63], v10, s[16:19], 0 offen offset:16
    buffer_load_dwordx4 v[64:67], v10, s[16:19], 0 offen offset:32
    buffer_load_dwordx4 v[68:71], v10, s[16:19], 0 offen offset:48
    s_mov_b32 s4, s86
    s_mov_b32 s5, s87
    s_mov_b32 s6, 0x2000000
    s_mov_b32 s7, 0x20000
    s_mov_b32 s20, s72
    s_mov_b32 s21, s73
    s_mov_b32 s22, 0x1c0000
    s_mov_b32 s23, 0x20000
    s_add_u32 s98, s91, 4096
    buffer_load_dwordx4 v[176:179], v144, s[20:23], s91 offen offset:0
    buffer_load_dwordx4 v[180:183], v144, s[20:23], s91 offen offset:4
    buffer_load_dwordx4 v[184:187], v144, s[20:23], s91 offen offset:8
    buffer_load_dwordx4 v[188:191], v144, s[20:23], s91 offen offset:12
    buffer_load_dwordx4 v[192:195], v145, s[20:23], s91 offen
    buffer_load_dwordx4 v[196:199], v144, s[20:23], s98 offen offset:0
    buffer_load_dwordx4 v[200:203], v144, s[20:23], s98 offen offset:4
    buffer_load_dwordx4 v[204:207], v144, s[20:23], s98 offen offset:8
    buffer_load_dwordx4 v[208:211], v144, s[20:23], s98 offen offset:12
    buffer_load_dwordx4 v[212:215], v145, s[20:23], s98 offen
    s_mov_b32 s46, 0xffff0000
    s_mov_b32 s54, 0x3f803f80
    s_mov_b32 s61, 0xbf317218
    s_mov_b32 s36, -1
    s_mov_b32 s37, 0x00ffffff
    s_mov_b32 s44, 0x00ff00ff
    s_mov_b32 s45, 0x00ff00ff
    s_movk_i32 s31, 0xff
    s_cmp_eq_u32 s28, 6
    s_cselect_b32 s42, 0xffff, s31
    s_mov_b32 s43, 0
    s_mul_i32 s31, s24, 14
    s_mov_b32 s38, 0x3fff
    s_mov_b32 s39, 0
    s_lshl_b64 s[38:39], s[38:39], s31
    s_lshl_b32 s34, s26, 2
    s_add_u32 s34, s34, s24
    s_lshl_b32 s34, s34, 2
    s_lshl_b32 s31, s25, 8
    s_add_u32 s31, s31, 26214400
    s_add_u32 s34, s34, s31
    s_mul_i32 s53, s24, 7168
    s_mul_i32 s31, s25, 114688
    s_add_u32 s31, s31, 6291456
    s_add_u32 s47, s31, s53
    s_mul_i32 s32, s27, 28672
    s_add_u32 s48, s31, s32
    s_mul_i32 s31, s25, 458752
    s_add_u32 s31, s31, 8388608
    s_mul_i32 s32, s27, 114688
    s_add_u32 s49, s31, s32
    s_mul_i32 s32, s24, 28672
    s_add_u32 s49, s49, s32
    s_lshl_b32 s32, s26, 13
    s_add_u32 s50, s31, s32
    s_lshl_b32 s32, s24, 11
    s_add_u32 s50, s50, s32
    s_lshl_b32 s51, s25, 13
    s_add_u32 s51, s51, 25165824
    s_lshl_b32 s32, s27, 11
    s_add_u32 s52, s51, s32
    s_lshl_b32 s31, s25, 2
    s_add_u32 s31, s31, s27
    s_lshl_b32 s31, s31, 12
    s_add_u32 s35, s31, 25690112
    s_mov_b32 s8, s80
    s_mov_b32 s9, s81
    s_mov_b32 s10, 0x188000
    s_mov_b32 s11, 0x20000
    s_lshl_b32 s76, s63, 2
    s_add_u32 s76, s76, s24
    s_mul_i32 s76, s76, 14336
    s_add_u32 s76, s76, 0
    s_add_u32 s77, s76, 8192
    v_lshlrev_b32 v150, 7, v171
    v_mov_b32 v151, 0x7ffffff0
    v_cmp_gt_u32 vcc, 48, v171
    s_nop 1
    v_cndmask_b32 v151, v151, v150, vcc
    s_mov_b32 s12, s64
    s_mov_b32 s13, s65
    s_mov_b32 s14, 0x1c0000
    s_mov_b32 s15, 0x20000
    s_mov_b32 s16, s78
    s_mov_b32 s17, s79
    s_mov_b32 s18, 0x188000
    s_mov_b32 s19, 0x20000
    s_mov_b32 s20, s80
    s_mov_b32 s21, s81
    s_mov_b32 s22, 0x188000
    s_mov_b32 s23, 0x20000
    v_mov_b32 v160, v171
    v_lshrrev_b32 v161, 2, v160
    v_mul_u32_u24 v161, 3584, v161
    v_and_b32 v162, 3, v160
    v_lshl_add_u32 v161, v162, 4, v161
    s_lshl_b32 s29, s26, 8
    s_lshl_b32 s30, s24, 6
    s_add_u32 s29, s29, s30
    v_add_u32 v161, s29, v161
    v_lshrrev_b32 v162, 3, v160
    v_mul_u32_u24 v162, 896, v162
    v_bfe_u32 v163, v160, 4, 1
    v_lshlrev_b32 v163, 2, v163
    v_and_b32 v164, 7, v160
    v_xor_b32 v163, v163, v164
    v_lshl_add_u32 v162, v163, 4, v162
    s_lshl_b32 s29, s28, 7
    s_mul_i32 s30, s24, 401408
    s_add_u32 s29, s29, s30
    v_add_u32 v162, s29, v162
    v_bfe_u32 v163, v160, 2, 2
    v_and_b32 v164, 3, v160
    v_bfe_u32 v165, v160, 4, 1
    v_lshrrev_b32 v166, 5, v160
    v_lshl_add_u32 v167, v166, 3, v163
    v_lshlrev_b32 v167, 6, v167
    v_lshl_add_u32 v167, v165, 5, v167
    v_lshl_add_u32 v167, v164, 3, v167
    v_lshl_add_u32 v168, v166, 2, v163
    v_lshlrev_b32 v168, 7, v168
    v_lshrrev_b32 v169, 1, v164
    v_lshl_add_u32 v169, v165, 1, v169
    v_lshrrev_b32 v170, 1, v163
    v_lshlrev_b32 v170, 2, v170
    v_xor_b32 v169, v169, v170
    v_lshl_add_u32 v168, v169, 4, v168
    v_and_b32 v169, 1, v164
    v_lshl_add_u32 v168, v169, 3, v168
    s_mul_i32 s56, s24, 20480
    s_add_u32 s56, s56, 81920
    v_add_u32 v167, s56, v167
    v_add_u32 v168, s56, v168
    v_xor_b32 v169, 64, v168
    v_lshrrev_b32 v11, 1, v1
    v_add_u32 v11, v11, v2
    v_and_b32 v11, 15, v11
    v_lshlrev_b32 v11, 4, v11
    v_and_b32 v136, 1, v1
    v_xor_b32 v136, 1, v136
    v_lshl_add_u32 v11, v136, 3, v11
    v_lshl_add_u32 v11, v2, 11, v11
    v_add_u32 v11, 79360, v11
    s_mov_b32 s29, 0x05040100
    s_mov_b32 s30, 0x07060302
    s_mov_b32 s46, 0xffff0000
    v_add_u32 v146, 0, v0
    v_lshrrev_b32 v147, 4, v146
    v_and_b32 v146, 15, v146
    v_lshrrev_b32 v148, 3, v147
    v_add_u32 v148, v148, v146
    v_and_b32 v148, 15, v148
    v_lshlrev_b32 v148, 4, v148
    v_lshl_add_u32 v152, v147, 8, v148
    v_add_u32 v152, 79360, v152
    v_lshlrev_b32 v148, 12, v147
    v_lshl_add_u32 v156, v146, 4, v148
    v_add_u32 v146, 256, v0
    v_lshrrev_b32 v147, 4, v146
    v_and_b32 v146, 15, v146
    v_lshrrev_b32 v148, 3, v147
    v_add_u32 v148, v148, v146
    v_and_b32 v148, 15, v148
    v_lshlrev_b32 v148, 4, v148
    v_lshl_add_u32 v153, v147, 8, v148
    v_add_u32 v153, 79360, v153
    v_lshlrev_b32 v148, 12, v147
    v_lshl_add_u32 v157, v146, 4, v148
    v_add_u32 v146, 512, v0
    v_lshrrev_b32 v147, 4, v146
    v_and_b32 v146, 15, v146
    v_lshrrev_b32 v148, 3, v147
    v_add_u32 v148, v148, v146
    v_and_b32 v148, 15, v148
    v_lshlrev_b32 v148, 4, v148
    v_lshl_add_u32 v154, v147, 8, v148
    v_add_u32 v154, 79360, v154
    v_lshlrev_b32 v148, 12, v147
    v_lshl_add_u32 v158, v146, 4, v148
    v_add_u32 v146, 768, v0
    v_lshrrev_b32 v147, 4, v146
    v_and_b32 v146, 15, v146
    v_lshrrev_b32 v148, 3, v147
    v_add_u32 v148, v148, v146
    v_and_b32 v148, 15, v148
    v_lshlrev_b32 v148, 4, v148
    v_lshl_add_u32 v155, v147, 8, v148
    v_add_u32 v155, 79360, v155
    v_lshlrev_b32 v148, 12, v147
    v_lshl_add_u32 v159, v146, 4, v148
    v_cmp_gt_u32 vcc, 128, v0
    s_nop 1
    v_cndmask_b32 v159, v9, v159, vcc
    s_mul_i32 s98, s62, 229376
    s_lshl_b32 s99, s63, 8
    s_add_u32 s98, s98, s99
    s_add_u32 s33, s98, 0
    s_waitcnt lgkmcnt(0)
    s_add_u32 s3, s3, 16
    s_cmp_lg_u32 s24, 0
    s_cbranch_scc1 L_awk
    s_lshl_b32 s98, s62, 7
    s_lshl_b32 s99, s63, 2
    s_add_u32 s98, s98, s99
    s_add_u32 s96, s98, 26220544
    s_add_u32 s99, s3, s88
    v_mov_b32 v147, s99
    buffer_store_dword v147, off, s[4:7], s96 sc0 sc1
L_awk:
    s_waitcnt vmcnt(10)
    v_perm_b32 v72, v12, v16, s29
    v_perm_b32 v73, v12, v16, s30
    v_perm_b32 v74, v13, v17, s29
    v_perm_b32 v75, v13, v17, s30
    v_perm_b32 v76, v14, v18, s29
    v_perm_b32 v77, v14, v18, s30
    v_perm_b32 v78, v15, v19, s29
    v_perm_b32 v79, v15, v19, s30
    v_perm_b32 v80, v16, v20, s29
    v_perm_b32 v81, v16, v20, s30
    v_perm_b32 v82, v17, v21, s29
    v_perm_b32 v83, v17, v21, s30
    v_perm_b32 v84, v18, v22, s29
    v_perm_b32 v85, v18, v22, s30
    v_perm_b32 v86, v19, v23, s29
    v_perm_b32 v87, v19, v23, s30
    v_perm_b32 v88, v20, v24, s29
    v_perm_b32 v89, v20, v24, s30
    v_perm_b32 v90, v21, v25, s29
    v_perm_b32 v91, v21, v25, s30
    v_perm_b32 v92, v22, v26, s29
    v_perm_b32 v93, v22, v26, s30
    v_perm_b32 v94, v23, v27, s29
    v_perm_b32 v95, v23, v27, s30
    v_perm_b32 v96, v24, v28, s29
    v_perm_b32 v97, v24, v28, s30
    v_perm_b32 v98, v25, v29, s29
    v_perm_b32 v99, v25, v29, s30
    v_perm_b32 v100, v26, v30, s29
    v_perm_b32 v101, v26, v30, s30
    v_perm_b32 v102, v27, v31, s29
    v_perm_b32 v103, v27, v31, s30
    v_dot2_f32_bf16 v104, v88, v56, 0
    v_dot2_f32_bf16 v112, v96, v56, 0
    v_dot2_f32_bf16 v105, v89, v58, 0
    v_dot2_f32_bf16 v113, v97, v58, 0
    v_dot2_f32_bf16 v106, v90, v60, 0
    v_dot2_f32_bf16 v114, v98, v60, 0
    v_dot2_f32_bf16 v107, v91, v62, 0
    v_dot2_f32_bf16 v115, v99, v62, 0
    v_dot2_f32_bf16 v108, v92, v64, 0
    v_dot2_f32_bf16 v116, v100, v64, 0
    v_dot2_f32_bf16 v109, v93, v66, 0
    v_dot2_f32_bf16 v117, v101, v66, 0
    v_dot2_f32_bf16 v110, v94, v68, 0
    v_dot2_f32_bf16 v118, v102, v68, 0
    v_dot2_f32_bf16 v111, v95, v70, 0
    v_dot2_f32_bf16 v119, v103, v70, 0
    v_dot2_f32_bf16 v104, v72, v57, v104
    v_dot2_f32_bf16 v112, v80, v57, v112
    v_dot2_f32_bf16 v105, v73, v59, v105
    v_dot2_f32_bf16 v113, v81, v59, v113
    v_dot2_f32_bf16 v106, v74, v61, v106
    v_dot2_f32_bf16 v114, v82, v61, v114
    v_dot2_f32_bf16 v107, v75, v63, v107
    v_dot2_f32_bf16 v115, v83, v63, v115
    v_dot2_f32_bf16 v108, v76, v65, v108
    v_dot2_f32_bf16 v116, v84, v65, v116
    v_dot2_f32_bf16 v109, v77, v67, v109
    v_dot2_f32_bf16 v117, v85, v67, v117
    v_dot2_f32_bf16 v110, v78, v69, v110
    v_dot2_f32_bf16 v118, v86, v69, v118
    v_dot2_f32_bf16 v111, v79, v71, v111
    v_dot2_f32_bf16 v119, v87, v71, v119
    v_dot2_f32_bf16 v120, v88, v57, 0
    v_dot2_f32_bf16 v128, v96, v57, 0
    v_dot2_f32_bf16 v121, v89, v59, 0
    v_dot2_f32_bf16 v129, v97, v59, 0
    v_dot2_f32_bf16 v122, v90, v61, 0
    v_dot2_f32_bf16 v130, v98, v61, 0
    v_dot2_f32_bf16 v123, v91, v63, 0
    v_dot2_f32_bf16 v131, v99, v63, 0
    v_dot2_f32_bf16 v124, v92, v65, 0
    v_dot2_f32_bf16 v132, v100, v65, 0
    v_dot2_f32_bf16 v125, v93, v67, 0
    v_dot2_f32_bf16 v133, v101, v67, 0
    v_dot2_f32_bf16 v126, v94, v69, 0
    v_dot2_f32_bf16 v134, v102, v69, 0
    v_dot2_f32_bf16 v127, v95, v71, 0
    v_dot2_f32_bf16 v135, v103, v71, 0
    v_perm_b32 v72, v28, v32, s29
    v_perm_b32 v73, v28, v32, s30
    v_perm_b32 v74, v29, v33, s29
    v_perm_b32 v75, v29, v33, s30
    v_perm_b32 v76, v30, v34, s29
    v_perm_b32 v77, v30, v34, s30
    v_perm_b32 v78, v31, v35, s29
    v_perm_b32 v79, v31, v35, s30
    v_perm_b32 v80, v32, v36, s29
    v_perm_b32 v81, v32, v36, s30
    v_perm_b32 v82, v33, v37, s29
    v_perm_b32 v83, v33, v37, s30
    v_perm_b32 v84, v34, v38, s29
    v_perm_b32 v85, v34, v38, s30
    v_perm_b32 v86, v35, v39, s29
    v_perm_b32 v87, v35, v39, s30
    v_dot2_f32_bf16 v120, v72, v56, v120
    v_dot2_f32_bf16 v128, v80, v56, v128
    v_dot2_f32_bf16 v121, v73, v58, v121
    v_dot2_f32_bf16 v129, v81, v58, v129
    v_dot2_f32_bf16 v122, v74, v60, v122
    v_dot2_f32_bf16 v130, v82, v60, v130
    v_dot2_f32_bf16 v123, v75, v62, v123
    v_dot2_f32_bf16 v131, v83, v62, v131
    v_dot2_f32_bf16 v124, v76, v64, v124
    v_dot2_f32_bf16 v132, v84, v64, v132
    v_dot2_f32_bf16 v125, v77, v66, v125
    v_dot2_f32_bf16 v133, v85, v66, v133
    v_dot2_f32_bf16 v126, v78, v68, v126
    v_dot2_f32_bf16 v134, v86, v68, v134
    v_dot2_f32_bf16 v127, v79, v70, v127
    v_dot2_f32_bf16 v135, v87, v70, v135
    v_lshlrev_b32 v136, 16, v40
    v_and_b32 v137, s46, v40
    v_lshlrev_b32 v138, 16, v41
    v_and_b32 v139, s46, v41
    v_lshlrev_b32 v140, 16, v42
    v_and_b32 v141, s46, v42
    v_lshlrev_b32 v142, 16, v43
    v_and_b32 v143, s46, v43
    v_mul_f32 v104, v104, v136
    v_mul_f32 v105, v105, v137
    v_mul_f32 v106, v106, v138
    v_mul_f32 v107, v107, v139
    v_mul_f32 v108, v108, v140
    v_mul_f32 v109, v109, v141
    v_mul_f32 v110, v110, v142
    v_mul_f32 v111, v111, v143
    v_lshlrev_b32 v136, 16, v44
    v_and_b32 v137, s46, v44
    v_lshlrev_b32 v138, 16, v45
    v_and_b32 v139, s46, v45
    v_lshlrev_b32 v140, 16, v46
    v_and_b32 v141, s46, v46
    v_lshlrev_b32 v142, 16, v47
    v_and_b32 v143, s46, v47
    v_mul_f32 v112, v112, v136
    v_mul_f32 v113, v113, v137
    v_mul_f32 v114, v114, v138
    v_mul_f32 v115, v115, v139
    v_mul_f32 v116, v116, v140
    v_mul_f32 v117, v117, v141
    v_mul_f32 v118, v118, v142
    v_mul_f32 v119, v119, v143
    v_lshlrev_b32 v136, 16, v48
    v_and_b32 v137, s46, v48
    v_lshlrev_b32 v138, 16, v49
    v_and_b32 v139, s46, v49
    v_lshlrev_b32 v140, 16, v50
    v_and_b32 v141, s46, v50
    v_lshlrev_b32 v142, 16, v51
    v_and_b32 v143, s46, v51
    v_mul_f32 v120, v120, v136
    v_mul_f32 v121, v121, v137
    v_mul_f32 v122, v122, v138
    v_mul_f32 v123, v123, v139
    v_mul_f32 v124, v124, v140
    v_mul_f32 v125, v125, v141
    v_mul_f32 v126, v126, v142
    v_mul_f32 v127, v127, v143
    v_lshlrev_b32 v136, 16, v52
    v_and_b32 v137, s46, v52
    v_lshlrev_b32 v138, 16, v53
    v_and_b32 v139, s46, v53
    v_lshlrev_b32 v140, 16, v54
    v_and_b32 v141, s46, v54
    v_lshlrev_b32 v142, 16, v55
    v_and_b32 v143, s46, v55
    v_mul_f32 v128, v128, v136
    v_mul_f32 v129, v129, v137
    v_mul_f32 v130, v130, v138
    v_mul_f32 v131, v131, v139
    v_mul_f32 v132, v132, v140
    v_mul_f32 v133, v133, v141
    v_mul_f32 v134, v134, v142
    v_mul_f32 v135, v135, v143
    v_cvt_pk_bf16_f32 v72, v128, v120
    v_cvt_pk_bf16_f32 v73, v112, v104
    v_cvt_pk_bf16_f32 v74, v129, v121
    v_cvt_pk_bf16_f32 v75, v113, v105
    v_cvt_pk_bf16_f32 v76, v130, v122
    v_cvt_pk_bf16_f32 v77, v114, v106
    v_cvt_pk_bf16_f32 v78, v131, v123
    v_cvt_pk_bf16_f32 v79, v115, v107
    v_cvt_pk_bf16_f32 v80, v132, v124
    v_cvt_pk_bf16_f32 v81, v116, v108
    v_cvt_pk_bf16_f32 v82, v133, v125
    v_cvt_pk_bf16_f32 v83, v117, v109
    v_cvt_pk_bf16_f32 v84, v134, v126
    v_cvt_pk_bf16_f32 v85, v118, v110
    v_cvt_pk_bf16_f32 v86, v135, v127
    v_cvt_pk_bf16_f32 v87, v119, v111
    v_cmp_gt_u32 vcc, 224, v0
    s_nop 0
    s_and_saveexec_b64 s[100:101], vcc
    ds_write_b64 v11, v[72:73] offset:0
    ds_write_b64 v11, v[74:75] offset:256
    ds_write_b64 v11, v[76:77] offset:512
    ds_write_b64 v11, v[78:79] offset:768
    ds_write_b64 v11, v[80:81] offset:1024
    ds_write_b64 v11, v[82:83] offset:1280
    ds_write_b64 v11, v[84:85] offset:1536
    ds_write_b64 v11, v[86:87] offset:1792
    s_mov_b64 exec, s[100:101]
    s_cmp_lg_u32 s24, 0
    s_cbranch_scc1 L_km_skip
    s_lshl_b32 s98, s62, 7
    s_add_u32 s98, s98, 26220544
    v_and_b32 v12, 31, v171
    v_lshlrev_b32 v12, 2, v12
    s_mov_b32 s55, 0
L_km_poll:
    buffer_load_dword v13, v12, s[4:7], s98 offen sc1
L_km_chk:
    s_add_u32 s99, s3, 1
    s_waitcnt vmcnt(0)
    v_subrev_u32 v14, s99, v13
    v_cmp_le_u32 vcc, 8, v14
    s_add_u32 s55, s55, 1
    s_and_b64 s[40:41], vcc, exec
    s_cbranch_scc0 L_km_ok
    s_cmp_lt_u32 s55, 0x40000
    s_cbranch_scc1 L_km_poll
L_km_ok:
    s_add_u32 s99, s3, s88
    v_cmp_ne_u32 vcc, s99, v13
    s_nop 0
    s_and_b64 s[40:41], vcc, exec
    s_cselect_b32 s89, 0, 1
    v_mov_b32 v13, s89
    v_mov_b32 v14, 93696
    ds_write_b32 v14, v13
L_km_skip:
    v_mov_b32 v14, 93696
    s_waitcnt lgkmcnt(0)
    s_barrier
    ds_read_b32 v13, v14
    s_waitcnt lgkmcnt(0)
    v_readfirstlane_b32 s89, v13
    ds_read_b128 v[12:15], v152
    ds_read_b128 v[16:19], v153
    ds_read_b128 v[20:23], v154
    ds_read_b128 v[24:27], v155
    s_cmp_eq_u32 s89, 1
    s_cbranch_scc1 L_ut_fast
    s_waitcnt lgkmcnt(3)
    buffer_store_dwordx4 v[12:15], v156, s[4:7], s33 offen sc0 sc1
    s_waitcnt lgkmcnt(2)
    buffer_store_dwordx4 v[16:19], v157, s[4:7], s33 offen sc0 sc1
    s_waitcnt lgkmcnt(1)
    buffer_store_dwordx4 v[20:23], v158, s[4:7], s33 offen sc0 sc1
    s_waitcnt lgkmcnt(0)
    buffer_store_dwordx4 v[24:27], v159, s[4:7], s33 offen sc0 sc1
    s_branch L_ut_done
L_ut_fast:
    s_waitcnt lgkmcnt(3)
    buffer_store_dwordx4 v[12:15], v156, s[4:7], s33 offen
    s_waitcnt lgkmcnt(2)
    buffer_store_dwordx4 v[16:19], v157, s[4:7], s33 offen
    s_waitcnt lgkmcnt(1)
    buffer_store_dwordx4 v[20:23], v158, s[4:7], s33 offen
    s_waitcnt lgkmcnt(0)
    buffer_store_dwordx4 v[24:27], v159, s[4:7], s33 offen
L_ut_done:
    v_mov_b32 v8, 0
    v_mov_b32 v9, 0
    v_mov_b32 v10, 0
    v_mov_b32 v11, 0
    v_lshrrev_b32 v7, 5, v0
    v_mul_u32_u24 v7, 1568, v7
    v_and_b32 v28, 31, v0
    v_lshl_add_u32 v7, v28, 4, v7
    v_add_u32 v7, 66816, v7
    ds_write_b128 v7, v[8:11]
    v_mul_u32_u24 v7, 21846, v0
    v_lshrrev_b32 v7, 16, v7
    v_mul_u32_u24 v28, 3, v7
    v_sub_u32 v28, v0, v28
    v_mul_u32_u24 v7, 4160, v7
    v_lshl_add_u32 v7, v28, 4, v7
    v_cmp_gt_u32 vcc, 48, v0
    s_nop 0
    s_and_saveexec_b64 s[100:101], vcc
    s_cbranch_execz L_cvzk
    ds_write_b128 v7, v[8:11] offset:256
L_cvzk:
    s_mov_b64 exec, s[100:101]
    v_add_u32 v29, 4, v0
    v_cmp_eq_u32 vcc, 255, v0
    s_nop 1
    v_cndmask_b32 v29, v29, 3, vcc
    v_lshlrev_b32 v29, 4, v29
    s_waitcnt vmcnt(0)
    s_barrier
    s_cmp_lg_u32 s24, 0
    s_cbranch_scc1 L_k0nf
    s_lshl_b32 s98, s62, 7
    s_lshl_b32 s99, s63, 2
    s_add_u32 s98, s98, s99
    s_add_u32 s96, s98, 26222592
    s_add_u32 s99, s3, 1
    v_mov_b32 v12, s99
    s_cmp_eq_u32 s89, 1
    s_cbranch_scc1 L_kf_fast
    buffer_store_dword v12, off, s[4:7], s96 sc0 sc1
    s_branch L_k0nf
L_kf_fast:
    buffer_store_dword v12, off, s[4:7], s96
L_k0nf:
    v_cmp_eq_u32 vcc, 255, v0
    s_nop 1
    v_cndmask_b32 v183, v183, v192, vcc
    v_cndmask_b32 v186, v186, v192, vcc
    v_cndmask_b32 v187, v187, v193, vcc
    v_cndmask_b32 v189, v189, v192, vcc
    v_cndmask_b32 v190, v190, v193, vcc
    v_cndmask_b32 v191, v191, v194, vcc
    ds_write_b128 v29, v[180:183] offset:4416
    ds_write_b128 v29, v[184:187] offset:12736
    ds_write_b128 v29, v[188:191] offset:21056
    ds_write_b128 v29, v[192:195] offset:29376
    v_alignbit_b32 v64, v177, v176, 16
    v_alignbit_b32 v65, v178, v177, 16
    v_alignbit_b32 v66, v179, v178, 16
    v_alignbit_b32 v67, v192, v179, 16
    ds_write_b128 v29, v[64:67] offset:256
    v_alignbit_b32 v68, v178, v177, 16
    v_alignbit_b32 v69, v179, v178, 16
    v_alignbit_b32 v70, v192, v179, 16
    v_alignbit_b32 v71, v193, v192, 16
    ds_write_b128 v29, v[68:71] offset:8576
    v_alignbit_b32 v72, v179, v178, 16
    v_alignbit_b32 v73, v192, v179, 16
    v_alignbit_b32 v74, v193, v192, 16
    v_alignbit_b32 v75, v194, v193, 16
    ds_write_b128 v29, v[72:75] offset:16896
    v_alignbit_b32 v76, v192, v179, 16
    v_alignbit_b32 v77, v193, v192, 16
    v_alignbit_b32 v78, v194, v193, 16
    v_alignbit_b32 v79, v195, v194, 16
    ds_write_b128 v29, v[76:79] offset:25216
    v_cmp_eq_u32 vcc, 255, v0
    s_nop 1
    v_cndmask_b32 v203, v203, v212, vcc
    v_cndmask_b32 v206, v206, v212, vcc
    v_cndmask_b32 v207, v207, v213, vcc
    v_cndmask_b32 v209, v209, v212, vcc
    v_cndmask_b32 v210, v210, v213, vcc
    v_cndmask_b32 v211, v211, v214, vcc
    ds_write_b128 v29, v[200:203] offset:37696
    ds_write_b128 v29, v[204:207] offset:46016
    ds_write_b128 v29, v[208:211] offset:54336
    ds_write_b128 v29, v[212:215] offset:62656
    v_alignbit_b32 v80, v197, v196, 16
    v_alignbit_b32 v81, v198, v197, 16
    v_alignbit_b32 v82, v199, v198, 16
    v_alignbit_b32 v83, v212, v199, 16
    ds_write_b128 v29, v[80:83] offset:33536
    v_alignbit_b32 v84, v198, v197, 16
    v_alignbit_b32 v85, v199, v198, 16
    v_alignbit_b32 v86, v212, v199, 16
    v_alignbit_b32 v87, v213, v212, 16
    ds_write_b128 v29, v[84:87] offset:41856
    v_alignbit_b32 v88, v199, v198, 16
    v_alignbit_b32 v89, v212, v199, 16
    v_alignbit_b32 v90, v213, v212, 16
    v_alignbit_b32 v91, v214, v213, 16
    ds_write_b128 v29, v[88:91] offset:50176
    v_alignbit_b32 v92, v212, v199, 16
    v_alignbit_b32 v93, v213, v212, 16
    v_alignbit_b32 v94, v214, v213, 16
    v_alignbit_b32 v95, v215, v214, 16
    ds_write_b128 v29, v[92:95] offset:58496
    s_branch L_join
L_T:
    s_mov_b32 s4, s86
    s_mov_b32 s5, s87
    s_mov_b32 s6, 0x2000000
    s_mov_b32 s7, 0x20000
    s_mov_b32 s20, s72
    s_mov_b32 s21, s73
    s_mov_b32 s22, 0x1c0000
    s_mov_b32 s23, 0x20000
    s_cmp_ge_u32 s63, 28
    s_cbranch_scc1 L_spare
    s_add_u32 s98, s91, 4096
    buffer_load_dwordx4 v[176:179], v144, s[20:23], s91 offen offset:0
    buffer_load_dwordx4 v[180:183], v144, s[20:23], s91 offen offset:4
    buffer_load_dwordx4 v[184:187], v144, s[20:23], s91 offen offset:8
    buffer_load_dwordx4 v[188:191], v144, s[20:23], s91 offen offset:12
    buffer_load_dwordx4 v[192:195], v145, s[20:23], s91 offen
    buffer_load_dwordx4 v[196:199], v144, s[20:23], s98 offen offset:0
    buffer_load_dwordx4 v[200:203], v144, s[20:23], s98 offen offset:4
    buffer_load_dwordx4 v[204:207], v144, s[20:23], s98 offen offset:8
    buffer_load_dwordx4 v[208:211], v144, s[20:23], s98 offen offset:12
    buffer_load_dwordx4 v[212:215], v145, s[20:23], s98 offen
    s_waitcnt lgkmcnt(0)
    s_add_u32 s3, s3, 16
    s_cmp_lg_u32 s24, 0
    s_cbranch_scc1 L_awt
    s_lshl_b32 s98, s62, 7
    s_lshl_b32 s99, s63, 2
    s_add_u32 s98, s98, s99
    s_add_u32 s96, s98, 26220544
    s_add_u32 s99, s3, s88
    v_mov_b32 v147, s99
    buffer_store_dword v147, off, s[4:7], s96 sc0 sc1
L_awt:
    s_mov_b32 s52, s78
    s_mov_b32 s53, s79
    s_mov_b32 s54, 0x188000
    s_mov_b32 s55, 0x20000
    s_sub_u32 s98, s63, 16
    s_mul_i32 s98, s98, 133888
    s_mul_i32 s99, s24, 33536
    s_add_u32 s98, s98, s99
    v_lshlrev_b32 v132, 7, v171
    v_cmp_gt_u32 vcc, 6, v171
    s_nop 1
    v_cndmask_b32 v133, v9, v132, vcc
    buffer_load_dword v174, v132, s[52:55], s98 offen
    s_add_u32 s98, s98, 8192
    buffer_load_dword v174, v132, s[52:55], s98 offen
    s_add_u32 s98, s98, 8192
    buffer_load_dword v174, v132, s[52:55], s98 offen
    s_add_u32 s98, s98, 8192
    buffer_load_dword v174, v132, s[52:55], s98 offen
    s_add_u32 s98, s98, 8192
    buffer_load_dword v174, v133, s[52:55], s98 offen
    s_mov_b32 s46, 0xffff0000
    s_waitcnt vmcnt(5)
    v_mov_b32 v8, 0
    v_mov_b32 v9, 0
    v_mov_b32 v10, 0
    v_mov_b32 v11, 0
    v_lshrrev_b32 v7, 5, v0
    v_mul_u32_u24 v7, 1568, v7
    v_and_b32 v28, 31, v0
    v_lshl_add_u32 v7, v28, 4, v7
    v_add_u32 v7, 66816, v7
    ds_write_b128 v7, v[8:11]
    v_mul_u32_u24 v7, 21846, v0
    v_lshrrev_b32 v7, 16, v7
    v_mul_u32_u24 v28, 3, v7
    v_sub_u32 v28, v0, v28
    v_mul_u32_u24 v7, 4160, v7
    v_lshl_add_u32 v7, v28, 4, v7
    v_cmp_gt_u32 vcc, 48, v0
    s_nop 0
    s_and_saveexec_b64 s[100:101], vcc
    s_cbranch_execz L_cvzt
    ds_write_b128 v7, v[8:11] offset:256
L_cvzt:
    s_mov_b64 exec, s[100:101]
    v_add_u32 v29, 4, v0
    v_cmp_eq_u32 vcc, 255, v0
    s_nop 1
    v_cndmask_b32 v29, v29, 3, vcc
    v_lshlrev_b32 v29, 4, v29
    v_cmp_eq_u32 vcc, 255, v0
    s_nop 1
    v_cndmask_b32 v183, v183, v192, vcc
    v_cndmask_b32 v186, v186, v192, vcc
    v_cndmask_b32 v187, v187, v193, vcc
    v_cndmask_b32 v189, v189, v192, vcc
    v_cndmask_b32 v190, v190, v193, vcc
    v_cndmask_b32 v191, v191, v194, vcc
    ds_write_b128 v29, v[180:183] offset:4416
    ds_write_b128 v29, v[184:187] offset:12736
    ds_write_b128 v29, v[188:191] offset:21056
    ds_write_b128 v29, v[192:195] offset:29376
    v_alignbit_b32 v64, v177, v176, 16
    v_alignbit_b32 v65, v178, v177, 16
    v_alignbit_b32 v66, v179, v178, 16
    v_alignbit_b32 v67, v192, v179, 16
    ds_write_b128 v29, v[64:67] offset:256
    v_alignbit_b32 v68, v178, v177, 16
    v_alignbit_b32 v69, v179, v178, 16
    v_alignbit_b32 v70, v192, v179, 16
    v_alignbit_b32 v71, v193, v192, 16
    ds_write_b128 v29, v[68:71] offset:8576
    v_alignbit_b32 v72, v179, v178, 16
    v_alignbit_b32 v73, v192, v179, 16
    v_alignbit_b32 v74, v193, v192, 16
    v_alignbit_b32 v75, v194, v193, 16
    ds_write_b128 v29, v[72:75] offset:16896
    v_alignbit_b32 v76, v192, v179, 16
    v_alignbit_b32 v77, v193, v192, 16
    v_alignbit_b32 v78, v194, v193, 16
    v_alignbit_b32 v79, v195, v194, 16
    ds_write_b128 v29, v[76:79] offset:25216
    v_cmp_eq_u32 vcc, 255, v0
    s_nop 1
    v_cndmask_b32 v203, v203, v212, vcc
    v_cndmask_b32 v206, v206, v212, vcc
    v_cndmask_b32 v207, v207, v213, vcc
    v_cndmask_b32 v209, v209, v212, vcc
    v_cndmask_b32 v210, v210, v213, vcc
    v_cndmask_b32 v211, v211, v214, vcc
    ds_write_b128 v29, v[200:203] offset:37696
    ds_write_b128 v29, v[204:207] offset:46016
    ds_write_b128 v29, v[208:211] offset:54336
    ds_write_b128 v29, v[212:215] offset:62656
    v_alignbit_b32 v80, v197, v196, 16
    v_alignbit_b32 v81, v198, v197, 16
    v_alignbit_b32 v82, v199, v198, 16
    v_alignbit_b32 v83, v212, v199, 16
    ds_write_b128 v29, v[80:83] offset:33536
    v_alignbit_b32 v84, v198, v197, 16
    v_alignbit_b32 v85, v199, v198, 16
    v_alignbit_b32 v86, v212, v199, 16
    v_alignbit_b32 v87, v213, v212, 16
    ds_write_b128 v29, v[84:87] offset:41856
    v_alignbit_b32 v88, v199, v198, 16
    v_alignbit_b32 v89, v212, v199, 16
    v_alignbit_b32 v90, v213, v212, 16
    v_alignbit_b32 v91, v214, v213, 16
    ds_write_b128 v29, v[88:91] offset:50176
    v_alignbit_b32 v92, v212, v199, 16
    v_alignbit_b32 v93, v213, v212, 16
    v_alignbit_b32 v94, v214, v213, 16
    v_alignbit_b32 v95, v215, v214, 16
    ds_write_b128 v29, v[92:95] offset:58496
    s_mov_b32 s46, 0xffff0000
    s_mov_b32 s54, 0x3f803f80
    s_mov_b32 s61, 0xbf317218
    s_mov_b32 s36, -1
    s_mov_b32 s37, 0x00ffffff
    s_mov_b32 s44, 0x00ff00ff
    s_mov_b32 s45, 0x00ff00ff
    s_movk_i32 s31, 0xff
    s_cmp_eq_u32 s28, 6
    s_cselect_b32 s42, 0xffff, s31
    s_mov_b32 s43, 0
    s_mul_i32 s31, s24, 14
    s_mov_b32 s38, 0x3fff
    s_mov_b32 s39, 0
    s_lshl_b64 s[38:39], s[38:39], s31
    s_lshl_b32 s34, s26, 2
    s_add_u32 s34, s34, s24
    s_lshl_b32 s34, s34, 2
    s_lshl_b32 s31, s25, 8
    s_add_u32 s31, s31, 26214400
    s_add_u32 s34, s34, s31
    s_mul_i32 s53, s24, 7168
    s_mul_i32 s31, s25, 114688
    s_add_u32 s31, s31, 6291456
    s_add_u32 s47, s31, s53
    s_mul_i32 s32, s27, 28672
    s_add_u32 s48, s31, s32
    s_mul_i32 s31, s25, 458752
    s_add_u32 s31, s31, 8388608
    s_mul_i32 s32, s27, 114688
    s_add_u32 s49, s31, s32
    s_mul_i32 s32, s24, 28672
    s_add_u32 s49, s49, s32
    s_lshl_b32 s32, s26, 13
    s_add_u32 s50, s31, s32
    s_lshl_b32 s32, s24, 11
    s_add_u32 s50, s50, s32
    s_lshl_b32 s51, s25, 13
    s_add_u32 s51, s51, 25165824
    s_lshl_b32 s32, s27, 11
    s_add_u32 s52, s51, s32
    s_lshl_b32 s31, s25, 2
    s_add_u32 s31, s31, s27
    s_lshl_b32 s31, s31, 12
    s_add_u32 s35, s31, 25690112
    s_mov_b32 s8, s80
    s_mov_b32 s9, s81
    s_mov_b32 s10, 0x188000
    s_mov_b32 s11, 0x20000
    s_lshl_b32 s76, s63, 2
    s_add_u32 s76, s76, s24
    s_mul_i32 s76, s76, 14336
    s_add_u32 s76, s76, 0
    s_add_u32 s77, s76, 8192
    v_lshlrev_b32 v150, 7, v171
    v_mov_b32 v151, 0x7ffffff0
    v_cmp_gt_u32 vcc, 48, v171
    s_nop 1
    v_cndmask_b32 v151, v151, v150, vcc
    s_mov_b32 s12, s64
    s_mov_b32 s13, s65
    s_mov_b32 s14, 0x1c0000
    s_mov_b32 s15, 0x20000
    s_mov_b32 s16, s78
    s_mov_b32 s17, s79
    s_mov_b32 s18, 0x188000
    s_mov_b32 s19, 0x20000
    s_mov_b32 s20, s80
    s_mov_b32 s21, s81
    s_mov_b32 s22, 0x188000
    s_mov_b32 s23, 0x20000
    v_mov_b32 v160, v171
    v_lshrrev_b32 v161, 2, v160
    v_mul_u32_u24 v161, 3584, v161
    v_and_b32 v162, 3, v160
    v_lshl_add_u32 v161, v162, 4, v161
    s_lshl_b32 s29, s26, 8
    s_lshl_b32 s30, s24, 6
    s_add_u32 s29, s29, s30
    v_add_u32 v161, s29, v161
    v_lshrrev_b32 v162, 3, v160
    v_mul_u32_u24 v162, 896, v162
    v_bfe_u32 v163, v160, 4, 1
    v_lshlrev_b32 v163, 2, v163
    v_and_b32 v164, 7, v160
    v_xor_b32 v163, v163, v164
    v_lshl_add_u32 v162, v163, 4, v162
    s_lshl_b32 s29, s28, 7
    s_mul_i32 s30, s24, 401408
    s_add_u32 s29, s29, s30
    v_add_u32 v162, s29, v162
    v_bfe_u32 v163, v160, 2, 2
    v_and_b32 v164, 3, v160
    v_bfe_u32 v165, v160, 4, 1
    v_lshrrev_b32 v166, 5, v160
    v_lshl_add_u32 v167, v166, 3, v163
    v_lshlrev_b32 v167, 6, v167
    v_lshl_add_u32 v167, v165, 5, v167
    v_lshl_add_u32 v167, v164, 3, v167
    v_lshl_add_u32 v168, v166, 2, v163
    v_lshlrev_b32 v168, 7, v168
    v_lshrrev_b32 v169, 1, v164
    v_lshl_add_u32 v169, v165, 1, v169
    v_lshrrev_b32 v170, 1, v163
    v_lshlrev_b32 v170, 2, v170
    v_xor_b32 v169, v169, v170
    v_lshl_add_u32 v168, v169, 4, v168
    v_and_b32 v169, 1, v164
    v_lshl_add_u32 v168, v169, 3, v168
    s_mul_i32 s56, s24, 20480
    s_add_u32 s56, s56, 81920
    v_add_u32 v167, s56, v167
    v_add_u32 v168, s56, v168
    v_xor_b32 v169, 64, v168
L_join:
    s_and_b32 s93, s92, 0xffff0000
    s_lshl_b32 s92, s92, 16
    s_lshl_b32 s98, s62, 7
    s_add_u32 s98, s98, 26222592
    v_and_b32 v12, 15, v171
    v_lshlrev_b32 v12, 2, v12
    s_lshl_b32 s99, s95, 6
    v_add_u32 v26, s99, v171
    v_and_b32 v27, 3, v26
    v_mul_u32_u24 v27, 1568, v27
    v_lshrrev_b32 v30, 2, v26
    v_lshl_add_u32 v27, v30, 4, v27
    s_mul_i32 s99, s94, 6272
    s_add_u32 s99, s99, 67328
    v_add_u32 v27, s99, v27
    v_lshlrev_b32 v26, 4, v26
    s_lshl_b32 s33, s94, 12
    s_add_u32 s33, s33, s91
    s_add_u32 s33, s33, 0
    s_mov_b32 s55, 0
Lc_k0poll:
    buffer_load_dword v13, v12, s[4:7], s98 offen sc1
    s_add_u32 s99, s3, 1
    s_waitcnt vmcnt(0)
    v_cmp_ne_u32 vcc, s99, v13
    s_add_u32 s55, s55, 1
    s_and_b64 s[40:41], vcc, exec
    s_cbranch_scc0 Lc_k0ok
    s_cmp_lt_u32 s55, 0x40000
    s_cbranch_scc1 Lc_k0poll
Lc_k0ok:
    buffer_load_dwordx4 v[16:19], v26, s[4:7], s33 offen sc1
    buffer_load_dwordx4 v[20:23], v26, s[4:7], s33 offen offset:2048 sc1
    v_and_b32 v14, 31, v171
    v_lshrrev_b32 v15, 5, v171
    v_and_b32 v7, 7, v14
    v_mul_u32_u24 v7, 4160, v7
    v_lshrrev_b32 v12, 3, v14
    v_sub_u32 v12, v12, v15
    v_lshl_add_u32 v7, v12, 4, v7
    s_mul_i32 s98, s94, 33280
    s_lshl_b32 s99, s95, 10
    s_add_u32 s98, s98, s99
    s_add_u32 s98, s98, 272
    v_add_u32 v14, s98, v7
    v_and_b32 v7, 31, v171
    v_lshlrev_b32 v7, 4, v7
    v_mul_u32_u24 v12, 1568, v15
    v_add_u32 v7, v7, v12
    s_mul_i32 s98, s94, 6272
    s_lshl_b32 s99, s95, 8
    s_sub_u32 s98, s98, s99
    s_add_u32 s98, s98, 66816
    v_add_u32 v15, s98, v7
    s_waitcnt vmcnt(1)
    ds_write_b128 v27, v[16:19]
    s_waitcnt vmcnt(0)
    ds_write_b128 v27, v[20:23] offset:512
    s_add_u32 m0, s56, 0
    s_mov_b32 s57, 0
    buffer_load_dwordx4 v161, s[16:19], s57 offen lds
    s_add_u32 m0, s56, 1024
    s_mov_b32 s57, 57344
    buffer_load_dwordx4 v161, s[16:19], s57 offen lds
    s_add_u32 m0, s56, 2048
    s_mov_b32 s57, 114688
    buffer_load_dwordx4 v161, s[16:19], s57 offen lds
    s_add_u32 m0, s56, 3072
    s_mov_b32 s57, 172032
    buffer_load_dwordx4 v161, s[16:19], s57 offen lds
    s_add_u32 m0, s56, 4096
    s_mov_b32 s57, 229376
    buffer_load_dwordx4 v161, s[16:19], s57 offen lds
    s_add_u32 m0, s56, 5120
    s_mov_b32 s57, 286720
    buffer_load_dwordx4 v161, s[16:19], s57 offen lds
    s_add_u32 m0, s56, 6144
    s_mov_b32 s57, 344064
    buffer_load_dwordx4 v161, s[16:19], s57 offen lds
    s_add_u32 m0, s56, 7168
    s_mov_b32 s57, 401408
    buffer_load_dwordx4 v161, s[16:19], s57 offen lds
    s_add_u32 m0, s56, 8192
    s_mov_b32 s57, 458752
    buffer_load_dwordx4 v161, s[16:19], s57 offen lds
    s_add_u32 m0, s56, 9216
    s_mov_b32 s57, 516096
    buffer_load_dwordx4 v161, s[16:19], s57 offen lds
    s_add_u32 m0, s56, 10240
    s_mov_b32 s57, 573440
    buffer_load_dwordx4 v161, s[16:19], s57 offen lds
    s_add_u32 m0, s56, 11264
    s_mov_b32 s57, 630784
    buffer_load_dwordx4 v161, s[16:19], s57 offen lds
    s_add_u32 m0, s56, 12288
    s_mov_b32 s57, 688128
    buffer_load_dwordx4 v161, s[16:19], s57 offen lds
    s_add_u32 m0, s56, 13312
    s_mov_b32 s57, 745472
    buffer_load_dwordx4 v161, s[16:19], s57 offen lds
    s_add_u32 m0, s56, 14336
    s_mov_b32 s57, 802816
    buffer_load_dwordx4 v161, s[16:19], s57 offen lds
    s_add_u32 m0, s56, 15360
    s_mov_b32 s57, 860160
    buffer_load_dwordx4 v161, s[16:19], s57 offen lds
    s_waitcnt lgkmcnt(0)
    s_barrier
    ds_read_b128 v[96:99], v14 offset:32
    ds_read_b128 v[100:103], v15 offset:1024
    ds_read_b128 v[104:107], v15 offset:512
    ds_read_b128 v[108:111], v14 offset:2080
    ds_read_b128 v[112:115], v14 offset:0
    ds_read_b128 v[116:119], v15 offset:4160
    ds_read_b128 v[120:123], v15 offset:3648
    ds_read_b128 v[124:127], v14 offset:2048
    s_waitcnt lgkmcnt(4)
    v_mfma_f32_32x32x16_bf16 v[80:95], v[96:99], v[100:103], 0
    ds_read_b128 v[128:131], v14 offset:96
    ds_read_b128 v[132:135], v15 offset:1008
    s_waitcnt vmcnt(12)
    ds_read_b64_tr_b16 v[176:177], v167 offset:0
    v_mfma_f32_32x32x16_bf16 v[64:79], v[96:99], v[104:107], 0
    ds_read_b128 v[136:139], v15 offset:496
    ds_read_b64_tr_b16 v[178:179], v167 offset:256
    ds_read_b64_tr_b16 v[180:181], v167 offset:1024
    v_mfma_f32_32x32x16_bf16 v[80:95], v[108:111], v[104:107], v[80:95]
    ds_read_b128 v[140:143], v14 offset:2144
    ds_read_b64_tr_b16 v[182:183], v167 offset:1280
    s_waitcnt lgkmcnt(8)
    v_mfma_f32_32x32x16_bf16 v[80:95], v[112:115], v[116:119], v[80:95]
    ds_read_b128 v[96:99], v14 offset:64
    ds_read_b128 v[100:103], v15 offset:4144
    ds_read_b64_tr_b16 v[184:185], v167 offset:2048
    ds_read_b64_tr_b16 v[186:187], v167 offset:2304
    v_mfma_f32_32x32x16_bf16 v[64:79], v[112:115], v[120:123], v[64:79]
    ds_read_b128 v[104:107], v15 offset:3632
    ds_read_b64_tr_b16 v[188:189], v167 offset:3072
    v_mfma_f32_32x32x16_bf16 v[80:95], v[124:127], v[120:123], v[80:95]
    ds_read_b128 v[108:111], v14 offset:2112
    ds_read_b64_tr_b16 v[190:191], v167 offset:3328
    s_add_u32 m0, s56, 16384
    s_mov_b32 s57, 917504
    buffer_load_dwordx4 v161, s[16:19], s57 offen lds
    s_waitcnt lgkmcnt(9)
    v_mfma_f32_32x32x16_bf16 v[80:95], v[128:131], v[132:135], v[80:95]
    ds_read_b128 v[112:115], v14 offset:160
    ds_read_b128 v[116:119], v15 offset:992
    s_add_u32 m0, s56, 17408
    s_mov_b32 s57, 974848
    buffer_load_dwordx4 v161, s[16:19], s57 offen lds
    v_mfma_f32_32x32x16_bf16 v[64:79], v[128:131], v[136:139], v[64:79]
    ds_read_b128 v[120:123], v15 offset:480
    s_add_u32 m0, s56, 18432
    s_mov_b32 s57, 1032192
    buffer_load_dwordx4 v161, s[16:19], s57 offen lds
    s_add_u32 m0, s56, 19456
    s_mov_b32 s57, 1089536
    buffer_load_dwordx4 v161, s[16:19], s57 offen lds
    v_mfma_f32_32x32x16_bf16 v[80:95], v[140:143], v[136:139], v[80:95]
    ds_read_b128 v[124:127], v14 offset:2208
    s_waitcnt vmcnt(12)
    ds_read_b64_tr_b16 v[192:193], v167 offset:4096
    s_waitcnt lgkmcnt(6)
    v_mfma_f32_32x32x16_bf16 v[80:95], v[96:99], v[100:103], v[80:95]
    ds_read_b128 v[128:131], v14 offset:128
    ds_read_b128 v[132:135], v15 offset:4128
    ds_read_b64_tr_b16 v[194:195], v167 offset:4352
    v_mfma_f32_32x32x16_bf16 v[64:79], v[96:99], v[104:107], v[64:79]
    ds_read_b128 v[136:139], v15 offset:3616
    ds_read_b64_tr_b16 v[196:197], v167 offset:5120
    ds_read_b64_tr_b16 v[198:199], v167 offset:5376
    v_mfma_f32_32x32x16_bf16 v[80:95], v[108:111], v[104:107], v[80:95]
    ds_read_b128 v[140:143], v14 offset:2176
    ds_read_b64_tr_b16 v[200:201], v167 offset:6144
    s_waitcnt lgkmcnt(9)
    v_mfma_f32_32x32x16_bf16 v[80:95], v[112:115], v[116:119], v[80:95]
    ds_read_b128 v[96:99], v14 offset:224
    ds_read_b128 v[100:103], v15 offset:976
    ds_read_b64_tr_b16 v[202:203], v167 offset:6400
    ds_read_b64_tr_b16 v[204:205], v167 offset:7168
    v_mfma_f32_32x32x16_bf16 v[64:79], v[112:115], v[120:123], v[64:79]
    ds_read_b128 v[104:107], v15 offset:464
    ds_read_b64_tr_b16 v[206:207], v167 offset:7424
    v_mfma_f32_32x32x16_bf16 v[80:95], v[124:127], v[120:123], v[80:95]
    ds_read_b128 v[108:111], v14 offset:2272
    s_waitcnt lgkmcnt(15)
    s_add_u32 m0, s56, 0
    s_mov_b32 s57, 1146880
    buffer_load_dwordx4 v161, s[16:19], s57 offen lds
    s_waitcnt lgkmcnt(8)
    v_mfma_f32_32x32x16_bf16 v[80:95], v[128:131], v[132:135], v[80:95]
    ds_read_b128 v[112:115], v14 offset:192
    ds_read_b128 v[116:119], v15 offset:4112
    s_add_u32 m0, s56, 1024
    s_mov_b32 s57, 1204224
    buffer_load_dwordx4 v161, s[16:19], s57 offen lds
    v_mfma_f32_32x32x16_bf16 v[64:79], v[128:131], v[136:139], v[64:79]
    ds_read_b128 v[120:123], v15 offset:3600
    s_add_u32 m0, s56, 2048
    s_mov_b32 s57, 1261568
    buffer_load_dwordx4 v161, s[16:19], s57 offen lds
    s_add_u32 m0, s56, 3072
    s_mov_b32 s57, 1318912
    buffer_load_dwordx4 v161, s[16:19], s57 offen lds
    v_mfma_f32_32x32x16_bf16 v[80:95], v[140:143], v[136:139], v[80:95]
    ds_read_b128 v[124:127], v14 offset:2240
    s_waitcnt vmcnt(12)
    ds_read_b64_tr_b16 v[208:209], v167 offset:8192
    s_waitcnt lgkmcnt(5)
    v_mfma_f32_32x32x16_bf16 v[80:95], v[96:99], v[100:103], v[80:95]
    ds_read_b128 v[128:131], v14 offset:288
    ds_read_b128 v[132:135], v15 offset:960
    ds_read_b64_tr_b16 v[210:211], v167 offset:8448
    v_mfma_f32_32x32x16_bf16 v[64:79], v[96:99], v[104:107], v[64:79]
    ds_read_b128 v[136:139], v15 offset:448
    ds_read_b64_tr_b16 v[212:213], v167 offset:9216
    ds_read_b64_tr_b16 v[214:215], v167 offset:9472
    v_mfma_f32_32x32x16_bf16 v[80:95], v[108:111], v[104:107], v[80:95]
    ds_read_b128 v[140:143], v14 offset:2336
    ds_read_b64_tr_b16 v[216:217], v167 offset:10240
    s_waitcnt lgkmcnt(9)
    v_mfma_f32_32x32x16_bf16 v[80:95], v[112:115], v[116:119], v[80:95]
    ds_read_b128 v[96:99], v14 offset:256
    ds_read_b128 v[100:103], v15 offset:4096
    ds_read_b64_tr_b16 v[218:219], v167 offset:10496
    ds_read_b64_tr_b16 v[220:221], v167 offset:11264
    v_mfma_f32_32x32x16_bf16 v[64:79], v[112:115], v[120:123], v[64:79]
    ds_read_b128 v[104:107], v15 offset:3584
    ds_read_b64_tr_b16 v[222:223], v167 offset:11520
    v_mfma_f32_32x32x16_bf16 v[80:95], v[124:127], v[120:123], v[80:95]
    ds_read_b128 v[108:111], v14 offset:2304
    s_waitcnt lgkmcnt(15)
    s_add_u32 m0, s56, 4096
    s_mov_b32 s57, 1376256
    buffer_load_dwordx4 v161, s[16:19], s57 offen lds
    s_waitcnt lgkmcnt(8)
    v_mfma_f32_32x32x16_bf16 v[80:95], v[128:131], v[132:135], v[80:95]
    ds_read_b128 v[112:115], v14 offset:352
    ds_read_b128 v[116:119], v15 offset:944
    s_add_u32 m0, s56, 5120
    s_mov_b32 s57, 1433600
    buffer_load_dwordx4 v161, s[16:19], s57 offen lds
    v_mfma_f32_32x32x16_bf16 v[64:79], v[128:131], v[136:139], v[64:79]
    ds_read_b128 v[120:123], v15 offset:432
    s_add_u32 m0, s56, 6144
    s_mov_b32 s57, 1490944
    buffer_load_dwordx4 v161, s[16:19], s57 offen lds
    s_add_u32 m0, s56, 7168
    s_mov_b32 s57, 1548288
    buffer_load_dwordx4 v161, s[16:19], s57 offen lds
    v_mfma_f32_32x32x16_bf16 v[80:95], v[140:143], v[136:139], v[80:95]
    ds_read_b128 v[124:127], v14 offset:2400
    s_waitcnt vmcnt(12)
    ds_read_b64_tr_b16 v[224:225], v167 offset:12288
    s_waitcnt lgkmcnt(5)
    v_mfma_f32_32x32x16_bf16 v[80:95], v[96:99], v[100:103], v[80:95]
    ds_read_b128 v[128:131], v14 offset:320
    ds_read_b128 v[132:135], v15 offset:4080
    ds_read_b64_tr_b16 v[226:227], v167 offset:12544
    v_mfma_f32_32x32x16_bf16 v[64:79], v[96:99], v[104:107], v[64:79]
    ds_read_b128 v[136:139], v15 offset:3568
    ds_read_b64_tr_b16 v[228:229], v167 offset:13312
    ds_read_b64_tr_b16 v[230:231], v167 offset:13568
    v_mfma_f32_32x32x16_bf16 v[80:95], v[108:111], v[104:107], v[80:95]
    ds_read_b128 v[140:143], v14 offset:2368
    ds_read_b64_tr_b16 v[232:233], v167 offset:14336
    s_waitcnt lgkmcnt(9)
    v_mfma_f32_32x32x16_bf16 v[80:95], v[112:115], v[116:119], v[80:95]
    ds_read_b128 v[96:99], v14 offset:416
    ds_read_b128 v[100:103], v15 offset:928
    ds_read_b64_tr_b16 v[234:235], v167 offset:14592
    ds_read_b64_tr_b16 v[236:237], v167 offset:15360
    buffer_load_dword v174, v150, s[8:11], s76 offen
    v_mfma_f32_32x32x16_bf16 v[64:79], v[112:115], v[120:123], v[64:79]
    ds_read_b128 v[104:107], v15 offset:416
    ds_read_b64_tr_b16 v[238:239], v167 offset:15616
    v_mfma_f32_32x32x16_bf16 v[80:95], v[124:127], v[120:123], v[80:95]
    ds_read_b128 v[108:111], v14 offset:2464
    s_waitcnt vmcnt(9)
    ds_read_b64_tr_b16 v[240:241], v167 offset:16384
    s_waitcnt lgkmcnt(9)
    v_mfma_f32_32x32x16_bf16 v[80:95], v[128:131], v[132:135], v[80:95]
    ds_read_b128 v[112:115], v14 offset:384
    ds_read_b128 v[116:119], v15 offset:4064
    ds_read_b64_tr_b16 v[242:243], v167 offset:16640
    ds_read_b64_tr_b16 v[244:245], v167 offset:17408
    buffer_load_dword v174, v151, s[8:11], s77 offen
    v_mfma_f32_32x32x16_bf16 v[64:79], v[128:131], v[136:139], v[64:79]
    ds_read_b128 v[120:123], v15 offset:3552
    ds_read_b64_tr_b16 v[246:247], v167 offset:17664
    v_mfma_f32_32x32x16_bf16 v[80:95], v[140:143], v[136:139], v[80:95]
    ds_read_b128 v[124:127], v14 offset:2432
    ds_read_b64_tr_b16 v[248:249], v167 offset:18432
    ds_read_b64_tr_b16 v[250:251], v167 offset:18688
    s_waitcnt lgkmcnt(10)
    v_mfma_f32_32x32x16_bf16 v[80:95], v[96:99], v[100:103], v[80:95]
    ds_read_b128 v[128:131], v14 offset:480
    ds_read_b128 v[132:135], v15 offset:912
    ds_read_b64_tr_b16 v[252:253], v167 offset:19456
    s_mov_b32 s98, 57344
    buffer_load_dwordx4 v[40:43], v149, s[12:15], 0 offen
    buffer_load_dwordx4 v[44:47], v149, s[12:15], s98 offen
    v_mfma_f32_32x32x16_bf16 v[64:79], v[96:99], v[104:107], v[64:79]
    ds_read_b128 v[136:139], v15 offset:400
    ds_read_b64_tr_b16 v[254:255], v167 offset:19712
    s_waitcnt vmcnt(8)
    v_mfma_f32_32x32x16_bf16 v[80:95], v[108:111], v[104:107], v[80:95]
    ds_read_b128 v[140:143], v14 offset:2528
    ds_read_b64_tr_b16 a[224:225], v167 offset:0
    s_waitcnt lgkmcnt(9)
    v_mfma_f32_32x32x16_bf16 v[80:95], v[112:115], v[116:119], v[80:95]
    ds_read_b128 v[96:99], v14 offset:448
    ds_read_b128 v[100:103], v15 offset:4048
    ds_read_b64_tr_b16 a[226:227], v167 offset:256
    ds_read_b64_tr_b16 a[228:229], v167 offset:1024
    v_mfma_f32_32x32x16_bf16 v[64:79], v[112:115], v[120:123], v[64:79]
    ds_read_b128 v[104:107], v15 offset:3536
    ds_read_b64_tr_b16 a[230:231], v167 offset:1280
    v_mfma_f32_32x32x16_bf16 v[80:95], v[124:127], v[120:123], v[80:95]
    ds_read_b128 v[108:111], v14 offset:2496
    ds_read_b64_tr_b16 a[232:233], v167 offset:2048
    ds_read_b64_tr_b16 a[234:235], v167 offset:2304
    s_waitcnt lgkmcnt(10)
    v_mfma_f32_32x32x16_bf16 v[80:95], v[128:131], v[132:135], v[80:95]
    ds_read_b128 v[112:115], v14 offset:544
    ds_read_b128 v[116:119], v15 offset:896
    ds_read_b64_tr_b16 a[236:237], v167 offset:3072
    ds_read_b64_tr_b16 a[238:239], v167 offset:3328
    v_mfma_f32_32x32x16_bf16 v[64:79], v[128:131], v[136:139], v[64:79]
    ds_read_b128 v[120:123], v15 offset:384
    s_waitcnt vmcnt(4)
    v_mfma_f32_32x32x16_bf16 v[80:95], v[140:143], v[136:139], v[80:95]
    ds_read_b128 v[124:127], v14 offset:2592
    ds_read_b64_tr_b16 a[240:241], v167 offset:4096
    ds_read_b64_tr_b16 a[242:243], v167 offset:4352
    s_waitcnt lgkmcnt(10)
    v_mfma_f32_32x32x16_bf16 v[80:95], v[96:99], v[100:103], v[80:95]
    ds_read_b128 v[128:131], v14 offset:512
    ds_read_b128 v[132:135], v15 offset:4032
    ds_read_b64_tr_b16 a[244:245], v167 offset:5120
    v_mfma_f32_32x32x16_bf16 v[64:79], v[96:99], v[104:107], v[64:79]
    ds_read_b128 v[136:139], v15 offset:3520
    ds_read_b64_tr_b16 a[246:247], v167 offset:5376
    ds_read_b64_tr_b16 a[248:249], v167 offset:6144
    v_mfma_f32_32x32x16_bf16 v[80:95], v[108:111], v[104:107], v[80:95]
    ds_read_b128 v[140:143], v14 offset:2560
    ds_read_b64_tr_b16 a[250:251], v167 offset:6400
    s_waitcnt lgkmcnt(10)
    v_mfma_f32_32x32x16_bf16 v[80:95], v[112:115], v[116:119], v[80:95]
    ds_read_b128 v[96:99], v14 offset:608
    ds_read_b128 v[100:103], v15 offset:880
    ds_read_b64_tr_b16 a[252:253], v167 offset:7168
    ds_read_b64_tr_b16 a[254:255], v167 offset:7424
    v_mfma_f32_32x32x16_bf16 v[64:79], v[112:115], v[120:123], v[64:79]
    ds_read_b128 v[104:107], v15 offset:368
    s_waitcnt lgkmcnt(1)
    v_mfma_f32_32x32x16_bf16 v[80:95], v[124:127], v[120:123], v[80:95]
    ds_read_b128 v[108:111], v14 offset:2656
    s_waitcnt lgkmcnt(7)
    v_mfma_f32_32x32x16_bf16 v[80:95], v[128:131], v[132:135], v[80:95]
    ds_read_b128 v[112:115], v14 offset:576
    ds_read_b128 v[116:119], v15 offset:4016
    v_mfma_f32_32x32x16_bf16 v[64:79], v[128:131], v[136:139], v[64:79]
    ds_read_b128 v[120:123], v15 offset:3504
    v_mfma_f32_32x32x16_bf16 v[80:95], v[140:143], v[136:139], v[80:95]
    ds_read_b128 v[124:127], v14 offset:2624
    s_waitcnt lgkmcnt(4)
    v_mfma_f32_32x32x16_bf16 v[80:95], v[96:99], v[100:103], v[80:95]
    ds_read_b128 v[128:131], v14 offset:672
    ds_read_b128 v[132:135], v15 offset:864
    v_mfma_f32_32x32x16_bf16 v[64:79], v[96:99], v[104:107], v[64:79]
    ds_read_b128 v[136:139], v15 offset:352
    v_mfma_f32_32x32x16_bf16 v[80:95], v[108:111], v[104:107], v[80:95]
    ds_read_b128 v[140:143], v14 offset:2720
    s_waitcnt lgkmcnt(4)
    v_mfma_f32_32x32x16_bf16 v[80:95], v[112:115], v[116:119], v[80:95]
    ds_read_b128 v[96:99], v14 offset:640
    ds_read_b128 v[100:103], v15 offset:4000
    v_mfma_f32_32x32x16_bf16 v[64:79], v[112:115], v[120:123], v[64:79]
    ds_read_b128 v[104:107], v15 offset:3488
    v_mfma_f32_32x32x16_bf16 v[80:95], v[124:127], v[120:123], v[80:95]
    ds_read_b128 v[108:111], v14 offset:2688
    s_waitcnt lgkmcnt(4)
    v_mfma_f32_32x32x16_bf16 v[80:95], v[128:131], v[132:135], v[80:95]
    ds_read_b128 v[112:115], v14 offset:736
    ds_read_b128 v[116:119], v15 offset:848
    v_and_b32 v7, 31, v171
    v_lshrrev_b32 v12, 5, v171
    v_mfma_f32_32x32x16_bf16 v[64:79], v[128:131], v[136:139], v[64:79]
    ds_read_b128 v[120:123], v15 offset:336
    v_and_b32 v13, 7, v7
    v_mfma_f32_32x32x16_bf16 v[80:95], v[140:143], v[136:139], v[80:95]
    ds_read_b128 v[124:127], v14 offset:2784
    v_xor_b32 v12, v12, v13
    s_waitcnt lgkmcnt(4)
    v_mfma_f32_32x32x16_bf16 v[80:95], v[96:99], v[100:103], v[80:95]
    ds_read_b128 v[128:131], v14 offset:704
    ds_read_b128 v[132:135], v15 offset:3984
    v_lshlrev_b32 v7, 7, v7
    v_mfma_f32_32x32x16_bf16 v[64:79], v[96:99], v[104:107], v[64:79]
    ds_read_b128 v[136:139], v15 offset:3472
    s_lshl_b32 s98, s24, 13
    s_add_u32 s98, s98, 256
    v_mfma_f32_32x32x16_bf16 v[80:95], v[108:111], v[104:107], v[80:95]
    ds_read_b128 v[140:143], v14 offset:2752
    v_add_u32 v7, s98, v7
    s_waitcnt lgkmcnt(4)
    v_mfma_f32_32x32x16_bf16 v[80:95], v[112:115], v[116:119], v[80:95]
    ds_read_b128 v[96:99], v14 offset:800
    ds_read_b128 v[100:103], v15 offset:832
    v_xor_b32 v16, 0, v12
    v_mfma_f32_32x32x16_bf16 v[64:79], v[112:115], v[120:123], v[64:79]
    ds_read_b128 v[104:107], v15 offset:320
    v_lshl_add_u32 v16, v16, 4, v7
    v_mfma_f32_32x32x16_bf16 v[80:95], v[124:127], v[120:123], v[80:95]
    ds_read_b128 v[108:111], v14 offset:2848
    v_xor_b32 v17, 2, v12
    v_lshl_add_u32 v17, v17, 4, v7
    s_waitcnt lgkmcnt(4)
    v_mfma_f32_32x32x16_bf16 v[80:95], v[128:131], v[132:135], v[80:95]
    ds_read_b128 v[112:115], v14 offset:768
    ds_read_b128 v[116:119], v15 offset:3968
    v_xor_b32 v18, 4, v12
    v_mfma_f32_32x32x16_bf16 v[64:79], v[128:131], v[136:139], v[64:79]
    ds_read_b128 v[120:123], v15 offset:3456
    v_lshl_add_u32 v18, v18, 4, v7
    v_mfma_f32_32x32x16_bf16 v[80:95], v[140:143], v[136:139], v[80:95]
    ds_read_b128 v[124:127], v14 offset:2816
    v_xor_b32 v19, 6, v12
    s_waitcnt lgkmcnt(4)
    v_mfma_f32_32x32x16_bf16 v[80:95], v[96:99], v[100:103], v[80:95]
    ds_read_b128 v[128:131], v14 offset:864
    ds_read_b128 v[132:135], v15 offset:816
    v_lshl_add_u32 v19, v19, 4, v7
    v_lshrrev_b32 v20, 3, v171
    v_mfma_f32_32x32x16_bf16 v[64:79], v[96:99], v[104:107], v[64:79]
    ds_read_b128 v[136:139], v15 offset:304
    v_and_b32 v21, 7, v171
    v_mfma_f32_32x32x16_bf16 v[80:95], v[108:111], v[104:107], v[80:95]
    ds_read_b128 v[140:143], v14 offset:2912
    s_lshl_b32 s98, s95, 4
    s_waitcnt lgkmcnt(4)
    v_mfma_f32_32x32x16_bf16 v[80:95], v[112:115], v[116:119], v[80:95]
    ds_read_b128 v[96:99], v14 offset:832
    ds_read_b128 v[100:103], v15 offset:3952
    v_add_u32 v22, s98, v20
    v_mfma_f32_32x32x16_bf16 v[64:79], v[112:115], v[120:123], v[64:79]
    ds_read_b128 v[104:107], v15 offset:3440
    v_xor_b32 v23, v21, v20
    v_lshlrev_b32 v23, 4, v23
    v_mfma_f32_32x32x16_bf16 v[80:95], v[124:127], v[120:123], v[80:95]
    ds_read_b128 v[108:111], v14 offset:2880
    v_lshl_add_u32 v23, v22, 7, v23
    s_waitcnt lgkmcnt(4)
    v_mfma_f32_32x32x16_bf16 v[80:95], v[128:131], v[132:135], v[80:95]
    ds_read_b128 v[112:115], v14 offset:928
    ds_read_b128 v[116:119], v15 offset:800
    s_lshl_b32 s98, s94, 12
    v_mfma_f32_32x32x16_bf16 v[64:79], v[128:131], v[136:139], v[64:79]
    ds_read_b128 v[120:123], v15 offset:288
    s_add_u32 s98, s98, 256
    v_mfma_f32_32x32x16_bf16 v[80:95], v[140:143], v[136:139], v[80:95]
    ds_read_b128 v[124:127], v14 offset:2976
    v_add_u32 v23, s98, v23
    v_lshrrev_b32 v24, 1, v21
    s_waitcnt lgkmcnt(4)
    v_mfma_f32_32x32x16_bf16 v[80:95], v[96:99], v[100:103], v[80:95]
    ds_read_b128 v[128:131], v14 offset:896
    ds_read_b128 v[132:135], v15 offset:3936
    v_mul_u32_u24 v24, 1568, v24
    v_mfma_f32_32x32x16_bf16 v[64:79], v[96:99], v[104:107], v[64:79]
    ds_read_b128 v[136:139], v15 offset:3424
    v_lshl_add_u32 v24, v22, 4, v24
    v_mfma_f32_32x32x16_bf16 v[80:95], v[108:111], v[104:107], v[80:95]
    ds_read_b128 v[140:143], v14 offset:2944
    v_and_b32 v25, 1, v21
    s_waitcnt lgkmcnt(4)
    v_mfma_f32_32x32x16_bf16 v[80:95], v[112:115], v[116:119], v[80:95]
    ds_read_b128 v[96:99], v14 offset:992
    ds_read_b128 v[100:103], v15 offset:784
    v_xor_b32 v25, 1, v25
    v_lshl_add_u32 v24, v25, 3, v24
    v_mfma_f32_32x32x16_bf16 v[64:79], v[112:115], v[120:123], v[64:79]
    ds_read_b128 v[104:107], v15 offset:272
    s_lshl_b32 s98, s94, 9
    v_mfma_f32_32x32x16_bf16 v[80:95], v[124:127], v[120:123], v[80:95]
    ds_read_b128 v[108:111], v14 offset:3040
    s_add_u32 s98, s98, 67328
    s_waitcnt lgkmcnt(4)
    v_mfma_f32_32x32x16_bf16 v[80:95], v[128:131], v[132:135], v[80:95]
    ds_read_b128 v[112:115], v14 offset:960
    ds_read_b128 v[116:119], v15 offset:3920
    v_add_u32 v24, s98, v24
    v_mfma_f32_32x32x16_bf16 v[64:79], v[128:131], v[136:139], v[64:79]
    ds_read_b128 v[120:123], v15 offset:3408
    s_lshl_b32 s98, s24, 11
    s_add_u32 s98, s98, s91
    v_mfma_f32_32x32x16_bf16 v[80:95], v[140:143], v[136:139], v[80:95]
    ds_read_b128 v[124:127], v14 offset:3008
    s_add_u32 s98, s98, 2097152
    s_waitcnt lgkmcnt(4)
    v_mfma_f32_32x32x16_bf16 v[80:95], v[96:99], v[100:103], v[80:95]
    v_lshlrev_b32 v25, 4, v171
    v_mfma_f32_32x32x16_bf16 v[64:79], v[96:99], v[104:107], v[64:79]
    v_add_u32 v25, s98, v25
    v_mfma_f32_32x32x16_bf16 v[80:95], v[108:111], v[104:107], v[80:95]
    s_waitcnt lgkmcnt(0)
    v_mfma_f32_32x32x16_bf16 v[80:95], v[112:115], v[116:119], v[80:95]
    v_mfma_f32_32x32x16_bf16 v[64:79], v[112:115], v[120:123], v[64:79]
    v_mfma_f32_32x32x16_bf16 v[80:95], v[124:127], v[120:123], v[80:95]
    s_barrier
    s_nop 9
    ds_write_b128 v16, v[64:67] offset:0
    ds_write_b128 v17, v[68:71] offset:0
    ds_write_b128 v18, v[72:75] offset:0
    ds_write_b128 v19, v[76:79] offset:0
    ds_write_b128 v16, v[80:83] offset:4096
    ds_write_b128 v17, v[84:87] offset:4096
    ds_write_b128 v18, v[88:91] offset:4096
    ds_write_b128 v19, v[92:95] offset:4096
    s_waitcnt lgkmcnt(0)
    s_barrier
    ds_read_b128 v[96:99], v23 offset:0
    ds_read_b128 v[100:103], v23 offset:8192
    ds_read_b128 v[104:107], v23 offset:16384
    ds_read_b128 v[108:111], v23 offset:24576
    ds_read_b64 v[112:113], v24 offset:0
    ds_read_b64 v[114:115], v24 offset:6272
    ds_read_b128 v[120:123], v23 offset:1024
    ds_read_b128 v[124:127], v23 offset:9216
    ds_read_b128 v[128:131], v23 offset:17408
    ds_read_b128 v[132:135], v23 offset:25600
    ds_read_b64 v[136:137], v24 offset:128
    ds_read_b64 v[138:139], v24 offset:6400
    s_waitcnt lgkmcnt(6)
    v_add_f32 v96, v96, v100
    v_add_f32 v97, v97, v101
    v_add_f32 v98, v98, v102
    v_add_f32 v99, v99, v103
    v_and_b32 v144, s46, v113
    v_lshlrev_b32 v145, 16, v113
    v_and_b32 v146, s46, v112
    v_lshlrev_b32 v147, 16, v112
    v_fmac_f32 v96, s92, v144
    v_fmac_f32 v97, s92, v145
    v_fmac_f32 v98, s92, v146
    v_fmac_f32 v99, s92, v147
    v_add_f32 v104, v104, v108
    v_add_f32 v105, v105, v109
    v_add_f32 v106, v106, v110
    v_add_f32 v107, v107, v111
    v_and_b32 v144, s46, v115
    v_lshlrev_b32 v145, 16, v115
    v_and_b32 v146, s46, v114
    v_lshlrev_b32 v147, 16, v114
    v_fmac_f32 v104, s93, v144
    v_fmac_f32 v105, s93, v145
    v_fmac_f32 v106, s93, v146
    v_fmac_f32 v107, s93, v147
    v_cvt_pk_bf16_f32 v32, v96, v104
    v_cvt_pk_bf16_f32 v33, v97, v105
    v_cvt_pk_bf16_f32 v34, v98, v106
    v_cvt_pk_bf16_f32 v35, v99, v107
    buffer_store_dwordx4 v[32:35], v25, s[4:7], 0 offen offset:0 sc0 sc1
    s_waitcnt lgkmcnt(0)
    v_add_f32 v120, v120, v124
    v_add_f32 v121, v121, v125
    v_add_f32 v122, v122, v126
    v_add_f32 v123, v123, v127
    v_and_b32 v144, s46, v137
    v_lshlrev_b32 v145, 16, v137
    v_and_b32 v146, s46, v136
    v_lshlrev_b32 v147, 16, v136
    v_fmac_f32 v120, s92, v144
    v_fmac_f32 v121, s92, v145
    v_fmac_f32 v122, s92, v146
    v_fmac_f32 v123, s92, v147
    v_add_f32 v128, v128, v132
    v_add_f32 v129, v129, v133
    v_add_f32 v130, v130, v134
    v_add_f32 v131, v131, v135
    v_and_b32 v144, s46, v139
    v_lshlrev_b32 v145, 16, v139
    v_and_b32 v146, s46, v138
    v_lshlrev_b32 v147, 16, v138
    v_fmac_f32 v128, s93, v144
    v_fmac_f32 v129, s93, v145
    v_fmac_f32 v130, s93, v146
    v_fmac_f32 v131, s93, v147
    v_cvt_pk_bf16_f32 v36, v120, v128
    v_cvt_pk_bf16_f32 v37, v121, v129
    v_cvt_pk_bf16_f32 v38, v122, v130
    v_cvt_pk_bf16_f32 v39, v123, v131
    buffer_store_dwordx4 v[36:39], v25, s[4:7], 0 offen offset:1024 sc0 sc1
L_ffn0:
    v_mov_b32 v0, v175
    v_and_b32 v152, 63, v0
    s_lshl_b32 s31, s25, 8
    s_add_u32 s31, s31, 26214400
    v_lshl_add_u32 v9, v152, 2, s31
    v_lshlrev_b32 v0, 4, v152
    v_add_u32 v1, 57344, v0
    v_and_b32 v153, 7, v152
    v_lshrrev_b32 v154, 3, v152
    s_lshl_b32 s31, s24, 3
    v_add_u32 v155, s31, v153
    v_lshlrev_b32 v2, 4, v155
    v_lshl_add_u32 v2, v154, 9, v2
    v_and_b32 v156, 1, v154
    v_add_u32 v156, s28, v156
    v_lshlrev_b32 v11, 4, v155
    v_lshl_add_u32 v11, v156, 9, v11
    v_lshrrev_b32 v157, 1, v156
    v_lshlrev_b32 v3, 4, v155
    v_lshl_add_u32 v3, v157, 9, v3
    v_and_b32 v157, 1, v156
    v_lshl_add_u32 v3, v157, 3, v3
    v_lshrrev_b32 v156, 1, v154
    s_lshl_b32 s31, s28, 2
    v_add_u32 v156, s31, v156
    v_lshlrev_b32 v4, 10, v156
    v_and_b32 v156, 1, v154
    v_lshl_add_u32 v156, v156, 5, v155
    v_lshl_add_u32 v4, v156, 4, v4
    s_lshl_b32 s31, s25, 7
    s_lshl_b32 s32, s27, 5
    s_add_u32 s31, s31, s32
    v_add_u32 v156, s31, v155
    v_mul_u32_u24 v8, 896, v156
    v_lshl_add_u32 v8, v154, 4, v8
    s_lshl_b32 s32, s28, 7
    v_add_u32 v8, s32, v8
    v_lshlrev_b32 v157, 15, v154
    v_lshl_add_u32 v157, v156, 2, v157
    s_lshl_b32 s32, s28, 18
    s_add_u32 s32, s32, 2097152
    v_add_u32 v58, s32, v157
    v_and_b32 v156, 31, v152
    v_lshlrev_b32 v5, 4, v156
    v_lshrrev_b32 v158, 5, v152
    v_lshl_add_u32 v5, v158, 11, v5
    v_and_b32 v159, 3, v156
    v_bfe_u32 v160, v156, 2, 1
    v_mul_u32_u24 v160, 12, v160
    v_or_b32 v159, v159, v160
    v_xor_b32 v159, v159, v158
    v_lshlrev_b32 v159, 4, v159
    v_lshl_add_u32 v6, v156, 8, v159
    s_lshl_b32 s32, s24, 13
    s_add_u32 s32, s32, 114688
    v_add_u32 v6, s32, v6
    v_and_b32 v159, 3, v153
    v_bfe_u32 v160, v153, 2, 1
    v_mul_u32_u24 v160, 12, v160
    v_or_b32 v159, v159, v160
    v_lshlrev_b32 v160, 1, v154
    v_xor_b32 v159, v159, v160
    v_lshlrev_b32 v159, 4, v159
    v_lshl_add_u32 v7, v155, 8, v159
    v_add_u32 v7, 114688, v7
    s_mov_b32 s12, s82
    s_mov_b32 s13, s83
    s_mov_b32 s14, 0x1c0000
    s_mov_b32 s15, 0x20000
    s_mul_i32 s96, s24, 28672
    s_lshl_b32 s97, s90, 7
    s_add_u32 s96, s96, s97
    s_add_u32 s96, s96, 26230784
    s_lshr_b32 s97, s25, 2
    s_mul_i32 s97, s97, 28672
    s_lshl_b32 s98, s28, 12
    s_add_u32 s97, s97, s98
    s_add_u32 s97, s97, 26230784
    s_lshl_b32 s98, s62, 7
    s_add_u32 s98, s98, 26220544
    v_lshrrev_b32 v158, 2, v0
    v_and_b32 v158, 0x7c, v158
    buffer_load_dword v13, v158, s[4:7], s98 offen sc1
    s_add_u32 s29, s3, 1
    v_mov_b32 v12, s29
    s_waitcnt vmcnt(1)
    buffer_store_dword v12, off, s[4:7], s96 sc0 sc1
    s_waitcnt vmcnt(4)
    v_mov_b32 v16, v40
    v_mov_b32 v17, v41
    v_mov_b32 v18, v42
    v_mov_b32 v19, v43
    v_mov_b32 v20, v44
    v_mov_b32 v21, v45
    v_mov_b32 v22, v46
    v_mov_b32 v23, v47
    s_waitcnt vmcnt(1)
    s_mov_b32 s55, 0
    s_branch L_mchk
L_mpoll:
    buffer_load_dword v13, v158, s[4:7], s98 offen sc1
    s_waitcnt vmcnt(0)
L_mchk:
    s_add_u32 s29, s3, 1
    v_subrev_u32 v157, s29, v13
    v_cmp_le_u32 vcc, 8, v157
    s_add_u32 s55, s55, 1
    s_and_b64 s[40:41], vcc, exec
    s_cbranch_scc0 L_mok
    s_cmp_lt_u32 s55, 0x40000
    s_cbranch_scc1 L_mpoll
L_mok:
    s_add_u32 s29, s3, s88
    v_cmp_ne_u32 vcc, s29, v13
    s_nop 0
    s_and_b64 s[40:41], vcc, exec
    s_cbranch_scc1 L_far_slow
    s_add_u32 m0, s56, 8192
    s_mov_b32 s59, 0
    buffer_load_dwordx4 v162, s[20:23], s59 offen lds
    v_mov_b32 v128, 0x3f803f80
    v_mov_b32 v129, 0x3f803f80
    v_mov_b32 v130, 0x3f803f80
    v_mov_b32 v131, 0x3f803f80
    s_add_u32 m0, s56, 9216
    s_mov_b32 s59, 7168
    buffer_load_dwordx4 v162, s[20:23], s59 offen lds
    s_add_u32 m0, s56, 10240
    s_mov_b32 s59, 14336
    buffer_load_dwordx4 v162, s[20:23], s59 offen lds
    s_add_u32 m0, s56, 11264
    s_mov_b32 s59, 21504
    buffer_load_dwordx4 v162, s[20:23], s59 offen lds
    v_mfma_f32_32x32x16_bf16 v[64:79], v[176:179], v[128:131], 0
    s_add_u32 m0, s56, 12288
    s_mov_b32 s59, 28672
    buffer_load_dwordx4 v162, s[20:23], s59 offen lds
    s_add_u32 m0, s56, 13312
    s_mov_b32 s59, 35840
    buffer_load_dwordx4 v162, s[20:23], s59 offen lds
    s_add_u32 m0, s56, 14336
    s_mov_b32 s59, 43008
    buffer_load_dwordx4 v162, s[20:23], s59 offen lds
    v_mfma_f32_32x32x16_bf16 v[64:79], v[180:183], v[128:131], v[64:79]
    s_add_u32 m0, s56, 15360
    s_mov_b32 s59, 50176
    buffer_load_dwordx4 v162, s[20:23], s59 offen lds
    s_add_u32 m0, s56, 16384
    s_mov_b32 s59, 57344
    buffer_load_dwordx4 v162, s[20:23], s59 offen lds
    s_add_u32 m0, s56, 17408
    s_mov_b32 s59, 64512
    buffer_load_dwordx4 v162, s[20:23], s59 offen lds
    v_mfma_f32_32x32x16_bf16 v[64:79], v[184:187], v[128:131], v[64:79]
    s_add_u32 m0, s56, 18432
    s_mov_b32 s59, 71680
    buffer_load_dwordx4 v162, s[20:23], s59 offen lds
    s_add_u32 m0, s56, 19456
    s_mov_b32 s59, 78848
    buffer_load_dwordx4 v162, s[20:23], s59 offen lds
    s_add_u32 m0, s56, 0
    s_mov_b32 s59, 86016
    buffer_load_dwordx4 v162, s[20:23], s59 offen lds
    v_mfma_f32_32x32x16_bf16 v[64:79], v[188:191], v[128:131], v[64:79]
    s_add_u32 m0, s56, 1024
    s_mov_b32 s59, 93184
    buffer_load_dwordx4 v162, s[20:23], s59 offen lds
    s_add_u32 m0, s56, 2048
    s_mov_b32 s59, 100352
    buffer_load_dwordx4 v162, s[20:23], s59 offen lds
    s_add_u32 m0, s56, 3072
    s_mov_b32 s59, 107520
    buffer_load_dwordx4 v162, s[20:23], s59 offen lds
    v_mfma_f32_32x32x16_bf16 v[64:79], v[192:195], v[128:131], v[64:79]
    v_dot2_f32_bf16 v152, v16, s54, 0
    v_dot2_f32_bf16 v153, v16, v16, 0
    v_dot2_f32_bf16 v152, v17, s54, v152
    v_mfma_f32_32x32x16_bf16 v[64:79], v[196:199], v[128:131], v[64:79]
    v_dot2_f32_bf16 v153, v17, v17, v153
    v_dot2_f32_bf16 v152, v18, s54, v152
    v_dot2_f32_bf16 v153, v18, v18, v153
    v_mfma_f32_32x32x16_bf16 v[64:79], v[200:203], v[128:131], v[64:79]
    v_dot2_f32_bf16 v152, v19, s54, v152
    v_dot2_f32_bf16 v153, v19, v19, v153
    s_nop 2
    v_permlane32_swap_b32 v152, v153
    v_mfma_f32_32x32x16_bf16 v[64:79], v[204:207], v[128:131], v[64:79]
    v_add_f32 v152, v152, v153
    v_mov_b32 v155, v152
    s_nop 1
    v_permlane16_swap_b32 v152, v155
    v_mfma_f32_32x32x16_bf16 v[64:79], v[208:211], v[128:131], v[64:79]
    v_add_f32 v152, v152, v155
    s_nop 1
    v_add_f32_dpp v152, v152, v152 row_ror:8 row_mask:0xf bank_mask:0xf
    v_mov_b32 v153, v152
    v_mfma_f32_32x32x16_bf16 v[64:79], v[212:215], v[128:131], v[64:79]
    s_nop 0
    v_permlane32_swap_b32 v152, v153
    v_cndmask_b32 v152, 0, v152, s[44:45]
    v_cndmask_b32 v153, 0, v153, s[44:45]
    v_mfma_f32_32x32x16_bf16 v[64:79], v[216:219], v[128:131], v[64:79]
    s_add_u32 s29, s3, 1
    v_mov_b32 v154, s29
    s_add_u32 s29, s35, 0
    s_mov_b64 exec, s[42:43]
    buffer_store_dwordx3 v[152:154], v11, s[4:7], s29 offen
    s_mov_b64 exec, -1
    s_nop 0
    v_dot2_f32_bf16 v152, v20, s54, 0
    v_dot2_f32_bf16 v153, v20, v20, 0
    v_mfma_f32_32x32x16_bf16 v[64:79], v[220:223], v[128:131], v[64:79]
    v_dot2_f32_bf16 v152, v21, s54, v152
    v_dot2_f32_bf16 v153, v21, v21, v153
    v_dot2_f32_bf16 v152, v22, s54, v152
    v_mfma_f32_32x32x16_bf16 v[64:79], v[224:227], v[128:131], v[64:79]
    v_dot2_f32_bf16 v153, v22, v22, v153
    v_dot2_f32_bf16 v152, v23, s54, v152
    v_dot2_f32_bf16 v153, v23, v23, v153
    v_mfma_f32_32x32x16_bf16 v[64:79], v[228:231], v[128:131], v[64:79]
    s_nop 1
    v_permlane32_swap_b32 v152, v153
    v_add_f32 v152, v152, v153
    v_mov_b32 v155, v152
    v_mfma_f32_32x32x16_bf16 v[64:79], v[232:235], v[128:131], v[64:79]
    s_nop 0
    v_permlane16_swap_b32 v152, v155
    v_add_f32 v152, v152, v155
    s_nop 1
    v_add_f32_dpp v152, v152, v152 row_ror:8 row_mask:0xf bank_mask:0xf
    v_mfma_f32_32x32x16_bf16 v[64:79], v[236:239], v[128:131], v[64:79]
    v_mov_b32 v153, v152
    s_nop 1
    v_permlane32_swap_b32 v152, v153
    v_cndmask_b32 v152, 0, v152, s[44:45]
    v_mfma_f32_32x32x16_bf16 v[64:79], v[240:243], v[128:131], v[64:79]
    v_cndmask_b32 v153, 0, v153, s[44:45]
    s_add_u32 s29, s3, 1
    v_mov_b32 v154, s29
    s_add_u32 s29, s35, 8192
    s_mov_b64 exec, s[42:43]
    buffer_store_dwordx3 v[152:154], v11, s[4:7], s29 offen
    s_mov_b64 exec, -1
    s_waitcnt vmcnt(14)
    v_mfma_f32_32x32x16_bf16 v[64:79], v[244:247], v[128:131], v[64:79]
    ds_read_b64_tr_b16 a[0:1], v168 offset:8192
    ds_read_b64_tr_b16 a[2:3], v168 offset:9216
    ds_read_b64_tr_b16 a[4:5], v169 offset:8192
    v_mfma_f32_32x32x16_bf16 v[64:79], v[248:251], v[128:131], v[64:79]
    ds_read_b64_tr_b16 a[6:7], v169 offset:9216
    ds_read_b64_tr_b16 a[8:9], v168 offset:10240
    ds_read_b64_tr_b16 a[10:11], v168 offset:11264
    v_mfma_f32_32x32x16_bf16 v[64:79], v[252:255], v[128:131], v[64:79]
    ds_read_b64_tr_b16 a[12:13], v169 offset:10240
    ds_read_b64_tr_b16 a[14:15], v169 offset:11264
    s_add_u32 m0, s56, 4096
    s_mov_b32 s59, 114688
    buffer_load_dwordx4 v162, s[20:23], s59 offen lds
    v_mfma_f32_32x32x16_bf16 v[64:79], a[224:227], v[128:131], v[64:79]
    s_add_u32 m0, s56, 5120
    s_mov_b32 s59, 121856
    buffer_load_dwordx4 v162, s[20:23], s59 offen lds
    s_add_u32 m0, s56, 6144
    s_mov_b32 s59, 129024
    buffer_load_dwordx4 v162, s[20:23], s59 offen lds
    s_add_u32 m0, s56, 7168
    s_mov_b32 s59, 136192
    buffer_load_dwordx4 v162, s[20:23], s59 offen lds
    v_mfma_f32_32x32x16_bf16 v[64:79], a[228:231], v[128:131], v[64:79]
    v_lshlrev_b32 v159, 3, v0
    v_and_b32 v159, 0xf80, v159
    buffer_load_dword v14, v159, s[4:7], s97 offen sc1
    s_waitcnt vmcnt(15)
    ds_read_b64_tr_b16 a[16:17], v168 offset:12288
    v_mfma_f32_32x32x16_bf16 v[64:79], a[232:235], v[128:131], v[64:79]
    ds_read_b64_tr_b16 a[18:19], v168 offset:13312
    ds_read_b64_tr_b16 a[20:21], v169 offset:12288
    ds_read_b64_tr_b16 a[22:23], v169 offset:13312
    v_mfma_f32_32x32x16_bf16 v[64:79], a[236:239], v[128:131], v[64:79]
    ds_read_b64_tr_b16 a[24:25], v168 offset:14336
    ds_read_b64_tr_b16 a[26:27], v168 offset:15360
    ds_read_b64_tr_b16 a[28:29], v169 offset:14336
    v_mfma_f32_32x32x16_bf16 v[64:79], a[240:243], v[128:131], v[64:79]
    ds_read_b64_tr_b16 a[30:31], v169 offset:15360
    s_waitcnt lgkmcnt(8)
    s_add_u32 m0, s56, 8192
    s_mov_b32 s59, 143360
    buffer_load_dwordx4 v162, s[20:23], s59 offen lds
    v_mfma_f32_32x32x16_bf16 v[64:79], a[244:247], v[128:131], v[64:79]
    s_add_u32 m0, s56, 9216
    s_mov_b32 s59, 150528
    buffer_load_dwordx4 v162, s[20:23], s59 offen lds
    s_add_u32 m0, s56, 10240
    s_mov_b32 s59, 157696
    buffer_load_dwordx4 v162, s[20:23], s59 offen lds
    s_add_u32 m0, s56, 11264
    s_mov_b32 s59, 164864
    buffer_load_dwordx4 v162, s[20:23], s59 offen lds
    v_mfma_f32_32x32x16_bf16 v[64:79], a[248:251], v[128:131], v[64:79]
    s_waitcnt vmcnt(15)
    ds_read_b64_tr_b16 a[32:33], v168 offset:16384
    ds_read_b64_tr_b16 a[34:35], v168 offset:17408
    v_mfma_f32_32x32x16_bf16 v[64:79], a[252:255], v[128:131], v[64:79]
    ds_read_b64_tr_b16 a[36:37], v169 offset:16384
    s_nop 10
    v_mov_b32 v32, v64
    v_mov_b32 v33, v65
    v_mov_b32 v34, v66
    v_mov_b32 v35, v67
    v_mov_b32 v36, v68
    v_mov_b32 v37, v69
    v_mov_b32 v38, v70
    v_mov_b32 v39, v71
    v_mov_b32 v40, v72
    v_mov_b32 v41, v73
    v_mov_b32 v42, v74
    v_mov_b32 v43, v75
    v_mov_b32 v44, v76
    v_mov_b32 v45, v77
    v_mov_b32 v46, v78
    v_mov_b32 v47, v79
    ds_read_b64_tr_b16 a[38:39], v169 offset:17408
    ds_read_b64_tr_b16 a[40:41], v168 offset:18432
    ds_read_b64_tr_b16 a[42:43], v168 offset:19456
    ds_read_b64_tr_b16 a[44:45], v169 offset:18432
    ds_read_b64_tr_b16 a[46:47], v169 offset:19456
    s_waitcnt lgkmcnt(8)
    s_add_u32 m0, s56, 12288
    s_mov_b32 s59, 172032
    buffer_load_dwordx4 v162, s[20:23], s59 offen lds
    s_add_u32 m0, s56, 13312
    s_mov_b32 s59, 179200
    buffer_load_dwordx4 v162, s[20:23], s59 offen lds
    s_add_u32 m0, s56, 14336
    s_mov_b32 s59, 186368
    buffer_load_dwordx4 v162, s[20:23], s59 offen lds
    s_add_u32 m0, s56, 15360
    s_mov_b32 s59, 193536
    buffer_load_dwordx4 v162, s[20:23], s59 offen lds
    s_waitcnt vmcnt(15)
    ds_read_b64_tr_b16 a[48:49], v168 offset:0
    ds_read_b64_tr_b16 a[50:51], v168 offset:1024
    ds_read_b64_tr_b16 a[52:53], v169 offset:0
    ds_read_b64_tr_b16 a[54:55], v169 offset:1024
    ds_read_b64_tr_b16 a[56:57], v168 offset:2048
    ds_read_b64_tr_b16 a[58:59], v168 offset:3072
    ds_read_b64_tr_b16 a[60:61], v169 offset:2048
    ds_read_b64_tr_b16 a[62:63], v169 offset:3072
    s_waitcnt lgkmcnt(8)
    s_add_u32 m0, s56, 16384
    s_mov_b32 s59, 200704
    buffer_load_dwordx4 v162, s[20:23], s59 offen lds
    s_add_u32 m0, s56, 17408
    s_mov_b32 s59, 207872
    buffer_load_dwordx4 v162, s[20:23], s59 offen lds
    s_add_u32 m0, s56, 18432
    s_mov_b32 s59, 215040
    buffer_load_dwordx4 v162, s[20:23], s59 offen lds
    s_add_u32 m0, s56, 19456
    s_mov_b32 s59, 222208
    buffer_load_dwordx4 v162, s[20:23], s59 offen lds
    s_waitcnt vmcnt(12)
    s_add_u32 s40, s3, 1
    v_cmp_ne_u32 vcc, s40, v14
    s_nop 0
    s_and_b64 s[40:41], vcc, exec
    s_cbranch_scc1 Lf_yspin_1
Lf_yback_2:
    s_mov_b32 s29, 0
    buffer_load_dword v24, v58, s[4:7], s29 offen sc1
    s_mov_b32 s29, 8192
    buffer_load_dword v25, v58, s[4:7], s29 offen sc1
    s_mov_b32 s29, 16384
    buffer_load_dword v26, v58, s[4:7], s29 offen sc1
    s_mov_b32 s29, 24576
    buffer_load_dword v27, v58, s[4:7], s29 offen sc1
    s_mov_b32 s29, 256
    buffer_load_dword v28, v58, s[4:7], s29 offen sc1
    s_mov_b32 s29, 8448
    buffer_load_dword v29, v58, s[4:7], s29 offen sc1
    s_mov_b32 s29, 16640
    buffer_load_dword v30, v58, s[4:7], s29 offen sc1
    s_mov_b32 s29, 24832
    buffer_load_dword v31, v58, s[4:7], s29 offen sc1
    s_add_u32 s33, s35, 0
    buffer_load_dwordx3 v[96:98], v2, s[4:7], s33 offen sc1
    s_add_u32 s99, s35, 8192
    buffer_load_dwordx3 v[120:122], v2, s[4:7], s99 offen sc1
    s_waitcnt vmcnt(23)
    ds_read_b64_tr_b16 a[64:65], v168 offset:4096
    ds_read_b64_tr_b16 a[66:67], v168 offset:5120
    ds_read_b64_tr_b16 a[68:69], v169 offset:4096
    ds_read_b64_tr_b16 a[70:71], v169 offset:5120
    ds_read_b64_tr_b16 a[72:73], v168 offset:6144
    ds_read_b64_tr_b16 a[74:75], v168 offset:7168
    ds_read_b64_tr_b16 a[76:77], v169 offset:6144
    ds_read_b64_tr_b16 a[78:79], v169 offset:7168
    s_waitcnt lgkmcnt(8)
    s_add_u32 m0, s56, 0
    s_mov_b32 s59, 229376
    buffer_load_dwordx4 v162, s[20:23], s59 offen lds
    s_add_u32 m0, s56, 1024
    s_mov_b32 s59, 236544
    buffer_load_dwordx4 v162, s[20:23], s59 offen lds
    s_add_u32 m0, s56, 2048
    s_mov_b32 s59, 243712
    buffer_load_dwordx4 v162, s[20:23], s59 offen lds
    s_add_u32 m0, s56, 3072
    s_mov_b32 s59, 250880
    buffer_load_dwordx4 v162, s[20:23], s59 offen lds
    s_waitcnt vmcnt(22)
    ds_read_b64_tr_b16 a[80:81], v168 offset:8192
    ds_read_b64_tr_b16 a[82:83], v168 offset:9216
    ds_read_b64_tr_b16 a[84:85], v169 offset:8192
    ds_read_b64_tr_b16 a[86:87], v169 offset:9216
    ds_read_b64_tr_b16 a[88:89], v168 offset:10240
    ds_read_b64_tr_b16 a[90:91], v168 offset:11264
    ds_read_b64_tr_b16 a[92:93], v169 offset:10240
    ds_read_b64_tr_b16 a[94:95], v169 offset:11264
    s_waitcnt lgkmcnt(8)
    s_add_u32 m0, s56, 4096
    s_mov_b32 s59, 258048
    buffer_load_dwordx4 v162, s[20:23], s59 offen lds
    s_add_u32 m0, s56, 5120
    s_mov_b32 s59, 265216
    buffer_load_dwordx4 v162, s[20:23], s59 offen lds
    s_add_u32 m0, s56, 6144
    s_mov_b32 s59, 272384
    buffer_load_dwordx4 v162, s[20:23], s59 offen lds
    s_add_u32 m0, s56, 7168
    s_mov_b32 s59, 279552
    buffer_load_dwordx4 v162, s[20:23], s59 offen lds
    s_waitcnt vmcnt(14)
    v_lshlrev_b32 v104, 16, v16
    v_and_b32 v105, s46, v16
    v_lshlrev_b32 v112, 16, v24
    v_and_b32 v113, s46, v24
    v_lshlrev_b32 v106, 16, v17
    v_and_b32 v107, s46, v17
    v_lshlrev_b32 v114, 16, v25
    v_and_b32 v115, s46, v25
    v_lshlrev_b32 v108, 16, v18
    v_and_b32 v109, s46, v18
    v_lshlrev_b32 v116, 16, v26
    v_and_b32 v117, s46, v26
    v_lshlrev_b32 v110, 16, v19
    v_and_b32 v111, s46, v19
    v_lshlrev_b32 v118, 16, v27
    v_and_b32 v119, s46, v27
    s_waitcnt vmcnt(9)
    s_add_u32 s40, s3, 1
    v_cmp_eq_u32 vcc, s40, v98
    s_nop 0
    s_andn2_b64 s[40:41], exec, vcc
    s_cbranch_scc1 Lf_sspin_4
Lf_sback_5:
    v_permlane32_swap_b32 v96, v97
    v_add_f32 v96, v96, v97
    v_mov_b32 v99, v96
    s_nop 1
    v_permlane16_swap_b32 v96, v99
    v_add_f32 v96, v96, v99
    s_nop 1
    v_add_f32_dpp v96, v96, v96 row_ror:8 row_mask:0xf bank_mask:0xf
    v_mov_b32 v99, v96
    s_nop 1
    v_permlane32_swap_b32 v96, v99
    v_mul_f32 v100, 0.002232142857142857, v96
    v_mul_f32 v99, 0.002232142857142857, v99
    v_fma_f32 v99, -v100, v100, v99
    v_max_f32 v99, 0, v99
    v_add_f32 v99, 0x3727c5ac, v99
    v_rsq_f32 v101, v99
    s_nop 0
    v_mul_f32 v112, v101, v112
    v_mul_f32 v113, v101, v113
    v_mul_f32 v114, v101, v114
    v_mul_f32 v115, v101, v115
    v_mul_f32 v116, v101, v116
    v_mul_f32 v117, v101, v117
    v_mul_f32 v118, v101, v118
    v_mul_f32 v119, v101, v119
    v_sub_f32 v96, v104, v100
    v_sub_f32 v97, v105, v100
    v_fmac_f32 v104, v96, v112
    v_fmac_f32 v105, v97, v113
    v_sub_f32 v96, v106, v100
    v_sub_f32 v97, v107, v100
    v_fmac_f32 v106, v96, v114
    v_fmac_f32 v107, v97, v115
    v_sub_f32 v96, v108, v100
    v_sub_f32 v97, v109, v100
    v_fmac_f32 v108, v96, v116
    v_fmac_f32 v109, v97, v117
    v_sub_f32 v96, v110, v100
    v_sub_f32 v97, v111, v100
    v_fmac_f32 v110, v96, v118
    v_fmac_f32 v111, v97, v119
    v_cvt_pk_bf16_f32 v16, v104, v105
    v_cvt_pk_bf16_f32 v17, v106, v107
    v_cvt_pk_bf16_f32 v18, v108, v109
    v_cvt_pk_bf16_f32 v19, v110, v111
    s_add_u32 s29, s48, 0
    buffer_store_dwordx4 v[16:19], v4, s[4:7], s29 offen
    v_dot2_f32_bf16 v96, v16, s54, 0
    v_dot2_f32_bf16 v97, v16, v16, 0
    v_dot2_f32_bf16 v96, v17, s54, v96
    v_dot2_f32_bf16 v97, v17, v17, v97
    v_dot2_f32_bf16 v96, v18, s54, v96
    v_dot2_f32_bf16 v97, v18, v18, v97
    v_dot2_f32_bf16 v96, v19, s54, v96
    v_dot2_f32_bf16 v97, v19, v19, v97
    s_nop 2
    v_permlane32_swap_b32 v96, v97
    v_add_f32 v96, v96, v97
    v_mov_b32 v99, v96
    s_nop 1
    v_permlane16_swap_b32 v96, v99
    v_add_f32 v96, v96, v99
    s_nop 1
    v_add_f32_dpp v96, v96, v96 row_ror:8 row_mask:0xf bank_mask:0xf
    v_mov_b32 v97, v96
    s_nop 1
    v_permlane32_swap_b32 v96, v97
    v_cndmask_b32 v96, 0, v96, s[44:45]
    v_cndmask_b32 v97, 0, v97, s[44:45]
    s_add_u32 s29, s52, 131072
    s_mov_b64 exec, s[42:43]
    buffer_store_dwordx2 v[96:97], v3, s[4:7], s29 offen
    s_mov_b64 exec, -1
    s_waitcnt vmcnt(24)
    ds_read_b64_tr_b16 a[96:97], v168 offset:12288
    ds_read_b64_tr_b16 a[98:99], v168 offset:13312
    ds_read_b64_tr_b16 a[100:101], v169 offset:12288
    ds_read_b64_tr_b16 a[102:103], v169 offset:13312
    ds_read_b64_tr_b16 a[104:105], v168 offset:14336
    ds_read_b64_tr_b16 a[106:107], v168 offset:15360
    ds_read_b64_tr_b16 a[108:109], v169 offset:14336
    ds_read_b64_tr_b16 a[110:111], v169 offset:15360
    s_waitcnt lgkmcnt(8)
    s_add_u32 m0, s56, 8192
    s_mov_b32 s59, 286720
    buffer_load_dwordx4 v162, s[20:23], s59 offen lds
    s_add_u32 m0, s56, 9216
    s_mov_b32 s59, 293888
    buffer_load_dwordx4 v162, s[20:23], s59 offen lds
    s_add_u32 m0, s56, 10240
    s_mov_b32 s59, 301056
    buffer_load_dwordx4 v162, s[20:23], s59 offen lds
    s_add_u32 m0, s56, 11264
    s_mov_b32 s59, 308224
    buffer_load_dwordx4 v162, s[20:23], s59 offen lds
    s_waitcnt vmcnt(16)
    v_lshlrev_b32 v128, 16, v20
    v_and_b32 v129, s46, v20
    v_lshlrev_b32 v136, 16, v28
    v_and_b32 v137, s46, v28
    v_lshlrev_b32 v130, 16, v21
    v_and_b32 v131, s46, v21
    v_lshlrev_b32 v138, 16, v29
    v_and_b32 v139, s46, v29
    v_lshlrev_b32 v132, 16, v22
    v_and_b32 v133, s46, v22
    v_lshlrev_b32 v140, 16, v30
    v_and_b32 v141, s46, v30
    v_lshlrev_b32 v134, 16, v23
    v_and_b32 v135, s46, v23
    v_lshlrev_b32 v142, 16, v31
    v_and_b32 v143, s46, v31
    s_waitcnt vmcnt(14)
    s_add_u32 s40, s3, 1
    v_cmp_eq_u32 vcc, s40, v122
    s_nop 0
    s_andn2_b64 s[40:41], exec, vcc
    s_cbranch_scc1 Lf_sspin_7
Lf_sback_8:
    v_permlane32_swap_b32 v120, v121
    v_add_f32 v120, v120, v121
    v_mov_b32 v123, v120
    s_nop 1
    v_permlane16_swap_b32 v120, v123
    v_add_f32 v120, v120, v123
    s_nop 1
    v_add_f32_dpp v120, v120, v120 row_ror:8 row_mask:0xf bank_mask:0xf
    v_mov_b32 v123, v120
    s_nop 1
    v_permlane32_swap_b32 v120, v123
    v_mul_f32 v124, 0.002232142857142857, v120
    v_mul_f32 v123, 0.002232142857142857, v123
    v_fma_f32 v123, -v124, v124, v123
    v_max_f32 v123, 0, v123
    v_add_f32 v123, 0x3727c5ac, v123
    v_rsq_f32 v125, v123
    s_nop 0
    v_mul_f32 v136, v125, v136
    v_mul_f32 v137, v125, v137
    v_mul_f32 v138, v125, v138
    v_mul_f32 v139, v125, v139
    v_mul_f32 v140, v125, v140
    v_mul_f32 v141, v125, v141
    v_mul_f32 v142, v125, v142
    v_mul_f32 v143, v125, v143
    v_sub_f32 v120, v128, v124
    v_sub_f32 v121, v129, v124
    v_fmac_f32 v128, v120, v136
    v_fmac_f32 v129, v121, v137
    v_sub_f32 v120, v130, v124
    v_sub_f32 v121, v131, v124
    v_fmac_f32 v130, v120, v138
    v_fmac_f32 v131, v121, v139
    s_add_u32 s29, s3, 1
    v_mov_b32 v12, s29
    s_waitcnt vmcnt(4)
    buffer_store_dword v12, off, s[4:7], s34
    v_sub_f32 v120, v132, v124
    v_sub_f32 v121, v133, v124
    v_fmac_f32 v132, v120, v140
    v_fmac_f32 v133, v121, v141
    v_sub_f32 v120, v134, v124
    v_sub_f32 v121, v135, v124
    v_fmac_f32 v134, v120, v142
    v_fmac_f32 v135, v121, v143
    v_cvt_pk_bf16_f32 v20, v128, v129
    v_cvt_pk_bf16_f32 v21, v130, v131
    v_cvt_pk_bf16_f32 v22, v132, v133
    v_cvt_pk_bf16_f32 v23, v134, v135
    s_add_u32 s29, s48, 57344
    buffer_store_dwordx4 v[20:23], v4, s[4:7], s29 offen
    v_dot2_f32_bf16 v120, v20, s54, 0
    v_dot2_f32_bf16 v121, v20, v20, 0
    v_dot2_f32_bf16 v120, v21, s54, v120
    v_dot2_f32_bf16 v121, v21, v21, v121
    v_dot2_f32_bf16 v120, v22, s54, v120
    v_dot2_f32_bf16 v121, v22, v22, v121
    v_dot2_f32_bf16 v120, v23, s54, v120
    v_dot2_f32_bf16 v121, v23, v23, v121
    s_nop 2
    v_permlane32_swap_b32 v120, v121
    v_add_f32 v120, v120, v121
    v_mov_b32 v123, v120
    s_nop 1
    v_permlane16_swap_b32 v120, v123
    v_add_f32 v120, v120, v123
    s_nop 1
    v_add_f32_dpp v120, v120, v120 row_ror:8 row_mask:0xf bank_mask:0xf
    v_mov_b32 v121, v120
    s_nop 1
    v_permlane32_swap_b32 v120, v121
    v_cndmask_b32 v120, 0, v120, s[44:45]
    v_cndmask_b32 v121, 0, v121, s[44:45]
    s_add_u32 s29, s52, 135168
    s_mov_b64 exec, s[42:43]
    buffer_store_dwordx2 v[120:121], v3, s[4:7], s29 offen
    s_mov_b64 exec, -1
    s_waitcnt vmcnt(27)
    ds_read_b64_tr_b16 a[112:113], v168 offset:16384
    ds_read_b64_tr_b16 a[114:115], v168 offset:17408
    ds_read_b64_tr_b16 a[116:117], v169 offset:16384
    ds_read_b64_tr_b16 a[118:119], v169 offset:17408
    ds_read_b64_tr_b16 a[120:121], v168 offset:18432
    ds_read_b64_tr_b16 a[122:123], v168 offset:19456
    ds_read_b64_tr_b16 a[124:125], v169 offset:18432
    ds_read_b64_tr_b16 a[126:127], v169 offset:19456
    s_waitcnt lgkmcnt(8)
    s_add_u32 m0, s56, 12288
    s_mov_b32 s59, 315392
    buffer_load_dwordx4 v162, s[20:23], s59 offen lds
    s_add_u32 m0, s56, 13312
    s_mov_b32 s59, 322560
    buffer_load_dwordx4 v162, s[20:23], s59 offen lds
    s_add_u32 m0, s56, 14336
    s_mov_b32 s59, 329728
    buffer_load_dwordx4 v162, s[20:23], s59 offen lds
    s_add_u32 m0, s56, 15360
    s_mov_b32 s59, 336896
    buffer_load_dwordx4 v162, s[20:23], s59 offen lds
    s_add_u32 s29, s3, 2
    v_mov_b32 v12, s29
    s_waitcnt vmcnt(4)
    buffer_store_dword v12, off, s[4:7], s34
    s_waitcnt vmcnt(18)
    ds_read_b64_tr_b16 a[128:129], v168 offset:0
    ds_read_b64_tr_b16 a[130:131], v168 offset:1024
    ds_read_b64_tr_b16 a[132:133], v169 offset:0
    ds_read_b64_tr_b16 a[134:135], v169 offset:1024
    ds_read_b64_tr_b16 a[136:137], v168 offset:2048
    ds_read_b64_tr_b16 a[138:139], v168 offset:3072
    ds_read_b64_tr_b16 a[140:141], v169 offset:2048
    ds_read_b64_tr_b16 a[142:143], v169 offset:3072
    s_waitcnt lgkmcnt(8)
    s_add_u32 m0, s56, 16384
    s_mov_b32 s59, 344064
    buffer_load_dwordx4 v162, s[20:23], s59 offen lds
    s_add_u32 m0, s56, 17408
    s_mov_b32 s59, 351232
    buffer_load_dwordx4 v162, s[20:23], s59 offen lds
    s_add_u32 m0, s56, 18432
    s_mov_b32 s59, 358400
    buffer_load_dwordx4 v162, s[20:23], s59 offen lds
    s_add_u32 m0, s56, 19456
    s_mov_b32 s59, 365568
    buffer_load_dwordx4 v162, s[20:23], s59 offen lds
    s_barrier
    buffer_load_dword v13, v9, s[4:7], 0 offen sc1
    s_waitcnt vmcnt(19)
    ds_read_b64_tr_b16 a[144:145], v168 offset:4096
    ds_read_b64_tr_b16 a[146:147], v168 offset:5120
    ds_read_b64_tr_b16 a[148:149], v169 offset:4096
    ds_read_b64_tr_b16 a[150:151], v169 offset:5120
    ds_read_b64_tr_b16 a[152:153], v168 offset:6144
    ds_read_b64_tr_b16 a[154:155], v168 offset:7168
    ds_read_b64_tr_b16 a[156:157], v169 offset:6144
    ds_read_b64_tr_b16 a[158:159], v169 offset:7168
    s_waitcnt lgkmcnt(8)
    s_add_u32 m0, s56, 0
    s_mov_b32 s59, 372736
    buffer_load_dwordx4 v162, s[20:23], s59 offen lds
    s_add_u32 m0, s56, 1024
    s_mov_b32 s59, 379904
    buffer_load_dwordx4 v162, s[20:23], s59 offen lds
    s_add_u32 m0, s56, 2048
    s_mov_b32 s59, 387072
    buffer_load_dwordx4 v162, s[20:23], s59 offen lds
    s_add_u32 m0, s56, 3072
    s_mov_b32 s59, 394240
    buffer_load_dwordx4 v162, s[20:23], s59 offen lds
    s_waitcnt vmcnt(17)
    ds_read_b64_tr_b16 a[160:161], v168 offset:8192
    ds_read_b64_tr_b16 a[162:163], v168 offset:9216
    ds_read_b64_tr_b16 a[164:165], v169 offset:8192
    ds_read_b64_tr_b16 a[166:167], v169 offset:9216
    ds_read_b64_tr_b16 a[168:169], v168 offset:10240
    ds_read_b64_tr_b16 a[170:171], v168 offset:11264
    ds_read_b64_tr_b16 a[172:173], v169 offset:10240
    ds_read_b64_tr_b16 a[174:175], v169 offset:11264
    s_waitcnt vmcnt(10)
    ds_read_b64_tr_b16 a[176:177], v168 offset:12288
    ds_read_b64_tr_b16 a[178:179], v168 offset:13312
    ds_read_b64_tr_b16 a[180:181], v169 offset:12288
    ds_read_b64_tr_b16 a[182:183], v169 offset:13312
    ds_read_b64_tr_b16 a[184:185], v168 offset:14336
    ds_read_b64_tr_b16 a[186:187], v168 offset:15360
    ds_read_b64_tr_b16 a[188:189], v169 offset:14336
    ds_read_b64_tr_b16 a[190:191], v169 offset:15360
    s_waitcnt vmcnt(4)
    s_add_u32 s40, s3, 1
    v_subrev_u32 v13, s40, v13
    v_cmp_gt_u32 vcc, 16, v13
    s_nop 0
    s_andn2_b64 s[40:41], s[36:37], vcc
    s_cbranch_scc1 Lf_spin_10
Lf_back_11:
    s_add_u32 m0, s53, 0
    s_add_u32 s57, s47, 0
    buffer_load_dwordx4 v0, s[4:7], s57 offen offset:0 sc1 lds
    s_add_u32 m0, s53, 0
    s_nop 0
    buffer_load_dwordx4 v0, s[4:7], s57 offen offset:1024 sc1 lds
    s_add_u32 m0, s53, 0
    s_nop 0
    buffer_load_dwordx4 v0, s[4:7], s57 offen offset:2048 sc1 lds
    s_add_u32 m0, s53, 0
    s_nop 0
    buffer_load_dwordx4 v0, s[4:7], s57 offen offset:3072 sc1 lds
    s_add_u32 m0, s53, 4096
    s_add_u32 s57, s47, 4096
    buffer_load_dwordx4 v0, s[4:7], s57 offen offset:0 sc1 lds
    s_add_u32 m0, s53, 4096
    s_nop 0
    buffer_load_dwordx4 v0, s[4:7], s57 offen offset:1024 sc1 lds
    s_add_u32 m0, s53, 4096
    s_nop 0
    buffer_load_dwordx4 v0, s[4:7], s57 offen offset:2048 sc1 lds
    s_add_u32 s58, s51, 131072
    buffer_load_dwordx4 v[112:115], v5, s[4:7], s58 offen offset:0 sc1
    buffer_load_dwordx4 v[116:119], v5, s[4:7], s58 offen offset:512 sc1
    buffer_load_dwordx4 v[120:123], v5, s[4:7], s58 offen offset:1024 sc1
    buffer_load_dwordx4 v[124:127], v5, s[4:7], s58 offen offset:1536 sc1
    s_waitcnt vmcnt(16)
    ds_read_b64_tr_b16 a[192:193], v168 offset:16384
    ds_read_b64_tr_b16 a[194:195], v168 offset:17408
    ds_read_b64_tr_b16 a[196:197], v169 offset:16384
    ds_read_b64_tr_b16 a[198:199], v169 offset:17408
    ds_read_b64_tr_b16 a[200:201], v168 offset:18432
    ds_read_b64_tr_b16 a[202:203], v168 offset:19456
    ds_read_b64_tr_b16 a[204:205], v169 offset:18432
    ds_read_b64_tr_b16 a[206:207], v169 offset:19456
    s_waitcnt vmcnt(11)
    ds_read_b64_tr_b16 a[208:209], v168 offset:0
    ds_read_b64_tr_b16 a[210:211], v168 offset:1024
    ds_read_b64_tr_b16 a[212:213], v169 offset:0
    ds_read_b64_tr_b16 a[214:215], v169 offset:1024
    ds_read_b64_tr_b16 a[216:217], v168 offset:2048
    ds_read_b64_tr_b16 a[218:219], v168 offset:3072
    ds_read_b64_tr_b16 a[220:221], v169 offset:2048
    ds_read_b64_tr_b16 a[222:223], v169 offset:3072
    s_waitcnt lgkmcnt(0)
    s_barrier
    s_add_u32 m0, s53, 28672
    s_add_u32 s57, s47, 28672
    buffer_load_dwordx4 v0, s[4:7], s57 offen offset:0 sc1 lds
    s_add_u32 m0, s53, 28672
    s_nop 0
    buffer_load_dwordx4 v0, s[4:7], s57 offen offset:1024 sc1 lds
    s_add_u32 m0, s53, 28672
    s_nop 0
    buffer_load_dwordx4 v0, s[4:7], s57 offen offset:2048 sc1 lds
    s_add_u32 m0, s53, 28672
    s_nop 0
    buffer_load_dwordx4 v0, s[4:7], s57 offen offset:3072 sc1 lds
    s_add_u32 m0, s53, 32768
    s_add_u32 s57, s47, 32768
    buffer_load_dwordx4 v0, s[4:7], s57 offen offset:0 sc1 lds
    s_add_u32 m0, s53, 32768
    s_nop 0
    buffer_load_dwordx4 v0, s[4:7], s57 offen offset:1024 sc1 lds
    s_add_u32 m0, s53, 32768
    s_nop 0
    buffer_load_dwordx4 v0, s[4:7], s57 offen offset:2048 sc1 lds
    s_waitcnt vmcnt(11)
    s_barrier
    ds_read_b128 v[128:131], v0 offset:0
    ds_read_b128 v[132:135], v0 offset:1024
    ds_read_b128 v[136:139], v0 offset:2048
    ds_read_b128 v[140:143], v0 offset:3072
    ds_read_b128 v[144:147], v0 offset:4096
    s_waitcnt lgkmcnt(3)
    v_mfma_f32_32x32x16_bf16 v[96:111], v[176:179], v[128:131], 0
    ds_read_b128 v[148:151], v0 offset:5120
    s_waitcnt vmcnt(7)
    v_add_f32 v58, v112, v114
    v_add_f32 v59, v113, v115
    v_add_f32 v60, v116, v118
    v_add_f32 v61, v117, v119
    v_mfma_f32_32x32x16_bf16 v[96:111], v[180:183], v[132:135], v[96:111]
    ds_read_b128 v[128:131], v0 offset:6144
    v_add_f32 v58, v58, v120
    v_add_f32 v59, v59, v121
    v_add_f32 v60, v60, v122
    s_waitcnt lgkmcnt(3)
    v_mfma_f32_32x32x16_bf16 v[96:111], v[184:187], v[136:139], v[96:111]
    ds_read_b128 v[132:135], v0 offset:7168
    v_add_f32 v61, v61, v123
    v_add_f32 v58, v58, v124
    v_add_f32 v59, v59, v125
    v_mfma_f32_32x32x16_bf16 v[96:111], v[188:191], v[140:143], v[96:111]
    ds_read_b128 v[136:139], v0 offset:8192
    v_add_f32 v58, v58, v60
    v_add_f32 v59, v59, v61
    v_mul_f32 v60, 0.002232142857142857, v58
    s_waitcnt lgkmcnt(3)
    v_mfma_f32_32x32x16_bf16 v[96:111], v[192:195], v[144:147], v[96:111]
    ds_read_b128 v[140:143], v0 offset:9216
    v_mul_f32 v59, 0.002232142857142857, v59
    v_fma_f32 v59, -v60, v60, v59
    v_max_f32 v59, 0, v59
    v_mfma_f32_32x32x16_bf16 v[96:111], v[196:199], v[148:151], v[96:111]
    ds_read_b128 v[144:147], v0 offset:10240
    v_add_f32 v59, 0x3727c5ac, v59
    v_rsq_f32 v61, v59
    s_nop 0
    v_mul_f32 v49, 0xbfb8aa3b, v61
    s_waitcnt lgkmcnt(3)
    v_mfma_f32_32x32x16_bf16 v[96:111], v[200:203], v[128:131], v[96:111]
    ds_read_b128 v[148:151], v0 offset:11264
    v_mul_f32 v48, v60, v49
    v_mov_b32 v51, v49
    v_sub_f32 v48, 0, v48
    buffer_load_dword v13, v9, s[4:7], 0 offen sc1
    v_mfma_f32_32x32x16_bf16 v[96:111], v[204:207], v[132:135], v[96:111]
    ds_read_b128 v[128:131], v0 offset:12288
    v_permlane32_swap_b32 v49, v51
    v_mov_b32 v50, v48
    s_nop 1
    v_permlane32_swap_b32 v48, v50
    s_waitcnt lgkmcnt(3)
    v_mfma_f32_32x32x16_bf16 v[96:111], v[208:211], v[136:139], v[96:111]
    ds_read_b128 v[132:135], v0 offset:13312
    v_mfma_f32_32x32x16_bf16 v[96:111], v[212:215], v[140:143], v[96:111]
    ds_read_b128 v[136:139], v0 offset:14336
    s_waitcnt lgkmcnt(3)
    v_mfma_f32_32x32x16_bf16 v[96:111], v[216:219], v[144:147], v[96:111]
    ds_read_b128 v[140:143], v0 offset:15360
    v_mfma_f32_32x32x16_bf16 v[96:111], v[220:223], v[148:151], v[96:111]
    ds_read_b128 v[144:147], v0 offset:16384
    s_waitcnt lgkmcnt(3)
    v_mfma_f32_32x32x16_bf16 v[96:111], v[224:227], v[128:131], v[96:111]
    ds_read_b128 v[148:151], v0 offset:17408
    v_mfma_f32_32x32x16_bf16 v[96:111], v[228:231], v[132:135], v[96:111]
    ds_read_b128 v[128:131], v0 offset:18432
    s_waitcnt lgkmcnt(3)
    v_mfma_f32_32x32x16_bf16 v[96:111], v[232:235], v[136:139], v[96:111]
    ds_read_b128 v[132:135], v0 offset:19456
    v_mfma_f32_32x32x16_bf16 v[96:111], v[236:239], v[140:143], v[96:111]
    ds_read_b128 v[136:139], v0 offset:20480
    s_waitcnt vmcnt(0)
    s_add_u32 s40, s3, 2
    v_subrev_u32 v13, s40, v13
    v_cmp_gt_u32 vcc, 16, v13
    s_nop 0
    s_andn2_b64 s[40:41], s[36:37], vcc
    s_cbranch_scc1 Lf_spin_13
Lf_back_14:
    s_waitcnt lgkmcnt(3)
    v_mfma_f32_32x32x16_bf16 v[96:111], v[240:243], v[144:147], v[96:111]
    ds_read_b128 v[140:143], v0 offset:21504
    v_mfma_f32_32x32x16_bf16 v[96:111], v[244:247], v[148:151], v[96:111]
    ds_read_b128 v[144:147], v0 offset:22528
    s_add_u32 m0, s53, 57344
    s_add_u32 s57, s47, 57344
    buffer_load_dwordx4 v0, s[4:7], s57 offen offset:0 sc1 lds
    s_waitcnt lgkmcnt(3)
    v_mfma_f32_32x32x16_bf16 v[96:111], v[248:251], v[128:131], v[96:111]
    ds_read_b128 v[148:151], v0 offset:23552
    s_add_u32 m0, s53, 57344
    s_nop 0
    buffer_load_dwordx4 v0, s[4:7], s57 offen offset:1024 sc1 lds
    v_mfma_f32_32x32x16_bf16 v[96:111], v[252:255], v[132:135], v[96:111]
    ds_read_b128 v[128:131], v0 offset:24576
    s_waitcnt lgkmcnt(3)
    v_mfma_f32_32x32x16_bf16 v[96:111], a[224:227], v[136:139], v[96:111]
    ds_read_b128 v[132:135], v0 offset:25600
    s_add_u32 m0, s53, 57344
    s_nop 0
    buffer_load_dwordx4 v0, s[4:7], s57 offen offset:2048 sc1 lds
    v_mfma_f32_32x32x16_bf16 v[96:111], a[228:231], v[140:143], v[96:111]
    ds_read_b128 v[136:139], v0 offset:26624
    s_waitcnt lgkmcnt(3)
    v_mfma_f32_32x32x16_bf16 v[96:111], a[232:235], v[144:147], v[96:111]
    ds_read_b128 v[140:143], v0 offset:27648
    s_add_u32 m0, s53, 57344
    s_nop 0
    buffer_load_dwordx4 v0, s[4:7], s57 offen offset:3072 sc1 lds
    v_mfma_f32_32x32x16_bf16 v[96:111], a[236:239], v[148:151], v[96:111]
    s_waitcnt vmcnt(5)
    s_barrier
    ds_read_b128 v[144:147], v0 offset:28672
    s_waitcnt lgkmcnt(3)
    v_mfma_f32_32x32x16_bf16 v[96:111], a[240:243], v[128:131], v[96:111]
    ds_read_b128 v[148:151], v0 offset:29696
    s_add_u32 m0, s53, 61440
    s_add_u32 s57, s47, 61440
    buffer_load_dwordx4 v0, s[4:7], s57 offen offset:0 sc1 lds
    v_mfma_f32_32x32x16_bf16 v[96:111], a[244:247], v[132:135], v[96:111]
    ds_read_b128 v[128:131], v0 offset:30720
    s_waitcnt lgkmcnt(3)
    v_mfma_f32_32x32x16_bf16 v[96:111], a[248:251], v[136:139], v[96:111]
    ds_read_b128 v[132:135], v0 offset:31744
    s_add_u32 m0, s53, 61440
    s_nop 0
    buffer_load_dwordx4 v0, s[4:7], s57 offen offset:1024 sc1 lds
    v_mfma_f32_32x32x16_bf16 v[96:111], a[252:255], v[140:143], v[96:111]
    ds_read_b128 v[136:139], v0 offset:32768
    s_waitcnt lgkmcnt(3)
    v_mfma_f32_32x32x16_bf16 v[112:127], v[176:179], v[144:147], 0
    ds_read_b128 v[140:143], v0 offset:33792
    s_add_u32 m0, s53, 61440
    s_nop 0
    buffer_load_dwordx4 v0, s[4:7], s57 offen offset:2048 sc1 lds
    v_mfma_f32_32x32x16_bf16 v[112:127], v[180:183], v[148:151], v[112:127]
    ds_read_b128 v[144:147], v0 offset:34816
    s_waitcnt lgkmcnt(3)
    v_mfma_f32_32x32x16_bf16 v[112:127], v[184:187], v[128:131], v[112:127]
    ds_read_b128 v[148:151], v0 offset:35840
    s_add_u32 m0, s53, 86016
    s_add_u32 s57, s47, 86016
    buffer_load_dwordx4 v0, s[4:7], s57 offen offset:0 sc1 lds
    v_mfma_f32_32x32x16_bf16 v[112:127], v[188:191], v[132:135], v[112:127]
    ds_read_b128 v[128:131], v0 offset:36864
    v_mul_f32 v152, v48, v32
    v_mul_f32 v153, v48, v33
    v_mul_f32 v154, v48, v34
    v_mul_f32 v155, v48, v35
    v_fma_f32 v96, v49, v96, v152
    s_waitcnt lgkmcnt(3)
    v_mfma_f32_32x32x16_bf16 v[112:127], v[192:195], v[136:139], v[112:127]
    ds_read_b128 v[132:135], v0 offset:37888
    s_add_u32 m0, s53, 86016
    s_nop 0
    buffer_load_dwordx4 v0, s[4:7], s57 offen offset:1024 sc1 lds
    v_fma_f32 v97, v49, v97, v153
    v_fma_f32 v98, v49, v98, v154
    v_fma_f32 v99, v49, v99, v155
    v_exp_f32 v152, v96
    v_mfma_f32_32x32x16_bf16 v[112:127], v[196:199], v[140:143], v[112:127]
    ds_read_b128 v[136:139], v0 offset:38912
    v_exp_f32 v153, v97
    v_exp_f32 v154, v98
    v_exp_f32 v155, v99
    v_add_f32 v152, 1.0, v152
    s_waitcnt lgkmcnt(3)
    v_mfma_f32_32x32x16_bf16 v[112:127], v[200:203], v[144:147], v[112:127]
    ds_read_b128 v[140:143], v0 offset:39936
    s_add_u32 m0, s53, 86016
    s_nop 0
    buffer_load_dwordx4 v0, s[4:7], s57 offen offset:2048 sc1 lds
    v_add_f32 v153, 1.0, v153
    v_add_f32 v154, 1.0, v154
    v_add_f32 v155, 1.0, v155
    v_rcp_f32 v152, v152
    v_mfma_f32_32x32x16_bf16 v[112:127], v[204:207], v[148:151], v[112:127]
    ds_read_b128 v[144:147], v0 offset:40960
    v_rcp_f32 v153, v153
    v_rcp_f32 v154, v154
    v_rcp_f32 v155, v155
    v_mul_f32 v96, v96, v152
    v_mul_f32 v97, v97, v153
    s_waitcnt lgkmcnt(3)
    v_mfma_f32_32x32x16_bf16 v[112:127], v[208:211], v[128:131], v[112:127]
    ds_read_b128 v[148:151], v0 offset:41984
    s_add_u32 m0, s53, 86016
    s_nop 0
    buffer_load_dwordx4 v0, s[4:7], s57 offen offset:3072 sc1 lds
    v_mul_f32 v98, v98, v154
    v_mul_f32 v99, v99, v155
    v_cvt_pk_bf16_f32 v160, v96, v97
    v_cvt_pk_bf16_f32 v161, v98, v99
    v_mfma_f32_32x32x16_bf16 v[112:127], v[212:215], v[132:135], v[112:127]
    ds_read_b128 v[128:131], v0 offset:43008
    v_mul_f32 v152, v48, v36
    v_mul_f32 v153, v48, v37
    v_mul_f32 v154, v48, v38
    v_mul_f32 v155, v48, v39
    s_waitcnt lgkmcnt(3)
    v_mfma_f32_32x32x16_bf16 v[112:127], v[216:219], v[136:139], v[112:127]
    ds_read_b128 v[132:135], v0 offset:44032
    s_add_u32 m0, s53, 90112
    s_add_u32 s57, s47, 90112
    buffer_load_dwordx4 v0, s[4:7], s57 offen offset:0 sc1 lds
    v_fma_f32 v100, v49, v100, v152
    v_fma_f32 v101, v49, v101, v153
    v_fma_f32 v102, v49, v102, v154
    v_fma_f32 v103, v49, v103, v155
    v_mfma_f32_32x32x16_bf16 v[112:127], v[220:223], v[140:143], v[112:127]
    ds_read_b128 v[136:139], v0 offset:45056
    v_exp_f32 v152, v100
    v_exp_f32 v153, v101
    v_exp_f32 v154, v102
    v_exp_f32 v155, v103
    v_add_f32 v152, 1.0, v152
    s_waitcnt lgkmcnt(3)
    v_mfma_f32_32x32x16_bf16 v[112:127], v[224:227], v[144:147], v[112:127]
    ds_read_b128 v[140:143], v0 offset:46080
    s_add_u32 m0, s53, 90112
    s_nop 0
    buffer_load_dwordx4 v0, s[4:7], s57 offen offset:1024 sc1 lds
    v_add_f32 v153, 1.0, v153
    v_add_f32 v154, 1.0, v154
    v_add_f32 v155, 1.0, v155
    v_rcp_f32 v152, v152
    v_mfma_f32_32x32x16_bf16 v[112:127], v[228:231], v[148:151], v[112:127]
    ds_read_b128 v[144:147], v0 offset:47104
    v_rcp_f32 v153, v153
    v_rcp_f32 v154, v154
    v_rcp_f32 v155, v155
    v_mul_f32 v100, v100, v152
    s_waitcnt lgkmcnt(3)
    v_mfma_f32_32x32x16_bf16 v[112:127], v[232:235], v[128:131], v[112:127]
    ds_read_b128 v[148:151], v0 offset:48128
    s_add_u32 m0, s53, 90112
    s_nop 0
    buffer_load_dwordx4 v0, s[4:7], s57 offen offset:2048 sc1 lds
    v_mul_f32 v101, v101, v153
    v_mul_f32 v102, v102, v154
    v_mul_f32 v103, v103, v155
    v_cvt_pk_bf16_f32 v162, v100, v101
    v_mfma_f32_32x32x16_bf16 v[112:127], v[236:239], v[132:135], v[112:127]
    ds_read_b128 v[128:131], v0 offset:49152
    v_cvt_pk_bf16_f32 v163, v102, v103
    s_add_u32 s30, s50, 0
    buffer_store_dwordx4 v[160:163], v0, s[4:7], s30 offen
    v_mul_f32 v152, v48, v40
    v_mul_f32 v153, v48, v41
    v_mul_f32 v154, v48, v42
    s_waitcnt lgkmcnt(3)
    v_mfma_f32_32x32x16_bf16 v[112:127], v[240:243], v[136:139], v[112:127]
    ds_read_b128 v[132:135], v0 offset:50176
    v_mul_f32 v155, v48, v43
    v_fma_f32 v104, v49, v104, v152
    v_fma_f32 v105, v49, v105, v153
    v_fma_f32 v106, v49, v106, v154
    v_mfma_f32_32x32x16_bf16 v[112:127], v[244:247], v[140:143], v[112:127]
    ds_read_b128 v[136:139], v0 offset:51200
    v_fma_f32 v107, v49, v107, v155
    v_exp_f32 v152, v104
    v_exp_f32 v153, v105
    v_exp_f32 v154, v106
    s_waitcnt lgkmcnt(3)
    v_mfma_f32_32x32x16_bf16 v[112:127], v[248:251], v[144:147], v[112:127]
    ds_read_b128 v[140:143], v0 offset:52224
    v_exp_f32 v155, v107
    v_add_f32 v152, 1.0, v152
    v_add_f32 v153, 1.0, v153
    v_add_f32 v154, 1.0, v154
    v_mfma_f32_32x32x16_bf16 v[112:127], v[252:255], v[148:151], v[112:127]
    ds_read_b128 v[144:147], v0 offset:53248
    v_add_f32 v155, 1.0, v155
    v_rcp_f32 v152, v152
    v_rcp_f32 v153, v153
    v_rcp_f32 v154, v154
    v_rcp_f32 v155, v155
    s_waitcnt lgkmcnt(3)
    v_mfma_f32_32x32x16_bf16 v[112:127], a[224:227], v[128:131], v[112:127]
    ds_read_b128 v[148:151], v0 offset:54272
    v_mul_f32 v104, v104, v152
    v_mul_f32 v105, v105, v153
    v_mul_f32 v106, v106, v154
    v_mul_f32 v107, v107, v155
    v_mfma_f32_32x32x16_bf16 v[112:127], a[228:231], v[132:135], v[112:127]
    ds_read_b128 v[128:131], v0 offset:55296
    v_cvt_pk_bf16_f32 v164, v104, v105
    v_cvt_pk_bf16_f32 v165, v106, v107
    v_mul_f32 v152, v48, v44
    v_mul_f32 v153, v48, v45
    s_waitcnt lgkmcnt(3)
    v_mfma_f32_32x32x16_bf16 v[112:127], a[232:235], v[136:139], v[112:127]
    ds_read_b128 v[132:135], v0 offset:56320
    v_mul_f32 v154, v48, v46
    v_mul_f32 v155, v48, v47
    v_fma_f32 v108, v49, v108, v152
    v_fma_f32 v109, v49, v109, v153
    v_mfma_f32_32x32x16_bf16 v[112:127], a[236:239], v[140:143], v[112:127]
    s_waitcnt vmcnt(8)
    s_barrier
    ds_read_b128 v[136:139], v1 offset:0
    v_fma_f32 v110, v49, v110, v154
    v_fma_f32 v111, v49, v111, v155
    v_exp_f32 v152, v108
    v_exp_f32 v153, v109
    v_exp_f32 v154, v110
    s_waitcnt lgkmcnt(3)
    v_mfma_f32_32x32x16_bf16 v[112:127], a[240:243], v[144:147], v[112:127]
    ds_read_b128 v[140:143], v1 offset:1024
    v_exp_f32 v155, v111
    v_add_f32 v152, 1.0, v152
    v_add_f32 v153, 1.0, v153
    v_add_f32 v154, 1.0, v154
    v_mfma_f32_32x32x16_bf16 v[112:127], a[244:247], v[148:151], v[112:127]
    ds_read_b128 v[144:147], v1 offset:2048
    v_add_f32 v155, 1.0, v155
    v_rcp_f32 v152, v152
    v_rcp_f32 v153, v153
    v_rcp_f32 v154, v154
    s_waitcnt lgkmcnt(3)
    v_mfma_f32_32x32x16_bf16 v[112:127], a[248:251], v[128:131], v[112:127]
    ds_read_b128 v[148:151], v1 offset:3072
    v_rcp_f32 v155, v155
    v_mul_f32 v108, v108, v152
    v_mul_f32 v109, v109, v153
    v_mul_f32 v110, v110, v154
    v_mfma_f32_32x32x16_bf16 v[112:127], a[252:255], v[132:135], v[112:127]
    ds_read_b128 v[128:131], v1 offset:4096
    v_mul_f32 v111, v111, v155
    v_cvt_pk_bf16_f32 v166, v108, v109
    v_cvt_pk_bf16_f32 v167, v110, v111
    s_add_u32 s30, s50, 0
    buffer_store_dwordx4 v[164:167], v0, s[4:7], s30 offen offset:1024
    s_waitcnt lgkmcnt(3)
    v_mfma_f32_32x32x16_bf16 v[64:79], v[176:179], v[136:139], 0
    ds_read_b128 v[132:135], v1 offset:5120
    v_mfma_f32_32x32x16_bf16 v[64:79], v[180:183], v[140:143], v[64:79]
    ds_read_b128 v[136:139], v1 offset:6144
    s_waitcnt lgkmcnt(3)
    v_mfma_f32_32x32x16_bf16 v[64:79], v[184:187], v[144:147], v[64:79]
    ds_read_b128 v[140:143], v1 offset:7168
    v_mfma_f32_32x32x16_bf16 v[64:79], v[188:191], v[148:151], v[64:79]
    ds_read_b128 v[144:147], v1 offset:8192
    v_mul_f32 v152, v50, v32
    v_mul_f32 v153, v50, v33
    v_mul_f32 v154, v50, v34
    v_mul_f32 v155, v50, v35
    v_fma_f32 v112, v51, v112, v152
    v_fma_f32 v113, v51, v113, v153
    s_waitcnt lgkmcnt(3)
    v_mfma_f32_32x32x16_bf16 v[64:79], v[192:195], v[128:131], v[64:79]
    ds_read_b128 v[148:151], v1 offset:9216
    v_fma_f32 v114, v51, v114, v154
    v_fma_f32 v115, v51, v115, v155
    v_exp_f32 v152, v112
    v_exp_f32 v153, v113
    v_exp_f32 v154, v114
    v_mfma_f32_32x32x16_bf16 v[64:79], v[196:199], v[132:135], v[64:79]
    ds_read_b128 v[128:131], v1 offset:10240
    v_exp_f32 v155, v115
    v_add_f32 v152, 1.0, v152
    v_add_f32 v153, 1.0, v153
    v_add_f32 v154, 1.0, v154
    v_add_f32 v155, 1.0, v155
    s_waitcnt lgkmcnt(3)
    v_mfma_f32_32x32x16_bf16 v[64:79], v[200:203], v[136:139], v[64:79]
    ds_read_b128 v[132:135], v1 offset:11264
    v_rcp_f32 v152, v152
    v_rcp_f32 v153, v153
    v_rcp_f32 v154, v154
    v_rcp_f32 v155, v155
    v_mul_f32 v112, v112, v152
    v_mul_f32 v113, v113, v153
    v_mfma_f32_32x32x16_bf16 v[64:79], v[204:207], v[140:143], v[64:79]
    ds_read_b128 v[136:139], v1 offset:12288
    v_mul_f32 v114, v114, v154
    v_mul_f32 v115, v115, v155
    v_cvt_pk_bf16_f32 v160, v112, v113
    v_cvt_pk_bf16_f32 v161, v114, v115
    v_mul_f32 v152, v50, v36
    s_waitcnt lgkmcnt(3)
    v_mfma_f32_32x32x16_bf16 v[64:79], v[208:211], v[144:147], v[64:79]
    ds_read_b128 v[140:143], v1 offset:13312
    v_mul_f32 v153, v50, v37
    v_mul_f32 v154, v50, v38
    v_mul_f32 v155, v50, v39
    v_fma_f32 v116, v51, v116, v152
    v_fma_f32 v117, v51, v117, v153
    v_mfma_f32_32x32x16_bf16 v[64:79], v[212:215], v[148:151], v[64:79]
    ds_read_b128 v[144:147], v1 offset:14336
    v_fma_f32 v118, v51, v118, v154
    v_fma_f32 v119, v51, v119, v155
    v_exp_f32 v152, v116
    v_exp_f32 v153, v117
    v_exp_f32 v154, v118
    v_exp_f32 v155, v119
    s_waitcnt lgkmcnt(3)
    v_mfma_f32_32x32x16_bf16 v[64:79], v[216:219], v[128:131], v[64:79]
    ds_read_b128 v[148:151], v1 offset:15360
    v_add_f32 v152, 1.0, v152
    v_add_f32 v153, 1.0, v153
    v_add_f32 v154, 1.0, v154
    v_add_f32 v155, 1.0, v155
    v_rcp_f32 v152, v152
    v_mfma_f32_32x32x16_bf16 v[64:79], v[220:223], v[132:135], v[64:79]
    ds_read_b128 v[128:131], v1 offset:16384
    v_rcp_f32 v153, v153
    v_rcp_f32 v154, v154
    v_rcp_f32 v155, v155
    v_mul_f32 v116, v116, v152
    v_mul_f32 v117, v117, v153
    s_waitcnt lgkmcnt(3)
    v_mfma_f32_32x32x16_bf16 v[64:79], v[224:227], v[136:139], v[64:79]
    ds_read_b128 v[132:135], v1 offset:17408
    v_mul_f32 v118, v118, v154
    v_mul_f32 v119, v119, v155
    v_cvt_pk_bf16_f32 v162, v116, v117
    v_cvt_pk_bf16_f32 v163, v118, v119
    s_add_u32 s30, s50, 114688
    buffer_store_dwordx4 v[160:163], v0, s[4:7], s30 offen
    v_mfma_f32_32x32x16_bf16 v[64:79], v[228:231], v[140:143], v[64:79]
    ds_read_b128 v[136:139], v1 offset:18432
    v_mul_f32 v152, v50, v40
    v_mul_f32 v153, v50, v41
    v_mul_f32 v154, v50, v42
    v_mul_f32 v155, v50, v43
    v_fma_f32 v120, v51, v120, v152
    v_fma_f32 v121, v51, v121, v153
    s_waitcnt lgkmcnt(3)
    v_mfma_f32_32x32x16_bf16 v[64:79], v[232:235], v[144:147], v[64:79]
    ds_read_b128 v[140:143], v1 offset:19456
    s_add_u32 s58, s51, 135168
    buffer_load_dwordx4 v[96:99], v5, s[4:7], s58 offen offset:0 sc1
    buffer_load_dwordx4 v[100:103], v5, s[4:7], s58 offen offset:512 sc1
    buffer_load_dwordx4 v[104:107], v5, s[4:7], s58 offen offset:1024 sc1
    buffer_load_dwordx4 v[108:111], v5, s[4:7], s58 offen offset:1536 sc1
    v_fma_f32 v122, v51, v122, v154
    v_fma_f32 v123, v51, v123, v155
    v_exp_f32 v152, v120
    v_exp_f32 v153, v121
    v_exp_f32 v154, v122
    v_mfma_f32_32x32x16_bf16 v[64:79], v[236:239], v[148:151], v[64:79]
    ds_read_b128 v[144:147], v1 offset:20480
    v_exp_f32 v155, v123
    v_add_f32 v152, 1.0, v152
    v_add_f32 v153, 1.0, v153
    v_add_f32 v154, 1.0, v154
    v_add_f32 v155, 1.0, v155
    s_waitcnt lgkmcnt(3)
    v_mfma_f32_32x32x16_bf16 v[64:79], v[240:243], v[128:131], v[64:79]
    ds_read_b128 v[148:151], v1 offset:21504
    v_rcp_f32 v152, v152
    v_rcp_f32 v153, v153
    v_rcp_f32 v154, v154
    v_rcp_f32 v155, v155
    v_mul_f32 v120, v120, v152
    v_mul_f32 v121, v121, v153
    v_mfma_f32_32x32x16_bf16 v[64:79], v[244:247], v[132:135], v[64:79]
    ds_read_b128 v[128:131], v1 offset:22528
    v_mul_f32 v122, v122, v154
    v_mul_f32 v123, v123, v155
    v_cvt_pk_bf16_f32 v164, v120, v121
    v_cvt_pk_bf16_f32 v165, v122, v123
    v_mul_f32 v152, v50, v44
    s_waitcnt lgkmcnt(3)
    v_mfma_f32_32x32x16_bf16 v[64:79], v[248:251], v[136:139], v[64:79]
    ds_read_b128 v[132:135], v1 offset:23552
    v_mul_f32 v153, v50, v45
    v_mul_f32 v154, v50, v46
    v_mul_f32 v155, v50, v47
    v_fma_f32 v124, v51, v124, v152
    v_fma_f32 v125, v51, v125, v153
    v_mfma_f32_32x32x16_bf16 v[64:79], v[252:255], v[140:143], v[64:79]
    ds_read_b128 v[136:139], v1 offset:24576
    v_fma_f32 v126, v51, v126, v154
    v_fma_f32 v127, v51, v127, v155
    v_exp_f32 v152, v124
    v_exp_f32 v153, v125
    v_exp_f32 v154, v126
    v_exp_f32 v155, v127
    s_waitcnt lgkmcnt(3)
    v_mfma_f32_32x32x16_bf16 v[64:79], a[224:227], v[144:147], v[64:79]
    ds_read_b128 v[140:143], v1 offset:25600
    v_add_f32 v152, 1.0, v152
    v_add_f32 v153, 1.0, v153
    v_add_f32 v154, 1.0, v154
    v_add_f32 v155, 1.0, v155
    v_rcp_f32 v152, v152
    v_mfma_f32_32x32x16_bf16 v[64:79], a[228:231], v[148:151], v[64:79]
    ds_read_b128 v[144:147], v1 offset:26624
    v_rcp_f32 v153, v153
    v_rcp_f32 v154, v154
    v_rcp_f32 v155, v155
    v_mul_f32 v124, v124, v152
    v_mul_f32 v125, v125, v153
    s_waitcnt lgkmcnt(3)
    v_mfma_f32_32x32x16_bf16 v[64:79], a[232:235], v[128:131], v[64:79]
    ds_read_b128 v[148:151], v1 offset:27648
    v_mul_f32 v126, v126, v154
    v_mul_f32 v127, v127, v155
    v_cvt_pk_bf16_f32 v166, v124, v125
    v_cvt_pk_bf16_f32 v167, v126, v127
    s_add_u32 s30, s50, 114688
    buffer_store_dwordx4 v[164:167], v0, s[4:7], s30 offen offset:1024
    v_mfma_f32_32x32x16_bf16 v[64:79], a[236:239], v[132:135], v[64:79]
    s_waitcnt vmcnt(8)
    s_barrier
    ds_read_b128 v[128:131], v1 offset:28672
    s_waitcnt lgkmcnt(3)
    v_mfma_f32_32x32x16_bf16 v[64:79], a[240:243], v[136:139], v[64:79]
    ds_read_b128 v[132:135], v1 offset:29696
    s_waitcnt vmcnt(1)
    v_add_f32 v58, v96, v98
    v_add_f32 v59, v97, v99
    v_add_f32 v60, v100, v102
    v_add_f32 v61, v101, v103
    v_mfma_f32_32x32x16_bf16 v[64:79], a[244:247], v[140:143], v[64:79]
    ds_read_b128 v[136:139], v1 offset:30720
    v_add_f32 v58, v58, v104
    v_add_f32 v59, v59, v105
    v_add_f32 v60, v60, v106
    v_add_f32 v61, v61, v107
    s_waitcnt lgkmcnt(3)
    v_mfma_f32_32x32x16_bf16 v[64:79], a[248:251], v[144:147], v[64:79]
    ds_read_b128 v[140:143], v1 offset:31744
    v_add_f32 v58, v58, v108
    v_add_f32 v59, v59, v109
    v_add_f32 v58, v58, v60
    v_mfma_f32_32x32x16_bf16 v[64:79], a[252:255], v[148:151], v[64:79]
    ds_read_b128 v[144:147], v1 offset:32768
    v_add_f32 v59, v59, v61
    v_mul_f32 v60, 0.002232142857142857, v58
    v_mul_f32 v59, 0.002232142857142857, v59
    v_fma_f32 v59, -v60, v60, v59
    s_waitcnt lgkmcnt(3)
    v_mfma_f32_32x32x16_bf16 v[80:95], v[176:179], v[128:131], 0
    ds_read_b128 v[148:151], v1 offset:33792
    v_max_f32 v59, 0, v59
    v_add_f32 v59, 0x3727c5ac, v59
    v_rsq_f32 v61, v59
    s_add_u32 s29, s3, 3
    v_mov_b32 v12, s29
    s_waitcnt vmcnt(0)
    buffer_store_dword v12, off, s[4:7], s34
    v_mfma_f32_32x32x16_bf16 v[80:95], v[180:183], v[132:135], v[80:95]
    ds_read_b128 v[128:131], v1 offset:34816
    v_mul_f32 v53, 0xbfb8aa3b, v61
    v_mul_f32 v52, v60, v53
    v_mov_b32 v55, v53
    v_sub_f32 v52, 0, v52
    s_waitcnt lgkmcnt(3)
    v_mfma_f32_32x32x16_bf16 v[80:95], v[184:187], v[136:139], v[80:95]
    ds_read_b128 v[132:135], v1 offset:35840
    v_permlane32_swap_b32 v53, v55
    v_mov_b32 v54, v52
    s_nop 1
    v_permlane32_swap_b32 v52, v54
    v_mfma_f32_32x32x16_bf16 v[80:95], v[188:191], v[140:143], v[80:95]
    ds_read_b128 v[136:139], v1 offset:36864
    s_waitcnt lgkmcnt(3)
    v_mfma_f32_32x32x16_bf16 v[80:95], v[192:195], v[144:147], v[80:95]
    ds_read_b128 v[140:143], v1 offset:37888
    v_mul_f32 v152, v52, v32
    v_mul_f32 v153, v52, v33
    v_mul_f32 v154, v52, v34
    v_mul_f32 v155, v52, v35
    v_fma_f32 v64, v53, v64, v152
    v_mfma_f32_32x32x16_bf16 v[80:95], v[196:199], v[148:151], v[80:95]
    ds_read_b128 v[144:147], v1 offset:38912
    v_fma_f32 v65, v53, v65, v153
    v_fma_f32 v66, v53, v66, v154
    v_fma_f32 v67, v53, v67, v155
    v_exp_f32 v152, v64
    s_waitcnt lgkmcnt(3)
    v_mfma_f32_32x32x16_bf16 v[80:95], v[200:203], v[128:131], v[80:95]
    ds_read_b128 v[148:151], v1 offset:39936
    v_exp_f32 v153, v65
    v_exp_f32 v154, v66
    v_exp_f32 v155, v67
    v_add_f32 v152, 1.0, v152
    v_add_f32 v153, 1.0, v153
    v_mfma_f32_32x32x16_bf16 v[80:95], v[204:207], v[132:135], v[80:95]
    ds_read_b128 v[128:131], v1 offset:40960
    v_add_f32 v154, 1.0, v154
    v_add_f32 v155, 1.0, v155
    v_rcp_f32 v152, v152
    v_rcp_f32 v153, v153
    buffer_load_dword v14, v9, s[4:7], 0 offen sc1
    s_waitcnt lgkmcnt(3)
    v_mfma_f32_32x32x16_bf16 v[80:95], v[208:211], v[136:139], v[80:95]
    ds_read_b128 v[132:135], v1 offset:41984
    v_rcp_f32 v154, v154
    v_rcp_f32 v155, v155
    v_mul_f32 v64, v64, v152
    v_mul_f32 v65, v65, v153
    v_mul_f32 v66, v66, v154
    v_mfma_f32_32x32x16_bf16 v[80:95], v[212:215], v[140:143], v[80:95]
    ds_read_b128 v[136:139], v1 offset:43008
    v_mul_f32 v67, v67, v155
    v_cvt_pk_bf16_f32 v160, v64, v65
    v_cvt_pk_bf16_f32 v161, v66, v67
    v_mul_f32 v152, v52, v36
    s_waitcnt lgkmcnt(3)
    v_mfma_f32_32x32x16_bf16 v[80:95], v[216:219], v[144:147], v[80:95]
    ds_read_b128 v[140:143], v1 offset:44032
    v_mul_f32 v153, v52, v37
    v_mul_f32 v154, v52, v38
    v_mul_f32 v155, v52, v39
    v_fma_f32 v68, v53, v68, v152
    v_mfma_f32_32x32x16_bf16 v[80:95], v[220:223], v[148:151], v[80:95]
    ds_read_b128 v[144:147], v1 offset:45056
    v_fma_f32 v69, v53, v69, v153
    v_fma_f32 v70, v53, v70, v154
    v_fma_f32 v71, v53, v71, v155
    v_exp_f32 v152, v68
    v_exp_f32 v153, v69
    s_waitcnt lgkmcnt(3)
    v_mfma_f32_32x32x16_bf16 v[80:95], v[224:227], v[128:131], v[80:95]
    ds_read_b128 v[148:151], v1 offset:46080
    v_exp_f32 v154, v70
    v_exp_f32 v155, v71
    v_add_f32 v152, 1.0, v152
    v_add_f32 v153, 1.0, v153
    v_mfma_f32_32x32x16_bf16 v[80:95], v[228:231], v[132:135], v[80:95]
    ds_read_b128 v[128:131], v1 offset:47104
    v_add_f32 v154, 1.0, v154
    v_add_f32 v155, 1.0, v155
    v_rcp_f32 v152, v152
    v_rcp_f32 v153, v153
    v_rcp_f32 v154, v154
    s_waitcnt lgkmcnt(3)
    v_mfma_f32_32x32x16_bf16 v[80:95], v[232:235], v[136:139], v[80:95]
    ds_read_b128 v[132:135], v1 offset:48128
    v_rcp_f32 v155, v155
    v_mul_f32 v68, v68, v152
    v_mul_f32 v69, v69, v153
    v_mul_f32 v70, v70, v154
    v_mfma_f32_32x32x16_bf16 v[80:95], v[236:239], v[140:143], v[80:95]
    ds_read_b128 v[136:139], v1 offset:49152
    v_mul_f32 v71, v71, v155
    v_cvt_pk_bf16_f32 v162, v68, v69
    v_cvt_pk_bf16_f32 v163, v70, v71
    s_add_u32 s30, s50, 229376
    buffer_store_dwordx4 v[160:163], v0, s[4:7], s30 offen
    s_waitcnt vmcnt(1)
    s_add_u32 s40, s3, 3
    v_subrev_u32 v14, s40, v14
    v_cmp_gt_u32 vcc, 16, v14
    s_nop 0
    s_andn2_b64 s[40:41], s[38:39], vcc
    s_cbranch_scc1 Lf_spin_16
Lf_back_17:
    s_add_u32 s60, s49, 0
    buffer_load_dwordx4 v[168:171], v0, s[4:7], s60 offen offset:0 sc1
    s_waitcnt lgkmcnt(3)
    v_mfma_f32_32x32x16_bf16 v[80:95], v[240:243], v[144:147], v[80:95]
    ds_read_b128 v[140:143], v1 offset:50176
    v_mul_f32 v152, v52, v40
    v_mul_f32 v153, v52, v41
    v_mul_f32 v154, v52, v42
    v_mul_f32 v155, v52, v43
    v_fma_f32 v72, v53, v72, v152
    buffer_load_dwordx4 v[172:175], v0, s[4:7], s60 offen offset:1024 sc1
    v_mfma_f32_32x32x16_bf16 v[80:95], v[244:247], v[148:151], v[80:95]
    ds_read_b128 v[144:147], v1 offset:51200
    v_fma_f32 v73, v53, v73, v153
    v_fma_f32 v74, v53, v74, v154
    v_fma_f32 v75, v53, v75, v155
    v_exp_f32 v152, v72
    s_waitcnt lgkmcnt(3)
    v_mfma_f32_32x32x16_bf16 v[80:95], v[248:251], v[128:131], v[80:95]
    ds_read_b128 v[148:151], v1 offset:52224
    v_exp_f32 v153, v73
    v_exp_f32 v154, v74
    v_exp_f32 v155, v75
    v_add_f32 v152, 1.0, v152
    v_add_f32 v153, 1.0, v153
    buffer_load_dwordx4 v[156:159], v0, s[4:7], s60 offen offset:2048 sc1
    v_mfma_f32_32x32x16_bf16 v[80:95], v[252:255], v[132:135], v[80:95]
    ds_read_b128 v[128:131], v1 offset:53248
    v_add_f32 v154, 1.0, v154
    v_add_f32 v155, 1.0, v155
    v_rcp_f32 v152, v152
    v_rcp_f32 v153, v153
    s_waitcnt lgkmcnt(3)
    v_mfma_f32_32x32x16_bf16 v[80:95], a[224:227], v[136:139], v[80:95]
    ds_read_b128 v[132:135], v1 offset:54272
    v_rcp_f32 v154, v154
    v_rcp_f32 v155, v155
    v_mul_f32 v72, v72, v152
    v_mul_f32 v73, v73, v153
    v_mul_f32 v74, v74, v154
    v_mfma_f32_32x32x16_bf16 v[80:95], a[228:231], v[140:143], v[80:95]
    ds_read_b128 v[136:139], v1 offset:55296
    v_mul_f32 v75, v75, v155
    v_cvt_pk_bf16_f32 v164, v72, v73
    v_cvt_pk_bf16_f32 v165, v74, v75
    v_mul_f32 v152, v52, v44
    s_waitcnt lgkmcnt(3)
    v_mfma_f32_32x32x16_bf16 v[80:95], a[232:235], v[144:147], v[80:95]
    ds_read_b128 v[140:143], v1 offset:56320
    v_mul_f32 v153, v52, v45
    v_mul_f32 v154, v52, v46
    v_mul_f32 v155, v52, v47
    v_fma_f32 v76, v53, v76, v152
    buffer_load_dwordx4 v[144:147], v0, s[4:7], s60 offen offset:3072 sc1
    v_mfma_f32_32x32x16_bf16 v[80:95], a[236:239], v[148:151], v[80:95]
    v_fma_f32 v77, v53, v77, v153
    v_fma_f32 v78, v53, v78, v154
    v_fma_f32 v79, v53, v79, v155
    v_exp_f32 v152, v76
    v_exp_f32 v153, v77
    s_add_u32 s60, s49, 4096
    buffer_load_dwordx4 v[148:151], v0, s[4:7], s60 offen offset:0 sc1
    s_waitcnt lgkmcnt(2)
    v_mfma_f32_32x32x16_bf16 v[80:95], a[240:243], v[128:131], v[80:95]
    v_exp_f32 v154, v78
    v_exp_f32 v155, v79
    v_add_f32 v152, 1.0, v152
    v_add_f32 v153, 1.0, v153
    buffer_load_dwordx4 v[128:131], v0, s[4:7], s60 offen offset:1024 sc1
    v_mfma_f32_32x32x16_bf16 v[80:95], a[244:247], v[132:135], v[80:95]
    v_add_f32 v154, 1.0, v154
    v_add_f32 v155, 1.0, v155
    v_rcp_f32 v152, v152
    v_rcp_f32 v153, v153
    v_rcp_f32 v154, v154
    s_waitcnt lgkmcnt(0)
    v_mfma_f32_32x32x16_bf16 v[80:95], a[248:251], v[136:139], v[80:95]
    v_rcp_f32 v155, v155
    v_mul_f32 v76, v76, v152
    v_mul_f32 v77, v77, v153
    v_mul_f32 v78, v78, v154
    buffer_load_dwordx4 v[132:135], v0, s[4:7], s60 offen offset:2048 sc1
    v_mfma_f32_32x32x16_bf16 v[80:95], a[252:255], v[140:143], v[80:95]
    v_mul_f32 v79, v79, v155
    v_cvt_pk_bf16_f32 v166, v76, v77
    v_cvt_pk_bf16_f32 v167, v78, v79
    s_add_u32 s30, s50, 229376
    buffer_store_dwordx4 v[164:167], v0, s[4:7], s30 offen offset:1024
    s_waitcnt vmcnt(7)
    v_mfma_f32_32x32x16_bf16 v[96:111], a[0:3], v[168:171], 0
    buffer_load_dwordx4 v[136:139], v0, s[4:7], s60 offen offset:3072 sc1
    v_mfma_f32_32x32x16_bf16 v[112:127], a[4:7], v[168:171], 0
    v_mul_f32 v152, v54, v32
    v_mul_f32 v153, v54, v33
    v_mul_f32 v154, v54, v34
    v_mul_f32 v155, v54, v35
    v_fma_f32 v80, v55, v80, v152
    v_fma_f32 v81, v55, v81, v153
    v_fma_f32 v82, v55, v82, v154
    v_fma_f32 v83, v55, v83, v155
    v_exp_f32 v152, v80
    s_waitcnt vmcnt(7)
    v_mfma_f32_32x32x16_bf16 v[96:111], a[8:11], v[172:175], v[96:111]
    v_exp_f32 v153, v81
    v_exp_f32 v154, v82
    v_exp_f32 v155, v83
    v_add_f32 v152, 1.0, v152
    v_add_f32 v153, 1.0, v153
    v_add_f32 v154, 1.0, v154
    v_add_f32 v155, 1.0, v155
    v_rcp_f32 v152, v152
    s_add_u32 s60, s49, 8192
    buffer_load_dwordx4 v[140:143], v0, s[4:7], s60 offen offset:0 sc1
    v_mfma_f32_32x32x16_bf16 v[112:127], a[12:15], v[172:175], v[112:127]
    v_rcp_f32 v153, v153
    v_rcp_f32 v154, v154
    v_rcp_f32 v155, v155
    v_mul_f32 v80, v80, v152
    v_mul_f32 v81, v81, v153
    v_mul_f32 v82, v82, v154
    v_mul_f32 v83, v83, v155
    v_cvt_pk_bf16_f32 v160, v80, v81
    s_waitcnt vmcnt(7)
    v_mfma_f32_32x32x16_bf16 v[96:111], a[16:19], v[156:159], v[96:111]
    v_cvt_pk_bf16_f32 v161, v82, v83
    v_mul_f32 v152, v54, v36
    v_mul_f32 v153, v54, v37
    v_mul_f32 v154, v54, v38
    v_mul_f32 v155, v54, v39
    v_fma_f32 v84, v55, v84, v152
    v_fma_f32 v85, v55, v85, v153
    v_fma_f32 v86, v55, v86, v154
    buffer_load_dwordx4 v[168:171], v0, s[4:7], s60 offen offset:1024 sc1
    v_mfma_f32_32x32x16_bf16 v[112:127], a[20:23], v[156:159], v[112:127]
    v_fma_f32 v87, v55, v87, v155
    v_exp_f32 v152, v84
    v_exp_f32 v153, v85
    v_exp_f32 v154, v86
    v_exp_f32 v155, v87
    v_add_f32 v152, 1.0, v152
    v_add_f32 v153, 1.0, v153
    v_add_f32 v154, 1.0, v154
    s_waitcnt vmcnt(7)
    v_mfma_f32_32x32x16_bf16 v[96:111], a[24:27], v[144:147], v[96:111]
    v_add_f32 v155, 1.0, v155
    v_rcp_f32 v152, v152
    v_rcp_f32 v153, v153
    v_rcp_f32 v154, v154
    v_rcp_f32 v155, v155
    v_mul_f32 v84, v84, v152
    v_mul_f32 v85, v85, v153
    v_mul_f32 v86, v86, v154
    buffer_load_dwordx4 v[172:175], v0, s[4:7], s60 offen offset:2048 sc1
    v_mfma_f32_32x32x16_bf16 v[112:127], a[28:31], v[144:147], v[112:127]
    v_mul_f32 v87, v87, v155
    v_cvt_pk_bf16_f32 v162, v84, v85
    v_cvt_pk_bf16_f32 v163, v86, v87
    s_add_u32 s30, s50, 344064
    buffer_store_dwordx4 v[160:163], v0, s[4:7], s30 offen
    v_mul_f32 v152, v54, v40
    v_mul_f32 v153, v54, v41
    v_mul_f32 v154, v54, v42
    v_mul_f32 v155, v54, v43
    v_fma_f32 v88, v55, v88, v152
    s_waitcnt vmcnt(8)
    v_mfma_f32_32x32x16_bf16 v[96:111], a[32:35], v[148:151], v[96:111]
    v_fma_f32 v89, v55, v89, v153
    v_fma_f32 v90, v55, v90, v154
    v_fma_f32 v91, v55, v91, v155
    v_exp_f32 v152, v88
    v_exp_f32 v153, v89
    v_exp_f32 v154, v90
    v_exp_f32 v155, v91
    v_add_f32 v152, 1.0, v152
    buffer_load_dwordx4 v[144:147], v0, s[4:7], s60 offen offset:3072 sc1
    v_mfma_f32_32x32x16_bf16 v[112:127], a[36:39], v[148:151], v[112:127]
    v_add_f32 v153, 1.0, v153
    v_add_f32 v154, 1.0, v154
    v_add_f32 v155, 1.0, v155
    v_rcp_f32 v152, v152
    v_rcp_f32 v153, v153
    v_rcp_f32 v154, v154
    v_rcp_f32 v155, v155
    v_mul_f32 v88, v88, v152
    s_waitcnt vmcnt(8)
    v_mfma_f32_32x32x16_bf16 v[96:111], a[40:43], v[128:131], v[96:111]
    v_mul_f32 v89, v89, v153
    v_mul_f32 v90, v90, v154
    v_mul_f32 v91, v91, v155
    v_cvt_pk_bf16_f32 v164, v88, v89
    v_cvt_pk_bf16_f32 v165, v90, v91
    v_mul_f32 v152, v54, v44
    v_mul_f32 v153, v54, v45
    v_mul_f32 v154, v54, v46
    s_add_u32 s60, s49, 12288
    buffer_load_dwordx4 v[148:151], v0, s[4:7], s60 offen offset:0 sc1
    v_mfma_f32_32x32x16_bf16 v[112:127], a[44:47], v[128:131], v[112:127]
    v_mul_f32 v155, v54, v47
    v_fma_f32 v92, v55, v92, v152
    v_fma_f32 v93, v55, v93, v153
    v_fma_f32 v94, v55, v94, v154
    v_fma_f32 v95, v55, v95, v155
    v_exp_f32 v152, v92
    v_exp_f32 v153, v93
    v_exp_f32 v154, v94
    s_waitcnt vmcnt(8)
    v_mfma_f32_32x32x16_bf16 v[96:111], a[48:51], v[132:135], v[96:111]
    v_exp_f32 v155, v95
    v_add_f32 v152, 1.0, v152
    v_add_f32 v153, 1.0, v153
    v_add_f32 v154, 1.0, v154
    v_add_f32 v155, 1.0, v155
    v_rcp_f32 v152, v152
    v_rcp_f32 v153, v153
    v_rcp_f32 v154, v154
    buffer_load_dwordx4 v[128:131], v0, s[4:7], s60 offen offset:1024 sc1
    v_mfma_f32_32x32x16_bf16 v[112:127], a[52:55], v[132:135], v[112:127]
    v_rcp_f32 v155, v155
    v_mul_f32 v92, v92, v152
    v_mul_f32 v93, v93, v153
    v_mul_f32 v94, v94, v154
    v_mul_f32 v95, v95, v155
    v_cvt_pk_bf16_f32 v166, v92, v93
    v_cvt_pk_bf16_f32 v167, v94, v95
    s_add_u32 s30, s50, 344064
    buffer_store_dwordx4 v[164:167], v0, s[4:7], s30 offen offset:1024
    s_waitcnt vmcnt(8)
    v_mfma_f32_32x32x16_bf16 v[96:111], a[56:59], v[136:139], v[96:111]
    buffer_load_dwordx4 v[132:135], v0, s[4:7], s60 offen offset:2048 sc1
    v_mfma_f32_32x32x16_bf16 v[112:127], a[60:63], v[136:139], v[112:127]
    s_waitcnt vmcnt(8)
    v_mfma_f32_32x32x16_bf16 v[96:111], a[64:67], v[140:143], v[96:111]
    buffer_load_dwordx4 v[136:139], v0, s[4:7], s60 offen offset:3072 sc1
    v_mfma_f32_32x32x16_bf16 v[112:127], a[68:71], v[140:143], v[112:127]
    s_waitcnt vmcnt(8)
    v_mfma_f32_32x32x16_bf16 v[96:111], a[72:75], v[168:171], v[96:111]
    s_add_u32 s60, s49, 16384
    buffer_load_dwordx4 v[140:143], v0, s[4:7], s60 offen offset:0 sc1
    v_mfma_f32_32x32x16_bf16 v[112:127], a[76:79], v[168:171], v[112:127]
    s_waitcnt vmcnt(8)
    v_mfma_f32_32x32x16_bf16 v[96:111], a[80:83], v[172:175], v[96:111]
    s_add_u32 s29, s3, 4
    v_mov_b32 v12, s29
    s_waitcnt vmcnt(3)
    buffer_store_dword v12, off, s[4:7], s34
    buffer_load_dwordx4 v[168:171], v0, s[4:7], s60 offen offset:1024 sc1
    v_mfma_f32_32x32x16_bf16 v[112:127], a[84:87], v[172:175], v[112:127]
    s_waitcnt vmcnt(8)
    v_mfma_f32_32x32x16_bf16 v[96:111], a[88:91], v[144:147], v[96:111]
    buffer_load_dwordx4 v[172:175], v0, s[4:7], s60 offen offset:2048 sc1
    v_mfma_f32_32x32x16_bf16 v[112:127], a[92:95], v[144:147], v[112:127]
    s_waitcnt vmcnt(8)
    v_mfma_f32_32x32x16_bf16 v[96:111], a[96:99], v[148:151], v[96:111]
    buffer_load_dwordx4 v[144:147], v0, s[4:7], s60 offen offset:3072 sc1
    v_mfma_f32_32x32x16_bf16 v[112:127], a[100:103], v[148:151], v[112:127]
    s_waitcnt vmcnt(8)
    v_mfma_f32_32x32x16_bf16 v[96:111], a[104:107], v[128:131], v[96:111]
    s_add_u32 s60, s49, 20480
    buffer_load_dwordx4 v[148:151], v0, s[4:7], s60 offen offset:0 sc1
    v_mfma_f32_32x32x16_bf16 v[112:127], a[108:111], v[128:131], v[112:127]
    s_waitcnt vmcnt(7)
    v_mfma_f32_32x32x16_bf16 v[96:111], a[112:115], v[132:135], v[96:111]
    buffer_load_dwordx4 v[128:131], v0, s[4:7], s60 offen offset:1024 sc1
    v_mfma_f32_32x32x16_bf16 v[112:127], a[116:119], v[132:135], v[112:127]
    s_waitcnt vmcnt(7)
    v_mfma_f32_32x32x16_bf16 v[96:111], a[120:123], v[136:139], v[96:111]
    buffer_load_dwordx4 v[132:135], v0, s[4:7], s60 offen offset:2048 sc1
    v_mfma_f32_32x32x16_bf16 v[112:127], a[124:127], v[136:139], v[112:127]
    buffer_load_dwordx4 v[136:139], v0, s[4:7], s60 offen offset:3072 sc1
    s_waitcnt vmcnt(8)
    v_mfma_f32_32x32x16_bf16 v[96:111], a[128:131], v[140:143], v[96:111]
    s_add_u32 s60, s49, 24576
    buffer_load_dwordx4 v[156:159], v0, s[4:7], s60 offen offset:0 sc1
    v_mfma_f32_32x32x16_bf16 v[112:127], a[132:135], v[140:143], v[112:127]
    buffer_load_dwordx4 v[140:143], v0, s[4:7], s60 offen offset:1024 sc1
    s_waitcnt vmcnt(8)
    v_mfma_f32_32x32x16_bf16 v[96:111], a[136:139], v[168:171], v[96:111]
    buffer_load_dwordx4 v[64:67], v0, s[4:7], s60 offen offset:2048 sc1
    v_mfma_f32_32x32x16_bf16 v[112:127], a[140:143], v[168:171], v[112:127]
    buffer_load_dwordx4 v[168:171], v0, s[4:7], s60 offen offset:3072 sc1
    s_waitcnt vmcnt(9)
    v_mfma_f32_32x32x16_bf16 v[96:111], a[144:147], v[172:175], v[96:111]
    buffer_load_dword v15, v9, s[4:7], 0 offen sc1
    v_mfma_f32_32x32x16_bf16 v[112:127], a[148:151], v[172:175], v[112:127]
    s_waitcnt vmcnt(9)
    v_mfma_f32_32x32x16_bf16 v[96:111], a[152:155], v[144:147], v[96:111]
    v_mfma_f32_32x32x16_bf16 v[112:127], a[156:159], v[144:147], v[112:127]
    s_waitcnt vmcnt(8)
    v_mfma_f32_32x32x16_bf16 v[96:111], a[160:163], v[148:151], v[96:111]
    v_mfma_f32_32x32x16_bf16 v[112:127], a[164:167], v[148:151], v[112:127]
    s_waitcnt vmcnt(7)
    v_mfma_f32_32x32x16_bf16 v[96:111], a[168:171], v[128:131], v[96:111]
    v_mfma_f32_32x32x16_bf16 v[112:127], a[172:175], v[128:131], v[112:127]
    s_waitcnt vmcnt(6)
    v_mfma_f32_32x32x16_bf16 v[96:111], a[176:179], v[132:135], v[96:111]
    s_waitcnt vmcnt(5)
    v_mfma_f32_32x32x16_bf16 v[96:111], a[184:187], v[136:139], v[96:111]
    s_waitcnt vmcnt(0)
    s_add_u32 s40, s3, 4
    v_subrev_u32 v15, s40, v15
    v_cmp_gt_u32 vcc, 16, v15
    s_nop 0
    s_andn2_b64 s[40:41], s[38:39], vcc
    s_cbranch_scc1 Lf_spin_19
Lf_back_20:
    s_add_u32 s60, s49, 229376
    buffer_load_dwordx4 v[128:131], v0, s[4:7], s60 offen offset:0 sc1
    buffer_load_dwordx4 v[144:147], v0, s[4:7], s60 offen offset:1024 sc1
    s_waitcnt vmcnt(6)
    v_mfma_f32_32x32x16_bf16 v[96:111], a[192:195], v[156:159], v[96:111]
    buffer_load_dwordx4 v[148:151], v0, s[4:7], s60 offen offset:2048 sc1
    s_waitcnt vmcnt(6)
    v_mfma_f32_32x32x16_bf16 v[96:111], a[200:203], v[140:143], v[96:111]
    s_waitcnt vmcnt(5)
    v_mfma_f32_32x32x16_bf16 v[96:111], a[208:211], v[64:67], v[96:111]
    buffer_load_dwordx4 v[172:175], v0, s[4:7], s60 offen offset:3072 sc1
    s_waitcnt vmcnt(5)
    v_mfma_f32_32x32x16_bf16 v[96:111], a[216:219], v[168:171], v[96:111]
    v_mfma_f32_32x32x16_bf16 v[112:127], a[180:183], v[132:135], v[112:127]
    s_add_u32 s60, s49, 233472
    buffer_load_dwordx4 v[132:135], v0, s[4:7], s60 offen offset:0 sc1
    v_mfma_f32_32x32x16_bf16 v[112:127], a[188:191], v[136:139], v[112:127]
    v_mfma_f32_32x32x16_bf16 v[112:127], a[196:199], v[156:159], v[112:127]
    buffer_load_dwordx4 v[136:139], v0, s[4:7], s60 offen offset:1024 sc1
    v_xor_b32 v58, 0, v6
    s_nop 4
    ds_write_b128 v58, v[96:99]
    v_mfma_f32_32x32x16_bf16 v[112:127], a[204:207], v[140:143], v[112:127]
    v_xor_b32 v59, 32, v6
    ds_write_b128 v59, v[100:103]
    v_mfma_f32_32x32x16_bf16 v[112:127], a[212:215], v[64:67], v[112:127]
    buffer_load_dwordx4 v[140:143], v0, s[4:7], s60 offen offset:2048 sc1
    v_xor_b32 v58, 64, v6
    ds_write_b128 v58, v[104:107]
    v_mfma_f32_32x32x16_bf16 v[112:127], a[220:223], v[168:171], v[112:127]
    v_xor_b32 v59, 96, v6
    ds_write_b128 v59, v[108:111]
    s_waitcnt vmcnt(6)
    v_mfma_f32_32x32x16_bf16 v[64:79], a[0:3], v[128:131], 0
    buffer_load_dwordx4 v[168:171], v0, s[4:7], s60 offen offset:3072 sc1
    v_mfma_f32_32x32x16_bf16 v[80:95], a[4:7], v[128:131], 0
    s_waitcnt vmcnt(6)
    v_mfma_f32_32x32x16_bf16 v[64:79], a[8:11], v[144:147], v[64:79]
    s_add_u32 s60, s49, 237568
    buffer_load_dwordx4 v[128:131], v0, s[4:7], s60 offen offset:0 sc1
    v_mfma_f32_32x32x16_bf16 v[80:95], a[12:15], v[144:147], v[80:95]
    v_xor_b32 v58, 128, v6
    s_nop 1
    ds_write_b128 v58, v[112:115]
    v_xor_b32 v59, 160, v6
    ds_write_b128 v59, v[116:119]
    s_waitcnt vmcnt(6)
    v_mfma_f32_32x32x16_bf16 v[64:79], a[16:19], v[148:151], v[64:79]
    buffer_load_dwordx4 v[144:147], v0, s[4:7], s60 offen offset:1024 sc1
    v_xor_b32 v58, 192, v6
    ds_write_b128 v58, v[120:123]
    v_mfma_f32_32x32x16_bf16 v[80:95], a[20:23], v[148:151], v[80:95]
    v_xor_b32 v59, 224, v6
    ds_write_b128 v59, v[124:127]
    s_waitcnt vmcnt(6)
    v_mfma_f32_32x32x16_bf16 v[64:79], a[24:27], v[172:175], v[64:79]
    buffer_load_dwordx4 v[148:151], v0, s[4:7], s60 offen offset:2048 sc1
    v_mfma_f32_32x32x16_bf16 v[80:95], a[28:31], v[172:175], v[80:95]
    s_waitcnt vmcnt(6)
    v_mfma_f32_32x32x16_bf16 v[64:79], a[32:35], v[132:135], v[64:79]
    buffer_load_dwordx4 v[172:175], v0, s[4:7], s60 offen offset:3072 sc1
    v_mfma_f32_32x32x16_bf16 v[80:95], a[36:39], v[132:135], v[80:95]
    s_waitcnt vmcnt(6)
    v_mfma_f32_32x32x16_bf16 v[64:79], a[40:43], v[136:139], v[64:79]
    s_add_u32 s60, s49, 241664
    buffer_load_dwordx4 v[132:135], v0, s[4:7], s60 offen offset:0 sc1
    v_mfma_f32_32x32x16_bf16 v[80:95], a[44:47], v[136:139], v[80:95]
    s_waitcnt lgkmcnt(0)
    s_barrier
    v_xor_b32 v58, 16, v7
    ds_read_b128 v[96:99], v7 offset:0
    ds_read_b128 v[100:103], v58 offset:0
    ds_read_b128 v[104:107], v7 offset:8192
    s_waitcnt vmcnt(6)
    v_mfma_f32_32x32x16_bf16 v[64:79], a[48:51], v[140:143], v[64:79]
    buffer_load_dwordx4 v[136:139], v0, s[4:7], s60 offen offset:1024 sc1
    ds_read_b128 v[108:111], v58 offset:8192
    ds_read_b128 v[112:115], v7 offset:16384
    ds_read_b128 v[116:119], v58 offset:16384
    ds_read_b128 v[120:123], v7 offset:24576
    ds_read_b128 v[124:127], v58 offset:24576
    v_mfma_f32_32x32x16_bf16 v[80:95], a[52:55], v[140:143], v[80:95]
    s_waitcnt vmcnt(6)
    v_mfma_f32_32x32x16_bf16 v[64:79], a[56:59], v[168:171], v[64:79]
    buffer_load_dwordx4 v[140:143], v0, s[4:7], s60 offen offset:2048 sc1
    v_lshlrev_b32 v160, 16, v16
    v_and_b32 v161, s46, v16
    v_lshlrev_b32 v162, 16, v17
    v_and_b32 v163, s46, v17
    v_lshlrev_b32 v164, 16, v18
    v_and_b32 v165, s46, v18
    v_lshlrev_b32 v166, 16, v19
    v_and_b32 v167, s46, v19
    s_waitcnt lgkmcnt(4)
    v_add_f32 v96, v96, v104
    v_mfma_f32_32x32x16_bf16 v[80:95], a[60:63], v[168:171], v[80:95]
    v_add_f32 v97, v97, v105
    v_add_f32 v98, v98, v106
    v_add_f32 v99, v99, v107
    v_add_f32 v100, v100, v108
    v_add_f32 v101, v101, v109
    v_add_f32 v102, v102, v110
    v_add_f32 v103, v103, v111
    s_waitcnt lgkmcnt(0)
    v_add_f32 v112, v112, v120
    v_add_f32 v113, v113, v121
    s_waitcnt vmcnt(6)
    v_mfma_f32_32x32x16_bf16 v[64:79], a[64:67], v[128:131], v[64:79]
    buffer_load_dwordx4 v[168:171], v0, s[4:7], s60 offen offset:3072 sc1
    v_add_f32 v114, v114, v122
    v_add_f32 v115, v115, v123
    v_add_f32 v116, v116, v124
    v_add_f32 v117, v117, v125
    v_add_f32 v118, v118, v126
    v_add_f32 v119, v119, v127
    v_add_f32 v96, v96, v112
    v_add_f32 v97, v97, v113
    v_add_f32 v98, v98, v114
    v_mfma_f32_32x32x16_bf16 v[80:95], a[68:71], v[128:131], v[80:95]
    v_add_f32 v99, v99, v115
    v_add_f32 v100, v100, v116
    v_add_f32 v101, v101, v117
    v_add_f32 v102, v102, v118
    v_add_f32 v103, v103, v119
    v_fmac_f32 v160, s61, v96
    v_fmac_f32 v161, s61, v97
    v_fmac_f32 v162, s61, v98
    v_fmac_f32 v163, s61, v99
    s_waitcnt vmcnt(6)
    v_mfma_f32_32x32x16_bf16 v[64:79], a[72:75], v[144:147], v[64:79]
    s_add_u32 s60, s49, 245760
    buffer_load_dwordx4 v[128:131], v0, s[4:7], s60 offen offset:0 sc1
    v_fmac_f32 v164, s61, v100
    v_fmac_f32 v165, s61, v101
    v_fmac_f32 v166, s61, v102
    v_fmac_f32 v167, s61, v103
    v_cvt_pk_bf16_f32 v16, v160, v161
    v_cvt_pk_bf16_f32 v17, v162, v163
    v_cvt_pk_bf16_f32 v18, v164, v165
    v_cvt_pk_bf16_f32 v19, v166, v167
    v_mfma_f32_32x32x16_bf16 v[80:95], a[76:79], v[144:147], v[80:95]
    v_dot2_f32_bf16 v60, v16, s54, 0
    v_dot2_f32_bf16 v61, v16, v16, 0
    v_dot2_f32_bf16 v60, v17, s54, v60
    v_dot2_f32_bf16 v61, v17, v17, v61
    v_dot2_f32_bf16 v60, v18, s54, v60
    s_waitcnt vmcnt(6)
    v_mfma_f32_32x32x16_bf16 v[64:79], a[80:83], v[148:151], v[64:79]
    buffer_load_dwordx4 v[144:147], v0, s[4:7], s60 offen offset:1024 sc1
    v_dot2_f32_bf16 v61, v18, v18, v61
    v_dot2_f32_bf16 v60, v19, s54, v60
    v_dot2_f32_bf16 v61, v19, v19, v61
    s_nop 2
    v_permlane32_swap_b32 v60, v61
    v_add_f32 v60, v60, v61
    v_mfma_f32_32x32x16_bf16 v[80:95], a[84:87], v[148:151], v[80:95]
    v_mov_b32 v63, v60
    s_nop 1
    v_permlane16_swap_b32 v60, v63
    v_add_f32 v60, v60, v63
    s_nop 1
    v_add_f32_dpp v60, v60, v60 row_ror:8 row_mask:0xf bank_mask:0xf
    v_mov_b32 v61, v60
    s_waitcnt vmcnt(6)
    v_mfma_f32_32x32x16_bf16 v[64:79], a[88:91], v[172:175], v[64:79]
    buffer_load_dwordx4 v[148:151], v0, s[4:7], s60 offen offset:2048 sc1
    v_permlane32_swap_b32 v60, v61
    v_cndmask_b32 v60, 0, v60, s[44:45]
    v_cndmask_b32 v61, 0, v61, s[44:45]
    s_add_u32 s29, s3, 2
    v_mov_b32 v62, s29
    s_add_u32 s29, s35, 262144
    s_mov_b64 exec, s[42:43]
    buffer_store_dwordx3 v[60:62], v11, s[4:7], s29 offen
    s_mov_b64 exec, -1
    v_mfma_f32_32x32x16_bf16 v[80:95], a[92:95], v[172:175], v[80:95]
    s_waitcnt vmcnt(7)
    v_mfma_f32_32x32x16_bf16 v[64:79], a[96:99], v[132:135], v[64:79]
    buffer_load_dwordx4 v[172:175], v0, s[4:7], s60 offen offset:3072 sc1
    v_mfma_f32_32x32x16_bf16 v[80:95], a[100:103], v[132:135], v[80:95]
    s_waitcnt vmcnt(7)
    v_mfma_f32_32x32x16_bf16 v[64:79], a[104:107], v[136:139], v[64:79]
    s_add_u32 s60, s49, 249856
    buffer_load_dwordx4 v[132:135], v0, s[4:7], s60 offen offset:0 sc1
    v_mfma_f32_32x32x16_bf16 v[80:95], a[108:111], v[136:139], v[80:95]
    s_waitcnt vmcnt(7)
    v_mfma_f32_32x32x16_bf16 v[64:79], a[112:115], v[140:143], v[64:79]
    buffer_load_dwordx4 v[136:139], v0, s[4:7], s60 offen offset:1024 sc1
    s_barrier
    v_mfma_f32_32x32x16_bf16 v[80:95], a[116:119], v[140:143], v[80:95]
    s_add_u32 s33, s35, 262144
    buffer_load_dwordx3 v[96:98], v2, s[4:7], s33 offen sc1
    s_waitcnt vmcnt(8)
    v_mfma_f32_32x32x16_bf16 v[64:79], a[120:123], v[168:171], v[64:79]
    buffer_load_dwordx4 v[140:143], v0, s[4:7], s60 offen offset:2048 sc1
    v_mfma_f32_32x32x16_bf16 v[80:95], a[124:127], v[168:171], v[80:95]
    buffer_load_dwordx4 v[168:171], v0, s[4:7], s60 offen offset:3072 sc1
    s_waitcnt vmcnt(9)
    v_mfma_f32_32x32x16_bf16 v[64:79], a[128:131], v[128:131], v[64:79]
    s_add_u32 s60, s49, 253952
    buffer_load_dwordx4 v[156:159], v0, s[4:7], s60 offen offset:0 sc1
    v_mfma_f32_32x32x16_bf16 v[80:95], a[132:135], v[128:131], v[80:95]
    buffer_load_dwordx4 v[128:131], v0, s[4:7], s60 offen offset:1024 sc1
    s_waitcnt vmcnt(10)
    v_mfma_f32_32x32x16_bf16 v[64:79], a[136:139], v[144:147], v[64:79]
    buffer_load_dwordx4 v[48:51], v0, s[4:7], s60 offen offset:2048 sc1
    v_mfma_f32_32x32x16_bf16 v[80:95], a[140:143], v[144:147], v[80:95]
    buffer_load_dwordx4 v[144:147], v0, s[4:7], s60 offen offset:3072 sc1
    s_waitcnt vmcnt(11)
    v_mfma_f32_32x32x16_bf16 v[64:79], a[144:147], v[148:151], v[64:79]
    v_mfma_f32_32x32x16_bf16 v[80:95], a[148:151], v[148:151], v[80:95]
    s_waitcnt vmcnt(9)
    v_mfma_f32_32x32x16_bf16 v[64:79], a[152:155], v[172:175], v[64:79]
    v_mfma_f32_32x32x16_bf16 v[80:95], a[156:159], v[172:175], v[80:95]
    s_waitcnt vmcnt(8)
    v_mfma_f32_32x32x16_bf16 v[64:79], a[160:163], v[132:135], v[64:79]
    v_mfma_f32_32x32x16_bf16 v[80:95], a[164:167], v[132:135], v[80:95]
    s_waitcnt vmcnt(7)
    v_mfma_f32_32x32x16_bf16 v[64:79], a[168:171], v[136:139], v[64:79]
    v_mfma_f32_32x32x16_bf16 v[80:95], a[172:175], v[136:139], v[80:95]
    s_waitcnt vmcnt(5)
    v_mfma_f32_32x32x16_bf16 v[64:79], a[176:179], v[140:143], v[64:79]
    s_waitcnt vmcnt(4)
    v_mfma_f32_32x32x16_bf16 v[64:79], a[184:187], v[168:171], v[64:79]
    v_lshlrev_b32 v104, 16, v16
    v_and_b32 v105, s46, v16
    v_lshlrev_b32 v112, 16, v24
    v_and_b32 v113, s46, v24
    v_lshlrev_b32 v106, 16, v17
    v_and_b32 v107, s46, v17
    v_lshlrev_b32 v114, 16, v25
    v_and_b32 v115, s46, v25
    s_waitcnt vmcnt(3)
    v_mfma_f32_32x32x16_bf16 v[64:79], a[192:195], v[156:159], v[64:79]
    v_lshlrev_b32 v108, 16, v18
    v_and_b32 v109, s46, v18
    v_lshlrev_b32 v116, 16, v26
    v_and_b32 v117, s46, v26
    v_lshlrev_b32 v110, 16, v19
    v_and_b32 v111, s46, v19
    v_lshlrev_b32 v118, 16, v27
    v_and_b32 v119, s46, v27
    s_waitcnt vmcnt(2)
    v_mfma_f32_32x32x16_bf16 v[64:79], a[200:203], v[128:131], v[64:79]
    s_waitcnt vmcnt(6)
    s_add_u32 s40, s3, 2
    v_cmp_eq_u32 vcc, s40, v98
    s_nop 0
    s_andn2_b64 s[40:41], exec, vcc
    s_cbranch_scc1 Lf_sspin_22
Lf_sback_23:
    v_permlane32_swap_b32 v96, v97
    v_add_f32 v96, v96, v97
    v_mov_b32 v99, v96
    s_nop 1
    v_permlane16_swap_b32 v96, v99
    v_add_f32 v96, v96, v99
    s_nop 1
    v_add_f32_dpp v96, v96, v96 row_ror:8 row_mask:0xf bank_mask:0xf
    v_mov_b32 v99, v96
    s_waitcnt vmcnt(1)
    v_mfma_f32_32x32x16_bf16 v[64:79], a[208:211], v[48:51], v[64:79]
    s_nop 0
    v_permlane32_swap_b32 v96, v99
    v_mul_f32 v100, 0.002232142857142857, v96
    v_mul_f32 v99, 0.002232142857142857, v99
    v_fma_f32 v99, -v100, v100, v99
    v_max_f32 v99, 0, v99
    v_add_f32 v99, 0x3727c5ac, v99
    v_rsq_f32 v101, v99
    s_nop 0
    v_mul_f32 v112, v101, v112
    s_waitcnt vmcnt(0)
    v_mfma_f32_32x32x16_bf16 v[64:79], a[216:219], v[144:147], v[64:79]
    v_mul_f32 v113, v101, v113
    v_mul_f32 v114, v101, v114
    v_mul_f32 v115, v101, v115
    v_mul_f32 v116, v101, v116
    v_mul_f32 v117, v101, v117
    v_mul_f32 v118, v101, v118
    v_mul_f32 v119, v101, v119
    v_sub_f32 v96, v104, v100
    v_mfma_f32_32x32x16_bf16 v[80:95], a[180:183], v[140:143], v[80:95]
    v_sub_f32 v97, v105, v100
    v_fmac_f32 v104, v96, v112
    v_fmac_f32 v105, v97, v113
    v_sub_f32 v96, v106, v100
    v_sub_f32 v97, v107, v100
    v_fmac_f32 v106, v96, v114
    v_fmac_f32 v107, v97, v115
    v_sub_f32 v96, v108, v100
    v_mfma_f32_32x32x16_bf16 v[80:95], a[188:191], v[168:171], v[80:95]
    v_sub_f32 v97, v109, v100
    v_fmac_f32 v108, v96, v116
    v_fmac_f32 v109, v97, v117
    v_sub_f32 v96, v110, v100
    v_sub_f32 v97, v111, v100
    v_fmac_f32 v110, v96, v118
    v_fmac_f32 v111, v97, v119
    v_cvt_pk_bf16_f32 v16, v104, v105
    v_mfma_f32_32x32x16_bf16 v[80:95], a[196:199], v[156:159], v[80:95]
    v_xor_b32 v58, 0, v6
    ds_write_b128 v58, v[64:67]
    v_cvt_pk_bf16_f32 v17, v106, v107
    v_cvt_pk_bf16_f32 v18, v108, v109
    v_cvt_pk_bf16_f32 v19, v110, v111
    s_add_u32 s29, s48, 0
    buffer_store_dwordx4 v[16:19], v4, s[4:7], s29 offen
    v_dot2_f32_bf16 v96, v16, s54, 0
    v_dot2_f32_bf16 v97, v16, v16, 0
    v_dot2_f32_bf16 v96, v17, s54, v96
    v_dot2_f32_bf16 v97, v17, v17, v97
    v_mfma_f32_32x32x16_bf16 v[80:95], a[204:207], v[128:131], v[80:95]
    v_xor_b32 v59, 32, v6
    ds_write_b128 v59, v[68:71]
    v_dot2_f32_bf16 v96, v18, s54, v96
    v_dot2_f32_bf16 v97, v18, v18, v97
    v_dot2_f32_bf16 v96, v19, s54, v96
    v_dot2_f32_bf16 v97, v19, v19, v97
    s_nop 2
    v_permlane32_swap_b32 v96, v97
    v_add_f32 v96, v96, v97
    v_mov_b32 v99, v96
    s_nop 1
    v_permlane16_swap_b32 v96, v99
    v_mfma_f32_32x32x16_bf16 v[80:95], a[212:215], v[48:51], v[80:95]
    v_xor_b32 v58, 64, v6
    ds_write_b128 v58, v[72:75]
    v_add_f32 v96, v96, v99
    s_nop 1
    v_add_f32_dpp v96, v96, v96 row_ror:8 row_mask:0xf bank_mask:0xf
    v_mov_b32 v97, v96
    s_nop 1
    v_permlane32_swap_b32 v96, v97
    v_cndmask_b32 v96, 0, v96, s[44:45]
    v_cndmask_b32 v97, 0, v97, s[44:45]
    s_add_u32 s29, s52, 393216
    s_mov_b64 exec, s[42:43]
    buffer_store_dwordx2 v[96:97], v3, s[4:7], s29 offen
    s_mov_b64 exec, -1
    v_mfma_f32_32x32x16_bf16 v[80:95], a[220:223], v[144:147], v[80:95]
    v_xor_b32 v59, 96, v6
    ds_write_b128 v59, v[76:79]
    v_xor_b32 v58, 128, v6
    s_nop 8
    ds_write_b128 v58, v[80:83]
    v_xor_b32 v59, 160, v6
    ds_write_b128 v59, v[84:87]
    v_xor_b32 v58, 192, v6
    ds_write_b128 v58, v[88:91]
    v_xor_b32 v59, 224, v6
    ds_write_b128 v59, v[92:95]
    s_add_u32 s29, s3, 5
    v_mov_b32 v12, s29
    s_waitcnt vmcnt(0)
    buffer_store_dword v12, off, s[4:7], s34
    s_waitcnt lgkmcnt(0)
    s_barrier
    v_xor_b32 v58, 16, v7
    ds_read_b128 v[64:67], v7 offset:0
    ds_read_b128 v[68:71], v58 offset:0
    ds_read_b128 v[72:75], v7 offset:8192
    ds_read_b128 v[76:79], v58 offset:8192
    ds_read_b128 v[80:83], v7 offset:16384
    ds_read_b128 v[84:87], v58 offset:16384
    ds_read_b128 v[88:91], v7 offset:24576
    ds_read_b128 v[92:95], v58 offset:24576
    buffer_load_dword v13, v9, s[4:7], 0 offen sc1
    v_lshlrev_b32 v160, 16, v20
    v_and_b32 v161, s46, v20
    v_lshlrev_b32 v162, 16, v21
    v_and_b32 v163, s46, v21
    v_lshlrev_b32 v164, 16, v22
    v_and_b32 v165, s46, v22
    v_lshlrev_b32 v166, 16, v23
    v_and_b32 v167, s46, v23
    s_waitcnt lgkmcnt(4)
    v_add_f32 v64, v64, v72
    v_add_f32 v65, v65, v73
    v_add_f32 v66, v66, v74
    v_add_f32 v67, v67, v75
    v_add_f32 v68, v68, v76
    v_add_f32 v69, v69, v77
    v_add_f32 v70, v70, v78
    v_add_f32 v71, v71, v79
    s_waitcnt lgkmcnt(0)
    v_add_f32 v80, v80, v88
    v_add_f32 v81, v81, v89
    v_add_f32 v82, v82, v90
    v_add_f32 v83, v83, v91
    v_add_f32 v84, v84, v92
    v_add_f32 v85, v85, v93
    v_add_f32 v86, v86, v94
    v_add_f32 v87, v87, v95
    v_add_f32 v64, v64, v80
    v_add_f32 v65, v65, v81
    v_add_f32 v66, v66, v82
    v_add_f32 v67, v67, v83
    v_add_f32 v68, v68, v84
    v_add_f32 v69, v69, v85
    v_add_f32 v70, v70, v86
    v_add_f32 v71, v71, v87
    v_fmac_f32 v160, s61, v64
    v_fmac_f32 v161, s61, v65
    v_fmac_f32 v162, s61, v66
    v_fmac_f32 v163, s61, v67
    v_fmac_f32 v164, s61, v68
    v_fmac_f32 v165, s61, v69
    v_fmac_f32 v166, s61, v70
    v_fmac_f32 v167, s61, v71
    v_cvt_pk_bf16_f32 v20, v160, v161
    v_cvt_pk_bf16_f32 v21, v162, v163
    v_cvt_pk_bf16_f32 v22, v164, v165
    v_cvt_pk_bf16_f32 v23, v166, v167
    s_waitcnt vmcnt(0)
    s_add_u32 s40, s3, 5
    v_subrev_u32 v13, s40, v13
    v_cmp_gt_u32 vcc, 16, v13
    s_nop 0
    s_andn2_b64 s[40:41], s[36:37], vcc
    s_cbranch_scc1 Lf_spin_25
Lf_back_26:
    s_add_u32 m0, s53, 0
    s_add_u32 s57, s47, 0
    buffer_load_dwordx4 v0, s[4:7], s57 offen offset:0 sc1 lds
    s_add_u32 m0, s53, 0
    s_nop 0
    buffer_load_dwordx4 v0, s[4:7], s57 offen offset:1024 sc1 lds
    s_add_u32 m0, s53, 0
    s_nop 0
    buffer_load_dwordx4 v0, s[4:7], s57 offen offset:2048 sc1 lds
    s_add_u32 m0, s53, 0
    s_nop 0
    buffer_load_dwordx4 v0, s[4:7], s57 offen offset:3072 sc1 lds
    s_add_u32 m0, s53, 4096
    s_add_u32 s57, s47, 4096
    buffer_load_dwordx4 v0, s[4:7], s57 offen offset:0 sc1 lds
    s_add_u32 m0, s53, 4096
    s_nop 0
    buffer_load_dwordx4 v0, s[4:7], s57 offen offset:1024 sc1 lds
    s_add_u32 m0, s53, 4096
    s_nop 0
    buffer_load_dwordx4 v0, s[4:7], s57 offen offset:2048 sc1 lds
    v_dot2_f32_bf16 v60, v20, s54, 0
    v_dot2_f32_bf16 v61, v20, v20, 0
    v_dot2_f32_bf16 v60, v21, s54, v60
    v_dot2_f32_bf16 v61, v21, v21, v61
    v_dot2_f32_bf16 v60, v22, s54, v60
    v_dot2_f32_bf16 v61, v22, v22, v61
    v_dot2_f32_bf16 v60, v23, s54, v60
    v_dot2_f32_bf16 v61, v23, v23, v61
    s_nop 2
    v_permlane32_swap_b32 v60, v61
    v_add_f32 v60, v60, v61
    v_mov_b32 v63, v60
    s_nop 1
    v_permlane16_swap_b32 v60, v63
    v_add_f32 v60, v60, v63
    s_nop 1
    v_add_f32_dpp v60, v60, v60 row_ror:8 row_mask:0xf bank_mask:0xf
    v_mov_b32 v61, v60
    s_nop 1
    v_permlane32_swap_b32 v60, v61
    v_cndmask_b32 v60, 0, v60, s[44:45]
    v_cndmask_b32 v61, 0, v61, s[44:45]
    s_add_u32 s29, s3, 2
    v_mov_b32 v62, s29
    s_add_u32 s29, s35, 270336
    s_mov_b64 exec, s[42:43]
    buffer_store_dwordx3 v[60:62], v11, s[4:7], s29 offen
    s_mov_b64 exec, -1
    s_add_u32 s58, s51, 393216
    buffer_load_dwordx4 v[112:115], v5, s[4:7], s58 offen offset:0 sc1
    buffer_load_dwordx4 v[116:119], v5, s[4:7], s58 offen offset:512 sc1
    buffer_load_dwordx4 v[120:123], v5, s[4:7], s58 offen offset:1024 sc1
    buffer_load_dwordx4 v[124:127], v5, s[4:7], s58 offen offset:1536 sc1
    s_waitcnt vmcnt(5)
    s_barrier
    ds_read_b128 v[128:131], v0 offset:0
    ds_read_b128 v[132:135], v0 offset:1024
    ds_read_b128 v[136:139], v0 offset:2048
    ds_read_b128 v[140:143], v0 offset:3072
    ds_read_b128 v[144:147], v0 offset:4096
    s_waitcnt lgkmcnt(3)
    v_mfma_f32_32x32x16_bf16 v[96:111], v[176:179], v[128:131], 0
    ds_read_b128 v[148:151], v0 offset:5120
    v_mfma_f32_32x32x16_bf16 v[96:111], v[180:183], v[132:135], v[96:111]
    ds_read_b128 v[128:131], v0 offset:6144
    s_waitcnt lgkmcnt(3)
    v_mfma_f32_32x32x16_bf16 v[96:111], v[184:187], v[136:139], v[96:111]
    ds_read_b128 v[132:135], v0 offset:7168
    s_add_u32 m0, s53, 28672
    s_add_u32 s57, s47, 28672
    buffer_load_dwordx4 v0, s[4:7], s57 offen offset:0 sc1 lds
    s_add_u32 s33, s35, 270336
    buffer_load_dwordx3 v[64:66], v2, s[4:7], s33 offen sc1
    v_mfma_f32_32x32x16_bf16 v[96:111], v[188:191], v[140:143], v[96:111]
    ds_read_b128 v[136:139], v0 offset:8192
    s_waitcnt lgkmcnt(3)
    v_mfma_f32_32x32x16_bf16 v[96:111], v[192:195], v[144:147], v[96:111]
    ds_read_b128 v[140:143], v0 offset:9216
    s_add_u32 m0, s53, 28672
    s_nop 0
    buffer_load_dwordx4 v0, s[4:7], s57 offen offset:1024 sc1 lds
    v_mfma_f32_32x32x16_bf16 v[96:111], v[196:199], v[148:151], v[96:111]
    ds_read_b128 v[144:147], v0 offset:10240
    s_waitcnt lgkmcnt(3)
    v_mfma_f32_32x32x16_bf16 v[96:111], v[200:203], v[128:131], v[96:111]
    ds_read_b128 v[148:151], v0 offset:11264
    v_mfma_f32_32x32x16_bf16 v[96:111], v[204:207], v[132:135], v[96:111]
    ds_read_b128 v[128:131], v0 offset:12288
    s_add_u32 m0, s53, 28672
    s_nop 0
    buffer_load_dwordx4 v0, s[4:7], s57 offen offset:2048 sc1 lds
    s_waitcnt lgkmcnt(3)
    v_mfma_f32_32x32x16_bf16 v[96:111], v[208:211], v[136:139], v[96:111]
    ds_read_b128 v[132:135], v0 offset:13312
    v_mfma_f32_32x32x16_bf16 v[96:111], v[212:215], v[140:143], v[96:111]
    ds_read_b128 v[136:139], v0 offset:14336
    s_add_u32 m0, s53, 28672
    s_nop 0
    buffer_load_dwordx4 v0, s[4:7], s57 offen offset:3072 sc1 lds
    s_waitcnt lgkmcnt(3)
    v_mfma_f32_32x32x16_bf16 v[96:111], v[216:219], v[144:147], v[96:111]
    ds_read_b128 v[140:143], v0 offset:15360
    v_mfma_f32_32x32x16_bf16 v[96:111], v[220:223], v[148:151], v[96:111]
    ds_read_b128 v[144:147], v0 offset:16384
    v_lshlrev_b32 v72, 16, v20
    v_and_b32 v73, s46, v20
    v_lshlrev_b32 v80, 16, v28
    v_and_b32 v81, s46, v28
    v_lshlrev_b32 v74, 16, v21
    v_and_b32 v75, s46, v21
    v_lshlrev_b32 v82, 16, v29
    v_and_b32 v83, s46, v29
    v_lshlrev_b32 v76, 16, v22
    v_and_b32 v77, s46, v22
    v_lshlrev_b32 v84, 16, v30
    v_and_b32 v85, s46, v30
    s_waitcnt lgkmcnt(3)
    v_mfma_f32_32x32x16_bf16 v[96:111], v[224:227], v[128:131], v[96:111]
    ds_read_b128 v[148:151], v0 offset:17408
    s_add_u32 m0, s53, 32768
    s_add_u32 s57, s47, 32768
    buffer_load_dwordx4 v0, s[4:7], s57 offen offset:0 sc1 lds
    v_lshlrev_b32 v78, 16, v23
    v_and_b32 v79, s46, v23
    v_lshlrev_b32 v86, 16, v31
    v_and_b32 v87, s46, v31
    s_waitcnt vmcnt(4)
    s_add_u32 s40, s3, 2
    v_cmp_eq_u32 vcc, s40, v66
    s_nop 0
    s_andn2_b64 s[40:41], exec, vcc
    s_cbranch_scc1 Lf_sspin_28
Lf_sback_29:
    v_permlane32_swap_b32 v64, v65
    v_add_f32 v64, v64, v65
    v_mov_b32 v67, v64
    s_nop 1
    v_permlane16_swap_b32 v64, v67
    v_add_f32 v64, v64, v67
    s_nop 1
    v_add_f32_dpp v64, v64, v64 row_ror:8 row_mask:0xf bank_mask:0xf
    v_mfma_f32_32x32x16_bf16 v[96:111], v[228:231], v[132:135], v[96:111]
    ds_read_b128 v[128:131], v0 offset:18432
    v_mov_b32 v67, v64
    s_nop 1
    v_permlane32_swap_b32 v64, v67
    v_mul_f32 v68, 0.002232142857142857, v64
    v_mul_f32 v67, 0.002232142857142857, v67
    v_fma_f32 v67, -v68, v68, v67
    v_max_f32 v67, 0, v67
    v_add_f32 v67, 0x3727c5ac, v67
    v_rsq_f32 v69, v67
    s_nop 0
    v_mul_f32 v80, v69, v80
    v_mul_f32 v81, v69, v81
    v_mul_f32 v82, v69, v82
    s_waitcnt lgkmcnt(3)
    v_mfma_f32_32x32x16_bf16 v[96:111], v[232:235], v[136:139], v[96:111]
    ds_read_b128 v[132:135], v0 offset:19456
    s_add_u32 m0, s53, 32768
    s_nop 0
    buffer_load_dwordx4 v0, s[4:7], s57 offen offset:1024 sc1 lds
    v_mul_f32 v83, v69, v83
    v_mul_f32 v84, v69, v84
    v_mul_f32 v85, v69, v85
    v_mul_f32 v86, v69, v86
    v_mul_f32 v87, v69, v87
    v_sub_f32 v64, v72, v68
    v_sub_f32 v65, v73, v68
    v_fmac_f32 v72, v64, v80
    v_fmac_f32 v73, v65, v81
    v_sub_f32 v64, v74, v68
    v_sub_f32 v65, v75, v68
    v_fmac_f32 v74, v64, v82
    v_mfma_f32_32x32x16_bf16 v[96:111], v[236:239], v[140:143], v[96:111]
    ds_read_b128 v[136:139], v0 offset:20480
    v_fmac_f32 v75, v65, v83
    v_sub_f32 v64, v76, v68
    v_sub_f32 v65, v77, v68
    v_fmac_f32 v76, v64, v84
    v_fmac_f32 v77, v65, v85
    v_sub_f32 v64, v78, v68
    v_sub_f32 v65, v79, v68
    v_fmac_f32 v78, v64, v86
    v_fmac_f32 v79, v65, v87
    v_cvt_pk_bf16_f32 v20, v72, v73
    v_cvt_pk_bf16_f32 v21, v74, v75
    s_waitcnt lgkmcnt(3)
    v_mfma_f32_32x32x16_bf16 v[96:111], v[240:243], v[144:147], v[96:111]
    ds_read_b128 v[140:143], v0 offset:21504
    v_cvt_pk_bf16_f32 v22, v76, v77
    v_cvt_pk_bf16_f32 v23, v78, v79
    s_add_u32 s29, s48, 57344
    buffer_store_dwordx4 v[20:23], v4, s[4:7], s29 offen
    v_dot2_f32_bf16 v64, v20, s54, 0
    v_dot2_f32_bf16 v65, v20, v20, 0
    v_dot2_f32_bf16 v64, v21, s54, v64
    v_dot2_f32_bf16 v65, v21, v21, v65
    v_dot2_f32_bf16 v64, v22, s54, v64
    v_dot2_f32_bf16 v65, v22, v22, v65
    v_dot2_f32_bf16 v64, v23, s54, v64
    v_dot2_f32_bf16 v65, v23, v23, v65
    v_mfma_f32_32x32x16_bf16 v[96:111], v[244:247], v[148:151], v[96:111]
    ds_read_b128 v[144:147], v0 offset:22528
    s_add_u32 m0, s53, 32768
    s_nop 0
    buffer_load_dwordx4 v0, s[4:7], s57 offen offset:2048 sc1 lds
    v_permlane32_swap_b32 v64, v65
    v_add_f32 v64, v64, v65
    v_mov_b32 v67, v64
    s_nop 1
    v_permlane16_swap_b32 v64, v67
    v_add_f32 v64, v64, v67
    s_nop 1
    v_add_f32_dpp v64, v64, v64 row_ror:8 row_mask:0xf bank_mask:0xf
    v_mov_b32 v65, v64
    s_nop 1
    v_permlane32_swap_b32 v64, v65
    v_cndmask_b32 v64, 0, v64, s[44:45]
    v_cndmask_b32 v65, 0, v65, s[44:45]
    s_add_u32 s29, s52, 397312
    s_mov_b64 exec, s[42:43]
    buffer_store_dwordx2 v[64:65], v3, s[4:7], s29 offen
    s_mov_b64 exec, -1
    s_waitcnt lgkmcnt(3)
    v_mfma_f32_32x32x16_bf16 v[96:111], v[248:251], v[128:131], v[96:111]
    ds_read_b128 v[148:151], v0 offset:23552
    s_waitcnt vmcnt(10)
    v_add_f32 v58, v112, v114
    v_add_f32 v59, v113, v115
    v_add_f32 v60, v116, v118
    v_add_f32 v61, v117, v119
    v_mfma_f32_32x32x16_bf16 v[96:111], v[252:255], v[132:135], v[96:111]
    ds_read_b128 v[128:131], v0 offset:24576
    v_add_f32 v58, v58, v120
    v_add_f32 v59, v59, v121
    v_add_f32 v60, v60, v122
    s_waitcnt lgkmcnt(3)
    v_mfma_f32_32x32x16_bf16 v[96:111], a[224:227], v[136:139], v[96:111]
    ds_read_b128 v[132:135], v0 offset:25600
    v_add_f32 v61, v61, v123
    v_add_f32 v58, v58, v124
    v_add_f32 v59, v59, v125
    v_mfma_f32_32x32x16_bf16 v[96:111], a[228:231], v[140:143], v[96:111]
    ds_read_b128 v[136:139], v0 offset:26624
    v_add_f32 v58, v58, v60
    v_add_f32 v59, v59, v61
    v_mul_f32 v60, 0.002232142857142857, v58
    s_waitcnt lgkmcnt(3)
    v_mfma_f32_32x32x16_bf16 v[96:111], a[232:235], v[144:147], v[96:111]
    ds_read_b128 v[140:143], v0 offset:27648
    v_mul_f32 v59, 0.002232142857142857, v59
    v_fma_f32 v59, -v60, v60, v59
    v_max_f32 v59, 0, v59
    v_mfma_f32_32x32x16_bf16 v[96:111], a[236:239], v[148:151], v[96:111]
    s_waitcnt vmcnt(1)
    s_barrier
    ds_read_b128 v[144:147], v0 offset:28672
    v_add_f32 v59, 0x3727c5ac, v59
    v_rsq_f32 v61, v59
    s_nop 0
    v_mul_f32 v49, 0xbfb8aa3b, v61
    s_waitcnt lgkmcnt(3)
    v_mfma_f32_32x32x16_bf16 v[96:111], a[240:243], v[128:131], v[96:111]
    ds_read_b128 v[148:151], v0 offset:29696
    v_mul_f32 v48, v60, v49
    v_mov_b32 v51, v49
    v_sub_f32 v48, 0, v48
    s_add_u32 s29, s3, 6
    v_mov_b32 v12, s29
    s_waitcnt vmcnt(0)
    buffer_store_dword v12, off, s[4:7], s34
    v_mfma_f32_32x32x16_bf16 v[96:111], a[244:247], v[132:135], v[96:111]
    ds_read_b128 v[128:131], v0 offset:30720
    v_permlane32_swap_b32 v49, v51
    v_mov_b32 v50, v48
    s_nop 1
    v_permlane32_swap_b32 v48, v50
    s_waitcnt lgkmcnt(3)
    v_mfma_f32_32x32x16_bf16 v[96:111], a[248:251], v[136:139], v[96:111]
    ds_read_b128 v[132:135], v0 offset:31744
    v_mfma_f32_32x32x16_bf16 v[96:111], a[252:255], v[140:143], v[96:111]
    ds_read_b128 v[136:139], v0 offset:32768
    buffer_load_dword v13, v9, s[4:7], 0 offen sc1
    s_waitcnt lgkmcnt(3)
    v_mfma_f32_32x32x16_bf16 v[112:127], v[176:179], v[144:147], 0
    ds_read_b128 v[140:143], v0 offset:33792
    v_mfma_f32_32x32x16_bf16 v[112:127], v[180:183], v[148:151], v[112:127]
    ds_read_b128 v[144:147], v0 offset:34816
    s_waitcnt lgkmcnt(3)
    v_mfma_f32_32x32x16_bf16 v[112:127], v[184:187], v[128:131], v[112:127]
    ds_read_b128 v[148:151], v0 offset:35840
    v_mfma_f32_32x32x16_bf16 v[112:127], v[188:191], v[132:135], v[112:127]
    ds_read_b128 v[128:131], v0 offset:36864
    s_waitcnt lgkmcnt(3)
    v_mfma_f32_32x32x16_bf16 v[112:127], v[192:195], v[136:139], v[112:127]
    ds_read_b128 v[132:135], v0 offset:37888
    v_mul_f32 v152, v48, v32
    v_mul_f32 v153, v48, v33
    v_mul_f32 v154, v48, v34
    v_mul_f32 v155, v48, v35
    v_fma_f32 v96, v49, v96, v152
    v_mfma_f32_32x32x16_bf16 v[112:127], v[196:199], v[140:143], v[112:127]
    ds_read_b128 v[136:139], v0 offset:38912
    v_fma_f32 v97, v49, v97, v153
    v_fma_f32 v98, v49, v98, v154
    v_fma_f32 v99, v49, v99, v155
    v_exp_f32 v152, v96
    s_waitcnt lgkmcnt(3)
    v_mfma_f32_32x32x16_bf16 v[112:127], v[200:203], v[144:147], v[112:127]
    ds_read_b128 v[140:143], v0 offset:39936
    v_exp_f32 v153, v97
    v_exp_f32 v154, v98
    v_exp_f32 v155, v99
    v_add_f32 v152, 1.0, v152
    v_mfma_f32_32x32x16_bf16 v[112:127], v[204:207], v[148:151], v[112:127]
    ds_read_b128 v[144:147], v0 offset:40960
    s_waitcnt vmcnt(0)
    s_add_u32 s40, s3, 6
    v_subrev_u32 v13, s40, v13
    v_cmp_gt_u32 vcc, 16, v13
    s_nop 0
    s_andn2_b64 s[40:41], s[36:37], vcc
    s_cbranch_scc1 Lf_spin_31
Lf_back_32:
    s_add_u32 m0, s53, 57344
    s_add_u32 s57, s47, 57344
    buffer_load_dwordx4 v0, s[4:7], s57 offen offset:0 sc1 lds
    v_add_f32 v153, 1.0, v153
    v_add_f32 v154, 1.0, v154
    v_add_f32 v155, 1.0, v155
    v_rcp_f32 v152, v152
    s_waitcnt lgkmcnt(3)
    v_mfma_f32_32x32x16_bf16 v[112:127], v[208:211], v[128:131], v[112:127]
    ds_read_b128 v[148:151], v0 offset:41984
    s_add_u32 m0, s53, 57344
    s_nop 0
    buffer_load_dwordx4 v0, s[4:7], s57 offen offset:1024 sc1 lds
    s_add_u32 m0, s53, 57344
    s_nop 0
    buffer_load_dwordx4 v0, s[4:7], s57 offen offset:2048 sc1 lds
    v_rcp_f32 v153, v153
    v_rcp_f32 v154, v154
    v_rcp_f32 v155, v155
    v_mul_f32 v96, v96, v152
    v_mul_f32 v97, v97, v153
    v_mfma_f32_32x32x16_bf16 v[112:127], v[212:215], v[132:135], v[112:127]
    ds_read_b128 v[128:131], v0 offset:43008
    s_add_u32 m0, s53, 57344
    s_nop 0
    buffer_load_dwordx4 v0, s[4:7], s57 offen offset:3072 sc1 lds
    s_add_u32 m0, s53, 61440
    s_add_u32 s57, s47, 61440
    buffer_load_dwordx4 v0, s[4:7], s57 offen offset:0 sc1 lds
    v_mul_f32 v98, v98, v154
    v_mul_f32 v99, v99, v155
    v_cvt_pk_bf16_f32 v160, v96, v97
    v_cvt_pk_bf16_f32 v161, v98, v99
    s_waitcnt lgkmcnt(3)
    v_mfma_f32_32x32x16_bf16 v[112:127], v[216:219], v[136:139], v[112:127]
    ds_read_b128 v[132:135], v0 offset:44032
    s_add_u32 m0, s53, 61440
    s_nop 0
    buffer_load_dwordx4 v0, s[4:7], s57 offen offset:1024 sc1 lds
    s_add_u32 m0, s53, 61440
    s_nop 0
    buffer_load_dwordx4 v0, s[4:7], s57 offen offset:2048 sc1 lds
    v_mul_f32 v152, v48, v36
    v_mul_f32 v153, v48, v37
    v_mul_f32 v154, v48, v38
    v_mul_f32 v155, v48, v39
    v_mfma_f32_32x32x16_bf16 v[112:127], v[220:223], v[140:143], v[112:127]
    ds_read_b128 v[136:139], v0 offset:45056
    v_fma_f32 v100, v49, v100, v152
    v_fma_f32 v101, v49, v101, v153
    v_fma_f32 v102, v49, v102, v154
    v_fma_f32 v103, v49, v103, v155
    s_waitcnt lgkmcnt(3)
    v_mfma_f32_32x32x16_bf16 v[112:127], v[224:227], v[144:147], v[112:127]
    ds_read_b128 v[140:143], v0 offset:46080
    v_exp_f32 v152, v100
    v_exp_f32 v153, v101
    v_exp_f32 v154, v102
    v_exp_f32 v155, v103
    v_add_f32 v152, 1.0, v152
    v_mfma_f32_32x32x16_bf16 v[112:127], v[228:231], v[148:151], v[112:127]
    ds_read_b128 v[144:147], v0 offset:47104
    v_add_f32 v153, 1.0, v153
    v_add_f32 v154, 1.0, v154
    v_add_f32 v155, 1.0, v155
    v_rcp_f32 v152, v152
    s_waitcnt lgkmcnt(3)
    v_mfma_f32_32x32x16_bf16 v[112:127], v[232:235], v[128:131], v[112:127]
    ds_read_b128 v[148:151], v0 offset:48128
    v_rcp_f32 v153, v153
    v_rcp_f32 v154, v154
    v_rcp_f32 v155, v155
    v_mul_f32 v100, v100, v152
    v_mfma_f32_32x32x16_bf16 v[112:127], v[236:239], v[132:135], v[112:127]
    ds_read_b128 v[128:131], v0 offset:49152
    v_mul_f32 v101, v101, v153
    v_mul_f32 v102, v102, v154
    v_mul_f32 v103, v103, v155
    v_cvt_pk_bf16_f32 v162, v100, v101
    s_waitcnt lgkmcnt(3)
    v_mfma_f32_32x32x16_bf16 v[112:127], v[240:243], v[136:139], v[112:127]
    ds_read_b128 v[132:135], v0 offset:50176
    v_cvt_pk_bf16_f32 v163, v102, v103
    s_add_u32 s30, s50, 0
    buffer_store_dwordx4 v[160:163], v0, s[4:7], s30 offen
    v_mul_f32 v152, v48, v40
    v_mul_f32 v153, v48, v41
    v_mul_f32 v154, v48, v42
    v_mfma_f32_32x32x16_bf16 v[112:127], v[244:247], v[140:143], v[112:127]
    ds_read_b128 v[136:139], v0 offset:51200
    v_mul_f32 v155, v48, v43
    v_fma_f32 v104, v49, v104, v152
    v_fma_f32 v105, v49, v105, v153
    v_fma_f32 v106, v49, v106, v154
    s_waitcnt lgkmcnt(3)
    v_mfma_f32_32x32x16_bf16 v[112:127], v[248:251], v[144:147], v[112:127]
    ds_read_b128 v[140:143], v0 offset:52224
    v_fma_f32 v107, v49, v107, v155
    v_exp_f32 v152, v104
    v_exp_f32 v153, v105
    v_exp_f32 v154, v106
    v_mfma_f32_32x32x16_bf16 v[112:127], v[252:255], v[148:151], v[112:127]
    ds_read_b128 v[144:147], v0 offset:53248
    v_exp_f32 v155, v107
    v_add_f32 v152, 1.0, v152
    v_add_f32 v153, 1.0, v153
    v_add_f32 v154, 1.0, v154
    s_waitcnt lgkmcnt(3)
    v_mfma_f32_32x32x16_bf16 v[112:127], a[224:227], v[128:131], v[112:127]
    ds_read_b128 v[148:151], v0 offset:54272
    v_add_f32 v155, 1.0, v155
    v_rcp_f32 v152, v152
    v_rcp_f32 v153, v153
    v_rcp_f32 v154, v154
    v_rcp_f32 v155, v155
    v_mfma_f32_32x32x16_bf16 v[112:127], a[228:231], v[132:135], v[112:127]
    ds_read_b128 v[128:131], v0 offset:55296
    v_mul_f32 v104, v104, v152
    v_mul_f32 v105, v105, v153
    v_mul_f32 v106, v106, v154
    v_mul_f32 v107, v107, v155
    s_waitcnt lgkmcnt(3)
    v_mfma_f32_32x32x16_bf16 v[112:127], a[232:235], v[136:139], v[112:127]
    ds_read_b128 v[132:135], v0 offset:56320
    v_cvt_pk_bf16_f32 v164, v104, v105
    v_cvt_pk_bf16_f32 v165, v106, v107
    v_mul_f32 v152, v48, v44
    v_mul_f32 v153, v48, v45
    v_mfma_f32_32x32x16_bf16 v[112:127], a[236:239], v[140:143], v[112:127]
    s_waitcnt vmcnt(1)
    s_barrier
    ds_read_b128 v[136:139], v1 offset:0
    v_mul_f32 v154, v48, v46
    v_mul_f32 v155, v48, v47
    v_fma_f32 v108, v49, v108, v152
    v_fma_f32 v109, v49, v109, v153
    s_waitcnt lgkmcnt(3)
    v_mfma_f32_32x32x16_bf16 v[112:127], a[240:243], v[144:147], v[112:127]
    ds_read_b128 v[140:143], v1 offset:1024
    v_fma_f32 v110, v49, v110, v154
    v_fma_f32 v111, v49, v111, v155
    v_exp_f32 v152, v108
    v_exp_f32 v153, v109
    v_exp_f32 v154, v110
    v_mfma_f32_32x32x16_bf16 v[112:127], a[244:247], v[148:151], v[112:127]
    ds_read_b128 v[144:147], v1 offset:2048
    s_add_u32 m0, s53, 86016
    s_add_u32 s57, s47, 86016
    buffer_load_dwordx4 v0, s[4:7], s57 offen offset:0 sc1 lds
    v_exp_f32 v155, v111
    v_add_f32 v152, 1.0, v152
    v_add_f32 v153, 1.0, v153
    v_add_f32 v154, 1.0, v154
    s_waitcnt lgkmcnt(3)
    v_mfma_f32_32x32x16_bf16 v[112:127], a[248:251], v[128:131], v[112:127]
    ds_read_b128 v[148:151], v1 offset:3072
    s_add_u32 m0, s53, 86016
    s_nop 0
    buffer_load_dwordx4 v0, s[4:7], s57 offen offset:1024 sc1 lds
    v_add_f32 v155, 1.0, v155
    v_rcp_f32 v152, v152
    v_rcp_f32 v153, v153
    v_rcp_f32 v154, v154
    v_mfma_f32_32x32x16_bf16 v[112:127], a[252:255], v[132:135], v[112:127]
    ds_read_b128 v[128:131], v1 offset:4096
    v_rcp_f32 v155, v155
    v_mul_f32 v108, v108, v152
    v_mul_f32 v109, v109, v153
    v_mul_f32 v110, v110, v154
    s_waitcnt lgkmcnt(3)
    v_mfma_f32_32x32x16_bf16 v[64:79], v[176:179], v[136:139], 0
    ds_read_b128 v[132:135], v1 offset:5120
    s_add_u32 m0, s53, 86016
    s_nop 0
    buffer_load_dwordx4 v0, s[4:7], s57 offen offset:2048 sc1 lds
    v_mul_f32 v111, v111, v155
    v_cvt_pk_bf16_f32 v166, v108, v109
    v_cvt_pk_bf16_f32 v167, v110, v111
    s_add_u32 s30, s50, 0
    buffer_store_dwordx4 v[164:167], v0, s[4:7], s30 offen offset:1024
    v_mfma_f32_32x32x16_bf16 v[64:79], v[180:183], v[140:143], v[64:79]
    ds_read_b128 v[136:139], v1 offset:6144
    s_waitcnt lgkmcnt(3)
    v_mfma_f32_32x32x16_bf16 v[64:79], v[184:187], v[144:147], v[64:79]
    ds_read_b128 v[140:143], v1 offset:7168
    s_add_u32 m0, s53, 86016
    s_nop 0
    buffer_load_dwordx4 v0, s[4:7], s57 offen offset:3072 sc1 lds
    v_mfma_f32_32x32x16_bf16 v[64:79], v[188:191], v[148:151], v[64:79]
    ds_read_b128 v[144:147], v1 offset:8192
    v_mul_f32 v152, v50, v32
    v_mul_f32 v153, v50, v33
    v_mul_f32 v154, v50, v34
    v_mul_f32 v155, v50, v35
    v_fma_f32 v112, v51, v112, v152
    v_fma_f32 v113, v51, v113, v153
    s_waitcnt lgkmcnt(3)
    v_mfma_f32_32x32x16_bf16 v[64:79], v[192:195], v[128:131], v[64:79]
    ds_read_b128 v[148:151], v1 offset:9216
    s_add_u32 m0, s53, 90112
    s_add_u32 s57, s47, 90112
    buffer_load_dwordx4 v0, s[4:7], s57 offen offset:0 sc1 lds
    v_fma_f32 v114, v51, v114, v154
    v_fma_f32 v115, v51, v115, v155
    v_exp_f32 v152, v112
    v_exp_f32 v153, v113
    v_exp_f32 v154, v114
    v_mfma_f32_32x32x16_bf16 v[64:79], v[196:199], v[132:135], v[64:79]
    ds_read_b128 v[128:131], v1 offset:10240
    v_exp_f32 v155, v115
    v_add_f32 v152, 1.0, v152
    v_add_f32 v153, 1.0, v153
    v_add_f32 v154, 1.0, v154
    v_add_f32 v155, 1.0, v155
    s_waitcnt lgkmcnt(3)
    v_mfma_f32_32x32x16_bf16 v[64:79], v[200:203], v[136:139], v[64:79]
    ds_read_b128 v[132:135], v1 offset:11264
    s_add_u32 m0, s53, 90112
    s_nop 0
    buffer_load_dwordx4 v0, s[4:7], s57 offen offset:1024 sc1 lds
    v_rcp_f32 v152, v152
    v_rcp_f32 v153, v153
    v_rcp_f32 v154, v154
    v_rcp_f32 v155, v155
    v_mul_f32 v112, v112, v152
    v_mul_f32 v113, v113, v153
    v_mfma_f32_32x32x16_bf16 v[64:79], v[204:207], v[140:143], v[64:79]
    ds_read_b128 v[136:139], v1 offset:12288
    v_mul_f32 v114, v114, v154
    v_mul_f32 v115, v115, v155
    v_cvt_pk_bf16_f32 v160, v112, v113
    v_cvt_pk_bf16_f32 v161, v114, v115
    v_mul_f32 v152, v50, v36
    s_waitcnt lgkmcnt(3)
    v_mfma_f32_32x32x16_bf16 v[64:79], v[208:211], v[144:147], v[64:79]
    ds_read_b128 v[140:143], v1 offset:13312
    s_add_u32 m0, s53, 90112
    s_nop 0
    buffer_load_dwordx4 v0, s[4:7], s57 offen offset:2048 sc1 lds
    v_mul_f32 v153, v50, v37
    v_mul_f32 v154, v50, v38
    v_mul_f32 v155, v50, v39
    v_fma_f32 v116, v51, v116, v152
    v_fma_f32 v117, v51, v117, v153
    v_mfma_f32_32x32x16_bf16 v[64:79], v[212:215], v[148:151], v[64:79]
    ds_read_b128 v[144:147], v1 offset:14336
    v_fma_f32 v118, v51, v118, v154
    v_fma_f32 v119, v51, v119, v155
    v_exp_f32 v152, v116
    v_exp_f32 v153, v117
    v_exp_f32 v154, v118
    v_exp_f32 v155, v119
    s_waitcnt lgkmcnt(3)
    v_mfma_f32_32x32x16_bf16 v[64:79], v[216:219], v[128:131], v[64:79]
    ds_read_b128 v[148:151], v1 offset:15360
    v_add_f32 v152, 1.0, v152
    v_add_f32 v153, 1.0, v153
    v_add_f32 v154, 1.0, v154
    v_add_f32 v155, 1.0, v155
    v_rcp_f32 v152, v152
    v_mfma_f32_32x32x16_bf16 v[64:79], v[220:223], v[132:135], v[64:79]
    ds_read_b128 v[128:131], v1 offset:16384
    v_rcp_f32 v153, v153
    v_rcp_f32 v154, v154
    v_rcp_f32 v155, v155
    v_mul_f32 v116, v116, v152
    v_mul_f32 v117, v117, v153
    s_waitcnt lgkmcnt(3)
    v_mfma_f32_32x32x16_bf16 v[64:79], v[224:227], v[136:139], v[64:79]
    ds_read_b128 v[132:135], v1 offset:17408
    v_mul_f32 v118, v118, v154
    v_mul_f32 v119, v119, v155
    v_cvt_pk_bf16_f32 v162, v116, v117
    v_cvt_pk_bf16_f32 v163, v118, v119
    s_add_u32 s30, s50, 114688
    buffer_store_dwordx4 v[160:163], v0, s[4:7], s30 offen
    v_mfma_f32_32x32x16_bf16 v[64:79], v[228:231], v[140:143], v[64:79]
    ds_read_b128 v[136:139], v1 offset:18432
    v_mul_f32 v152, v50, v40
    v_mul_f32 v153, v50, v41
    v_mul_f32 v154, v50, v42
    v_mul_f32 v155, v50, v43
    v_fma_f32 v120, v51, v120, v152
    v_fma_f32 v121, v51, v121, v153
    s_waitcnt lgkmcnt(3)
    v_mfma_f32_32x32x16_bf16 v[64:79], v[232:235], v[144:147], v[64:79]
    ds_read_b128 v[140:143], v1 offset:19456
    s_add_u32 s58, s51, 397312
    buffer_load_dwordx4 v[96:99], v5, s[4:7], s58 offen offset:0 sc1
    buffer_load_dwordx4 v[100:103], v5, s[4:7], s58 offen offset:512 sc1
    buffer_load_dwordx4 v[104:107], v5, s[4:7], s58 offen offset:1024 sc1
    buffer_load_dwordx4 v[108:111], v5, s[4:7], s58 offen offset:1536 sc1
    v_fma_f32 v122, v51, v122, v154
    v_fma_f32 v123, v51, v123, v155
    v_exp_f32 v152, v120
    v_exp_f32 v153, v121
    v_exp_f32 v154, v122
    v_mfma_f32_32x32x16_bf16 v[64:79], v[236:239], v[148:151], v[64:79]
    ds_read_b128 v[144:147], v1 offset:20480
    v_exp_f32 v155, v123
    v_add_f32 v152, 1.0, v152
    v_add_f32 v153, 1.0, v153
    v_add_f32 v154, 1.0, v154
    v_add_f32 v155, 1.0, v155
    s_waitcnt lgkmcnt(3)
    v_mfma_f32_32x32x16_bf16 v[64:79], v[240:243], v[128:131], v[64:79]
    ds_read_b128 v[148:151], v1 offset:21504
    v_rcp_f32 v152, v152
    v_rcp_f32 v153, v153
    v_rcp_f32 v154, v154
    v_rcp_f32 v155, v155
    v_mul_f32 v120, v120, v152
    v_mul_f32 v121, v121, v153
    v_mfma_f32_32x32x16_bf16 v[64:79], v[244:247], v[132:135], v[64:79]
    ds_read_b128 v[128:131], v1 offset:22528
    v_mul_f32 v122, v122, v154
    v_mul_f32 v123, v123, v155
    v_cvt_pk_bf16_f32 v164, v120, v121
    v_cvt_pk_bf16_f32 v165, v122, v123
    v_mul_f32 v152, v50, v44
    s_waitcnt lgkmcnt(3)
    v_mfma_f32_32x32x16_bf16 v[64:79], v[248:251], v[136:139], v[64:79]
    ds_read_b128 v[132:135], v1 offset:23552
    v_mul_f32 v153, v50, v45
    v_mul_f32 v154, v50, v46
    v_mul_f32 v155, v50, v47
    v_fma_f32 v124, v51, v124, v152
    v_fma_f32 v125, v51, v125, v153
    v_mfma_f32_32x32x16_bf16 v[64:79], v[252:255], v[140:143], v[64:79]
    ds_read_b128 v[136:139], v1 offset:24576
    v_fma_f32 v126, v51, v126, v154
    v_fma_f32 v127, v51, v127, v155
    v_exp_f32 v152, v124
    v_exp_f32 v153, v125
    v_exp_f32 v154, v126
    v_exp_f32 v155, v127
    s_waitcnt lgkmcnt(3)
    v_mfma_f32_32x32x16_bf16 v[64:79], a[224:227], v[144:147], v[64:79]
    ds_read_b128 v[140:143], v1 offset:25600
    v_add_f32 v152, 1.0, v152
    v_add_f32 v153, 1.0, v153
    v_add_f32 v154, 1.0, v154
    v_add_f32 v155, 1.0, v155
    v_rcp_f32 v152, v152
    v_mfma_f32_32x32x16_bf16 v[64:79], a[228:231], v[148:151], v[64:79]
    ds_read_b128 v[144:147], v1 offset:26624
    v_rcp_f32 v153, v153
    v_rcp_f32 v154, v154
    v_rcp_f32 v155, v155
    v_mul_f32 v124, v124, v152
    v_mul_f32 v125, v125, v153
    s_waitcnt lgkmcnt(3)
    v_mfma_f32_32x32x16_bf16 v[64:79], a[232:235], v[128:131], v[64:79]
    ds_read_b128 v[148:151], v1 offset:27648
    v_mul_f32 v126, v126, v154
    v_mul_f32 v127, v127, v155
    v_cvt_pk_bf16_f32 v166, v124, v125
    v_cvt_pk_bf16_f32 v167, v126, v127
    s_add_u32 s30, s50, 114688
    buffer_store_dwordx4 v[164:167], v0, s[4:7], s30 offen offset:1024
    v_mfma_f32_32x32x16_bf16 v[64:79], a[236:239], v[132:135], v[64:79]
    s_waitcnt vmcnt(6)
    s_barrier
    ds_read_b128 v[128:131], v1 offset:28672
    s_waitcnt lgkmcnt(3)
    v_mfma_f32_32x32x16_bf16 v[64:79], a[240:243], v[136:139], v[64:79]
    ds_read_b128 v[132:135], v1 offset:29696
    s_waitcnt vmcnt(1)
    v_add_f32 v58, v96, v98
    v_add_f32 v59, v97, v99
    v_add_f32 v60, v100, v102
    v_add_f32 v61, v101, v103
    v_mfma_f32_32x32x16_bf16 v[64:79], a[244:247], v[140:143], v[64:79]
    ds_read_b128 v[136:139], v1 offset:30720
    v_add_f32 v58, v58, v104
    v_add_f32 v59, v59, v105
    v_add_f32 v60, v60, v106
    v_add_f32 v61, v61, v107
    s_waitcnt lgkmcnt(3)
    v_mfma_f32_32x32x16_bf16 v[64:79], a[248:251], v[144:147], v[64:79]
    ds_read_b128 v[140:143], v1 offset:31744
    v_add_f32 v58, v58, v108
    v_add_f32 v59, v59, v109
    v_add_f32 v58, v58, v60
    v_mfma_f32_32x32x16_bf16 v[64:79], a[252:255], v[148:151], v[64:79]
    ds_read_b128 v[144:147], v1 offset:32768
    v_add_f32 v59, v59, v61
    v_mul_f32 v60, 0.002232142857142857, v58
    v_mul_f32 v59, 0.002232142857142857, v59
    v_fma_f32 v59, -v60, v60, v59
    s_waitcnt lgkmcnt(3)
    v_mfma_f32_32x32x16_bf16 v[80:95], v[176:179], v[128:131], 0
    ds_read_b128 v[148:151], v1 offset:33792
    v_max_f32 v59, 0, v59
    v_add_f32 v59, 0x3727c5ac, v59
    v_rsq_f32 v61, v59
    s_add_u32 s29, s3, 7
    v_mov_b32 v12, s29
    s_waitcnt vmcnt(0)
    buffer_store_dword v12, off, s[4:7], s34
    v_mfma_f32_32x32x16_bf16 v[80:95], v[180:183], v[132:135], v[80:95]
    ds_read_b128 v[128:131], v1 offset:34816
    v_mul_f32 v53, 0xbfb8aa3b, v61
    v_mul_f32 v52, v60, v53
    v_mov_b32 v55, v53
    v_sub_f32 v52, 0, v52
    s_waitcnt lgkmcnt(3)
    v_mfma_f32_32x32x16_bf16 v[80:95], v[184:187], v[136:139], v[80:95]
    ds_read_b128 v[132:135], v1 offset:35840
    v_permlane32_swap_b32 v53, v55
    v_mov_b32 v54, v52
    s_nop 1
    v_permlane32_swap_b32 v52, v54
    v_mfma_f32_32x32x16_bf16 v[80:95], v[188:191], v[140:143], v[80:95]
    ds_read_b128 v[136:139], v1 offset:36864
    s_waitcnt lgkmcnt(3)
    v_mfma_f32_32x32x16_bf16 v[80:95], v[192:195], v[144:147], v[80:95]
    ds_read_b128 v[140:143], v1 offset:37888
    v_mul_f32 v152, v52, v32
    v_mul_f32 v153, v52, v33
    v_mul_f32 v154, v52, v34
    v_mul_f32 v155, v52, v35
    v_fma_f32 v64, v53, v64, v152
    v_mfma_f32_32x32x16_bf16 v[80:95], v[196:199], v[148:151], v[80:95]
    ds_read_b128 v[144:147], v1 offset:38912
    v_fma_f32 v65, v53, v65, v153
    v_fma_f32 v66, v53, v66, v154
    v_fma_f32 v67, v53, v67, v155
    v_exp_f32 v152, v64
    s_waitcnt lgkmcnt(3)
    v_mfma_f32_32x32x16_bf16 v[80:95], v[200:203], v[128:131], v[80:95]
    ds_read_b128 v[148:151], v1 offset:39936
    v_exp_f32 v153, v65
    v_exp_f32 v154, v66
    v_exp_f32 v155, v67
    v_add_f32 v152, 1.0, v152
    v_add_f32 v153, 1.0, v153
    v_mfma_f32_32x32x16_bf16 v[80:95], v[204:207], v[132:135], v[80:95]
    ds_read_b128 v[128:131], v1 offset:40960
    v_add_f32 v154, 1.0, v154
    v_add_f32 v155, 1.0, v155
    v_rcp_f32 v152, v152
    v_rcp_f32 v153, v153
    buffer_load_dword v14, v9, s[4:7], 0 offen sc1
    s_waitcnt lgkmcnt(3)
    v_mfma_f32_32x32x16_bf16 v[80:95], v[208:211], v[136:139], v[80:95]
    ds_read_b128 v[132:135], v1 offset:41984
    v_rcp_f32 v154, v154
    v_rcp_f32 v155, v155
    v_mul_f32 v64, v64, v152
    v_mul_f32 v65, v65, v153
    v_mul_f32 v66, v66, v154
    v_mfma_f32_32x32x16_bf16 v[80:95], v[212:215], v[140:143], v[80:95]
    ds_read_b128 v[136:139], v1 offset:43008
    v_mul_f32 v67, v67, v155
    v_cvt_pk_bf16_f32 v160, v64, v65
    v_cvt_pk_bf16_f32 v161, v66, v67
    v_mul_f32 v152, v52, v36
    s_waitcnt lgkmcnt(3)
    v_mfma_f32_32x32x16_bf16 v[80:95], v[216:219], v[144:147], v[80:95]
    ds_read_b128 v[140:143], v1 offset:44032
    v_mul_f32 v153, v52, v37
    v_mul_f32 v154, v52, v38
    v_mul_f32 v155, v52, v39
    v_fma_f32 v68, v53, v68, v152
    v_mfma_f32_32x32x16_bf16 v[80:95], v[220:223], v[148:151], v[80:95]
    ds_read_b128 v[144:147], v1 offset:45056
    v_fma_f32 v69, v53, v69, v153
    v_fma_f32 v70, v53, v70, v154
    v_fma_f32 v71, v53, v71, v155
    v_exp_f32 v152, v68
    v_exp_f32 v153, v69
    s_waitcnt lgkmcnt(3)
    v_mfma_f32_32x32x16_bf16 v[80:95], v[224:227], v[128:131], v[80:95]
    ds_read_b128 v[148:151], v1 offset:46080
    v_exp_f32 v154, v70
    v_exp_f32 v155, v71
    v_add_f32 v152, 1.0, v152
    v_add_f32 v153, 1.0, v153
    v_mfma_f32_32x32x16_bf16 v[80:95], v[228:231], v[132:135], v[80:95]
    ds_read_b128 v[128:131], v1 offset:47104
    v_add_f32 v154, 1.0, v154
    v_add_f32 v155, 1.0, v155
    v_rcp_f32 v152, v152
    v_rcp_f32 v153, v153
    v_rcp_f32 v154, v154
    s_waitcnt lgkmcnt(3)
    v_mfma_f32_32x32x16_bf16 v[80:95], v[232:235], v[136:139], v[80:95]
    ds_read_b128 v[132:135], v1 offset:48128
    v_rcp_f32 v155, v155
    v_mul_f32 v68, v68, v152
    v_mul_f32 v69, v69, v153
    v_mul_f32 v70, v70, v154
    v_mfma_f32_32x32x16_bf16 v[80:95], v[236:239], v[140:143], v[80:95]
    ds_read_b128 v[136:139], v1 offset:49152
    v_mul_f32 v71, v71, v155
    v_cvt_pk_bf16_f32 v162, v68, v69
    v_cvt_pk_bf16_f32 v163, v70, v71
    s_add_u32 s30, s50, 229376
    buffer_store_dwordx4 v[160:163], v0, s[4:7], s30 offen
    s_waitcnt vmcnt(1)
    s_add_u32 s40, s3, 7
    v_subrev_u32 v14, s40, v14
    v_cmp_gt_u32 vcc, 16, v14
    s_nop 0
    s_andn2_b64 s[40:41], s[38:39], vcc
    s_cbranch_scc1 Lf_spin_34
Lf_back_35:
    s_add_u32 s60, s49, 0
    buffer_load_dwordx4 v[168:171], v0, s[4:7], s60 offen offset:0 sc1
    s_waitcnt lgkmcnt(3)
    v_mfma_f32_32x32x16_bf16 v[80:95], v[240:243], v[144:147], v[80:95]
    ds_read_b128 v[140:143], v1 offset:50176
    v_mul_f32 v152, v52, v40
    v_mul_f32 v153, v52, v41
    v_mul_f32 v154, v52, v42
    v_mul_f32 v155, v52, v43
    v_fma_f32 v72, v53, v72, v152
    buffer_load_dwordx4 v[172:175], v0, s[4:7], s60 offen offset:1024 sc1
    v_mfma_f32_32x32x16_bf16 v[80:95], v[244:247], v[148:151], v[80:95]
    ds_read_b128 v[144:147], v1 offset:51200
    v_fma_f32 v73, v53, v73, v153
    v_fma_f32 v74, v53, v74, v154
    v_fma_f32 v75, v53, v75, v155
    v_exp_f32 v152, v72
    s_waitcnt lgkmcnt(3)
    v_mfma_f32_32x32x16_bf16 v[80:95], v[248:251], v[128:131], v[80:95]
    ds_read_b128 v[148:151], v1 offset:52224
    v_exp_f32 v153, v73
    v_exp_f32 v154, v74
    v_exp_f32 v155, v75
    v_add_f32 v152, 1.0, v152
    v_add_f32 v153, 1.0, v153
    buffer_load_dwordx4 v[156:159], v0, s[4:7], s60 offen offset:2048 sc1
    v_mfma_f32_32x32x16_bf16 v[80:95], v[252:255], v[132:135], v[80:95]
    ds_read_b128 v[128:131], v1 offset:53248
    v_add_f32 v154, 1.0, v154
    v_add_f32 v155, 1.0, v155
    v_rcp_f32 v152, v152
    v_rcp_f32 v153, v153
    s_waitcnt lgkmcnt(3)
    v_mfma_f32_32x32x16_bf16 v[80:95], a[224:227], v[136:139], v[80:95]
    ds_read_b128 v[132:135], v1 offset:54272
    v_rcp_f32 v154, v154
    v_rcp_f32 v155, v155
    v_mul_f32 v72, v72, v152
    v_mul_f32 v73, v73, v153
    v_mul_f32 v74, v74, v154
    v_mfma_f32_32x32x16_bf16 v[80:95], a[228:231], v[140:143], v[80:95]
    ds_read_b128 v[136:139], v1 offset:55296
    v_mul_f32 v75, v75, v155
    v_cvt_pk_bf16_f32 v164, v72, v73
    v_cvt_pk_bf16_f32 v165, v74, v75
    v_mul_f32 v152, v52, v44
    s_waitcnt lgkmcnt(3)
    v_mfma_f32_32x32x16_bf16 v[80:95], a[232:235], v[144:147], v[80:95]
    ds_read_b128 v[140:143], v1 offset:56320
    v_mul_f32 v153, v52, v45
    v_mul_f32 v154, v52, v46
    v_mul_f32 v155, v52, v47
    v_fma_f32 v76, v53, v76, v152
    buffer_load_dwordx4 v[144:147], v0, s[4:7], s60 offen offset:3072 sc1
    v_mfma_f32_32x32x16_bf16 v[80:95], a[236:239], v[148:151], v[80:95]
    v_fma_f32 v77, v53, v77, v153
    v_fma_f32 v78, v53, v78, v154
    v_fma_f32 v79, v53, v79, v155
    v_exp_f32 v152, v76
    v_exp_f32 v153, v77
    s_add_u32 s60, s49, 4096
    buffer_load_dwordx4 v[148:151], v0, s[4:7], s60 offen offset:0 sc1
    s_waitcnt lgkmcnt(2)
    v_mfma_f32_32x32x16_bf16 v[80:95], a[240:243], v[128:131], v[80:95]
    v_exp_f32 v154, v78
    v_exp_f32 v155, v79
    v_add_f32 v152, 1.0, v152
    v_add_f32 v153, 1.0, v153
    buffer_load_dwordx4 v[128:131], v0, s[4:7], s60 offen offset:1024 sc1
    v_mfma_f32_32x32x16_bf16 v[80:95], a[244:247], v[132:135], v[80:95]
    v_add_f32 v154, 1.0, v154
    v_add_f32 v155, 1.0, v155
    v_rcp_f32 v152, v152
    v_rcp_f32 v153, v153
    v_rcp_f32 v154, v154
    s_waitcnt lgkmcnt(0)
    v_mfma_f32_32x32x16_bf16 v[80:95], a[248:251], v[136:139], v[80:95]
    v_rcp_f32 v155, v155
    v_mul_f32 v76, v76, v152
    v_mul_f32 v77, v77, v153
    v_mul_f32 v78, v78, v154
    buffer_load_dwordx4 v[132:135], v0, s[4:7], s60 offen offset:2048 sc1
    v_mfma_f32_32x32x16_bf16 v[80:95], a[252:255], v[140:143], v[80:95]
    v_mul_f32 v79, v79, v155
    v_cvt_pk_bf16_f32 v166, v76, v77
    v_cvt_pk_bf16_f32 v167, v78, v79
    s_add_u32 s30, s50, 229376
    buffer_store_dwordx4 v[164:167], v0, s[4:7], s30 offen offset:1024
    s_waitcnt vmcnt(7)
    v_mfma_f32_32x32x16_bf16 v[96:111], a[0:3], v[168:171], 0
    buffer_load_dwordx4 v[136:139], v0, s[4:7], s60 offen offset:3072 sc1
    v_mfma_f32_32x32x16_bf16 v[112:127], a[4:7], v[168:171], 0
    v_mul_f32 v152, v54, v32
    v_mul_f32 v153, v54, v33
    v_mul_f32 v154, v54, v34
    v_mul_f32 v155, v54, v35
    v_fma_f32 v80, v55, v80, v152
    v_fma_f32 v81, v55, v81, v153
    v_fma_f32 v82, v55, v82, v154
    v_fma_f32 v83, v55, v83, v155
    v_exp_f32 v152, v80
    s_waitcnt vmcnt(7)
    v_mfma_f32_32x32x16_bf16 v[96:111], a[8:11], v[172:175], v[96:111]
    v_exp_f32 v153, v81
    v_exp_f32 v154, v82
    v_exp_f32 v155, v83
    v_add_f32 v152, 1.0, v152
    v_add_f32 v153, 1.0, v153
    v_add_f32 v154, 1.0, v154
    v_add_f32 v155, 1.0, v155
    v_rcp_f32 v152, v152
    s_add_u32 s60, s49, 8192
    buffer_load_dwordx4 v[140:143], v0, s[4:7], s60 offen offset:0 sc1
    v_mfma_f32_32x32x16_bf16 v[112:127], a[12:15], v[172:175], v[112:127]
    v_rcp_f32 v153, v153
    v_rcp_f32 v154, v154
    v_rcp_f32 v155, v155
    v_mul_f32 v80, v80, v152
    v_mul_f32 v81, v81, v153
    v_mul_f32 v82, v82, v154
    v_mul_f32 v83, v83, v155
    v_cvt_pk_bf16_f32 v160, v80, v81
    s_waitcnt vmcnt(7)
    v_mfma_f32_32x32x16_bf16 v[96:111], a[16:19], v[156:159], v[96:111]
    v_cvt_pk_bf16_f32 v161, v82, v83
    v_mul_f32 v152, v54, v36
    v_mul_f32 v153, v54, v37
    v_mul_f32 v154, v54, v38
    v_mul_f32 v155, v54, v39
    v_fma_f32 v84, v55, v84, v152
    v_fma_f32 v85, v55, v85, v153
    v_fma_f32 v86, v55, v86, v154
    buffer_load_dwordx4 v[168:171], v0, s[4:7], s60 offen offset:1024 sc1
    v_mfma_f32_32x32x16_bf16 v[112:127], a[20:23], v[156:159], v[112:127]
    v_fma_f32 v87, v55, v87, v155
    v_exp_f32 v152, v84
    v_exp_f32 v153, v85
    v_exp_f32 v154, v86
    v_exp_f32 v155, v87
    v_add_f32 v152, 1.0, v152
    v_add_f32 v153, 1.0, v153
    v_add_f32 v154, 1.0, v154
    s_waitcnt vmcnt(7)
    v_mfma_f32_32x32x16_bf16 v[96:111], a[24:27], v[144:147], v[96:111]
    v_add_f32 v155, 1.0, v155
    v_rcp_f32 v152, v152
    v_rcp_f32 v153, v153
    v_rcp_f32 v154, v154
    v_rcp_f32 v155, v155
    v_mul_f32 v84, v84, v152
    v_mul_f32 v85, v85, v153
    v_mul_f32 v86, v86, v154
    buffer_load_dwordx4 v[172:175], v0, s[4:7], s60 offen offset:2048 sc1
    v_mfma_f32_32x32x16_bf16 v[112:127], a[28:31], v[144:147], v[112:127]
    v_mul_f32 v87, v87, v155
    v_cvt_pk_bf16_f32 v162, v84, v85
    v_cvt_pk_bf16_f32 v163, v86, v87
    s_add_u32 s30, s50, 344064
    buffer_store_dwordx4 v[160:163], v0, s[4:7], s30 offen
    v_mul_f32 v152, v54, v40
    v_mul_f32 v153, v54, v41
    v_mul_f32 v154, v54, v42
    v_mul_f32 v155, v54, v43
    v_fma_f32 v88, v55, v88, v152
    s_waitcnt vmcnt(8)
    v_mfma_f32_32x32x16_bf16 v[96:111], a[32:35], v[148:151], v[96:111]
    v_fma_f32 v89, v55, v89, v153
    v_fma_f32 v90, v55, v90, v154
    v_fma_f32 v91, v55, v91, v155
    v_exp_f32 v152, v88
    v_exp_f32 v153, v89
    v_exp_f32 v154, v90
    v_exp_f32 v155, v91
    v_add_f32 v152, 1.0, v152
    buffer_load_dwordx4 v[144:147], v0, s[4:7], s60 offen offset:3072 sc1
    v_mfma_f32_32x32x16_bf16 v[112:127], a[36:39], v[148:151], v[112:127]
    v_add_f32 v153, 1.0, v153
    v_add_f32 v154, 1.0, v154
    v_add_f32 v155, 1.0, v155
    v_rcp_f32 v152, v152
    v_rcp_f32 v153, v153
    v_rcp_f32 v154, v154
    v_rcp_f32 v155, v155
    v_mul_f32 v88, v88, v152
    s_waitcnt vmcnt(8)
    v_mfma_f32_32x32x16_bf16 v[96:111], a[40:43], v[128:131], v[96:111]
    v_mul_f32 v89, v89, v153
    v_mul_f32 v90, v90, v154
    v_mul_f32 v91, v91, v155
    v_cvt_pk_bf16_f32 v164, v88, v89
    v_cvt_pk_bf16_f32 v165, v90, v91
    v_mul_f32 v152, v54, v44
    v_mul_f32 v153, v54, v45
    v_mul_f32 v154, v54, v46
    s_add_u32 s60, s49, 12288
    buffer_load_dwordx4 v[148:151], v0, s[4:7], s60 offen offset:0 sc1
    v_mfma_f32_32x32x16_bf16 v[112:127], a[44:47], v[128:131], v[112:127]
    v_mul_f32 v155, v54, v47
    v_fma_f32 v92, v55, v92, v152
    v_fma_f32 v93, v55, v93, v153
    v_fma_f32 v94, v55, v94, v154
    v_fma_f32 v95, v55, v95, v155
    v_exp_f32 v152, v92
    v_exp_f32 v153, v93
    v_exp_f32 v154, v94
    s_waitcnt vmcnt(8)
    v_mfma_f32_32x32x16_bf16 v[96:111], a[48:51], v[132:135], v[96:111]
    v_exp_f32 v155, v95
    v_add_f32 v152, 1.0, v152
    v_add_f32 v153, 1.0, v153
    v_add_f32 v154, 1.0, v154
    v_add_f32 v155, 1.0, v155
    v_rcp_f32 v152, v152
    v_rcp_f32 v153, v153
    v_rcp_f32 v154, v154
    buffer_load_dwordx4 v[128:131], v0, s[4:7], s60 offen offset:1024 sc1
    v_mfma_f32_32x32x16_bf16 v[112:127], a[52:55], v[132:135], v[112:127]
    v_rcp_f32 v155, v155
    v_mul_f32 v92, v92, v152
    v_mul_f32 v93, v93, v153
    v_mul_f32 v94, v94, v154
    v_mul_f32 v95, v95, v155
    v_cvt_pk_bf16_f32 v166, v92, v93
    v_cvt_pk_bf16_f32 v167, v94, v95
    s_add_u32 s30, s50, 344064
    buffer_store_dwordx4 v[164:167], v0, s[4:7], s30 offen offset:1024
    s_waitcnt vmcnt(8)
    v_mfma_f32_32x32x16_bf16 v[96:111], a[56:59], v[136:139], v[96:111]
    buffer_load_dwordx4 v[132:135], v0, s[4:7], s60 offen offset:2048 sc1
    v_mfma_f32_32x32x16_bf16 v[112:127], a[60:63], v[136:139], v[112:127]
    s_waitcnt vmcnt(8)
    v_mfma_f32_32x32x16_bf16 v[96:111], a[64:67], v[140:143], v[96:111]
    buffer_load_dwordx4 v[136:139], v0, s[4:7], s60 offen offset:3072 sc1
    v_mfma_f32_32x32x16_bf16 v[112:127], a[68:71], v[140:143], v[112:127]
    s_waitcnt vmcnt(8)
    v_mfma_f32_32x32x16_bf16 v[96:111], a[72:75], v[168:171], v[96:111]
    s_add_u32 s60, s49, 16384
    buffer_load_dwordx4 v[140:143], v0, s[4:7], s60 offen offset:0 sc1
    v_mfma_f32_32x32x16_bf16 v[112:127], a[76:79], v[168:171], v[112:127]
    s_waitcnt vmcnt(8)
    v_mfma_f32_32x32x16_bf16 v[96:111], a[80:83], v[172:175], v[96:111]
    s_add_u32 s29, s3, 8
    v_mov_b32 v12, s29
    s_waitcnt vmcnt(3)
    buffer_store_dword v12, off, s[4:7], s34
    buffer_load_dwordx4 v[168:171], v0, s[4:7], s60 offen offset:1024 sc1
    v_mfma_f32_32x32x16_bf16 v[112:127], a[84:87], v[172:175], v[112:127]
    s_waitcnt vmcnt(8)
    v_mfma_f32_32x32x16_bf16 v[96:111], a[88:91], v[144:147], v[96:111]
    buffer_load_dwordx4 v[172:175], v0, s[4:7], s60 offen offset:2048 sc1
    v_mfma_f32_32x32x16_bf16 v[112:127], a[92:95], v[144:147], v[112:127]
    s_waitcnt vmcnt(8)
    v_mfma_f32_32x32x16_bf16 v[96:111], a[96:99], v[148:151], v[96:111]
    buffer_load_dwordx4 v[144:147], v0, s[4:7], s60 offen offset:3072 sc1
    v_mfma_f32_32x32x16_bf16 v[112:127], a[100:103], v[148:151], v[112:127]
    s_waitcnt vmcnt(8)
    v_mfma_f32_32x32x16_bf16 v[96:111], a[104:107], v[128:131], v[96:111]
    s_add_u32 s60, s49, 20480
    buffer_load_dwordx4 v[148:151], v0, s[4:7], s60 offen offset:0 sc1
    v_mfma_f32_32x32x16_bf16 v[112:127], a[108:111], v[128:131], v[112:127]
    s_waitcnt vmcnt(7)
    v_mfma_f32_32x32x16_bf16 v[96:111], a[112:115], v[132:135], v[96:111]
    buffer_load_dwordx4 v[128:131], v0, s[4:7], s60 offen offset:1024 sc1
    v_mfma_f32_32x32x16_bf16 v[112:127], a[116:119], v[132:135], v[112:127]
    s_waitcnt vmcnt(7)
    v_mfma_f32_32x32x16_bf16 v[96:111], a[120:123], v[136:139], v[96:111]
    buffer_load_dwordx4 v[132:135], v0, s[4:7], s60 offen offset:2048 sc1
    v_mfma_f32_32x32x16_bf16 v[112:127], a[124:127], v[136:139], v[112:127]
    buffer_load_dwordx4 v[136:139], v0, s[4:7], s60 offen offset:3072 sc1
    s_waitcnt vmcnt(8)
    v_mfma_f32_32x32x16_bf16 v[96:111], a[128:131], v[140:143], v[96:111]
    s_add_u32 s60, s49, 24576
    buffer_load_dwordx4 v[156:159], v0, s[4:7], s60 offen offset:0 sc1
    v_mfma_f32_32x32x16_bf16 v[112:127], a[132:135], v[140:143], v[112:127]
    buffer_load_dwordx4 v[140:143], v0, s[4:7], s60 offen offset:1024 sc1
    s_waitcnt vmcnt(8)
    v_mfma_f32_32x32x16_bf16 v[96:111], a[136:139], v[168:171], v[96:111]
    buffer_load_dwordx4 v[64:67], v0, s[4:7], s60 offen offset:2048 sc1
    v_mfma_f32_32x32x16_bf16 v[112:127], a[140:143], v[168:171], v[112:127]
    buffer_load_dwordx4 v[168:171], v0, s[4:7], s60 offen offset:3072 sc1
    s_waitcnt vmcnt(9)
    v_mfma_f32_32x32x16_bf16 v[96:111], a[144:147], v[172:175], v[96:111]
    buffer_load_dword v15, v9, s[4:7], 0 offen sc1
    v_mfma_f32_32x32x16_bf16 v[112:127], a[148:151], v[172:175], v[112:127]
    s_waitcnt vmcnt(9)
    v_mfma_f32_32x32x16_bf16 v[96:111], a[152:155], v[144:147], v[96:111]
    v_mfma_f32_32x32x16_bf16 v[112:127], a[156:159], v[144:147], v[112:127]
    s_waitcnt vmcnt(8)
    v_mfma_f32_32x32x16_bf16 v[96:111], a[160:163], v[148:151], v[96:111]
    v_mfma_f32_32x32x16_bf16 v[112:127], a[164:167], v[148:151], v[112:127]
    s_waitcnt vmcnt(7)
    v_mfma_f32_32x32x16_bf16 v[96:111], a[168:171], v[128:131], v[96:111]
    v_mfma_f32_32x32x16_bf16 v[112:127], a[172:175], v[128:131], v[112:127]
    s_waitcnt vmcnt(6)
    v_mfma_f32_32x32x16_bf16 v[96:111], a[176:179], v[132:135], v[96:111]
    s_waitcnt vmcnt(5)
    v_mfma_f32_32x32x16_bf16 v[96:111], a[184:187], v[136:139], v[96:111]
    s_waitcnt vmcnt(0)
    s_add_u32 s40, s3, 8
    v_subrev_u32 v15, s40, v15
    v_cmp_gt_u32 vcc, 16, v15
    s_nop 0
    s_andn2_b64 s[40:41], s[38:39], vcc
    s_cbranch_scc1 Lf_spin_37
Lf_back_38:
    s_add_u32 s60, s49, 229376
    buffer_load_dwordx4 v[128:131], v0, s[4:7], s60 offen offset:0 sc1
    buffer_load_dwordx4 v[144:147], v0, s[4:7], s60 offen offset:1024 sc1
    s_waitcnt vmcnt(6)
    v_mfma_f32_32x32x16_bf16 v[96:111], a[192:195], v[156:159], v[96:111]
    buffer_load_dwordx4 v[148:151], v0, s[4:7], s60 offen offset:2048 sc1
    s_waitcnt vmcnt(6)
    v_mfma_f32_32x32x16_bf16 v[96:111], a[200:203], v[140:143], v[96:111]
    s_waitcnt vmcnt(5)
    v_mfma_f32_32x32x16_bf16 v[96:111], a[208:211], v[64:67], v[96:111]
    buffer_load_dwordx4 v[172:175], v0, s[4:7], s60 offen offset:3072 sc1
    s_waitcnt vmcnt(5)
    v_mfma_f32_32x32x16_bf16 v[96:111], a[216:219], v[168:171], v[96:111]
    v_mfma_f32_32x32x16_bf16 v[112:127], a[180:183], v[132:135], v[112:127]
    s_add_u32 s60, s49, 233472
    buffer_load_dwordx4 v[132:135], v0, s[4:7], s60 offen offset:0 sc1
    v_mfma_f32_32x32x16_bf16 v[112:127], a[188:191], v[136:139], v[112:127]
    v_mfma_f32_32x32x16_bf16 v[112:127], a[196:199], v[156:159], v[112:127]
    buffer_load_dwordx4 v[136:139], v0, s[4:7], s60 offen offset:1024 sc1
    v_xor_b32 v58, 0, v6
    s_nop 4
    ds_write_b128 v58, v[96:99]
    v_mfma_f32_32x32x16_bf16 v[112:127], a[204:207], v[140:143], v[112:127]
    v_xor_b32 v59, 32, v6
    ds_write_b128 v59, v[100:103]
    v_mfma_f32_32x32x16_bf16 v[112:127], a[212:215], v[64:67], v[112:127]
    buffer_load_dwordx4 v[140:143], v0, s[4:7], s60 offen offset:2048 sc1
    v_xor_b32 v58, 64, v6
    ds_write_b128 v58, v[104:107]
    v_mfma_f32_32x32x16_bf16 v[112:127], a[220:223], v[168:171], v[112:127]
    v_xor_b32 v59, 96, v6
    ds_write_b128 v59, v[108:111]
    s_waitcnt vmcnt(6)
    v_mfma_f32_32x32x16_bf16 v[64:79], a[0:3], v[128:131], 0
    buffer_load_dwordx4 v[168:171], v0, s[4:7], s60 offen offset:3072 sc1
    v_mfma_f32_32x32x16_bf16 v[80:95], a[4:7], v[128:131], 0
    s_waitcnt vmcnt(6)
    v_mfma_f32_32x32x16_bf16 v[64:79], a[8:11], v[144:147], v[64:79]
    s_add_u32 s60, s49, 237568
    buffer_load_dwordx4 v[128:131], v0, s[4:7], s60 offen offset:0 sc1
    v_mfma_f32_32x32x16_bf16 v[80:95], a[12:15], v[144:147], v[80:95]
    v_xor_b32 v58, 128, v6
    s_nop 1
    ds_write_b128 v58, v[112:115]
    v_xor_b32 v59, 160, v6
    ds_write_b128 v59, v[116:119]
    s_waitcnt vmcnt(6)
    v_mfma_f32_32x32x16_bf16 v[64:79], a[16:19], v[148:151], v[64:79]
    buffer_load_dwordx4 v[144:147], v0, s[4:7], s60 offen offset:1024 sc1
    v_xor_b32 v58, 192, v6
    ds_write_b128 v58, v[120:123]
    v_mfma_f32_32x32x16_bf16 v[80:95], a[20:23], v[148:151], v[80:95]
    v_xor_b32 v59, 224, v6
    ds_write_b128 v59, v[124:127]
    s_waitcnt vmcnt(6)
    v_mfma_f32_32x32x16_bf16 v[64:79], a[24:27], v[172:175], v[64:79]
    buffer_load_dwordx4 v[148:151], v0, s[4:7], s60 offen offset:2048 sc1
    v_mfma_f32_32x32x16_bf16 v[80:95], a[28:31], v[172:175], v[80:95]
    s_waitcnt vmcnt(6)
    v_mfma_f32_32x32x16_bf16 v[64:79], a[32:35], v[132:135], v[64:79]
    buffer_load_dwordx4 v[172:175], v0, s[4:7], s60 offen offset:3072 sc1
    v_mfma_f32_32x32x16_bf16 v[80:95], a[36:39], v[132:135], v[80:95]
    s_waitcnt vmcnt(6)
    v_mfma_f32_32x32x16_bf16 v[64:79], a[40:43], v[136:139], v[64:79]
    s_add_u32 s60, s49, 241664
    buffer_load_dwordx4 v[132:135], v0, s[4:7], s60 offen offset:0 sc1
    v_mfma_f32_32x32x16_bf16 v[80:95], a[44:47], v[136:139], v[80:95]
    s_waitcnt lgkmcnt(0)
    s_barrier
    v_xor_b32 v58, 16, v7
    ds_read_b128 v[96:99], v7 offset:0
    ds_read_b128 v[100:103], v58 offset:0
    ds_read_b128 v[104:107], v7 offset:8192
    s_waitcnt vmcnt(6)
    v_mfma_f32_32x32x16_bf16 v[64:79], a[48:51], v[140:143], v[64:79]
    buffer_load_dwordx4 v[136:139], v0, s[4:7], s60 offen offset:1024 sc1
    ds_read_b128 v[108:111], v58 offset:8192
    ds_read_b128 v[112:115], v7 offset:16384
    ds_read_b128 v[116:119], v58 offset:16384
    ds_read_b128 v[120:123], v7 offset:24576
    ds_read_b128 v[124:127], v58 offset:24576
    v_mfma_f32_32x32x16_bf16 v[80:95], a[52:55], v[140:143], v[80:95]
    s_waitcnt vmcnt(6)
    v_mfma_f32_32x32x16_bf16 v[64:79], a[56:59], v[168:171], v[64:79]
    buffer_load_dwordx4 v[140:143], v0, s[4:7], s60 offen offset:2048 sc1
    v_lshlrev_b32 v160, 16, v16
    v_and_b32 v161, s46, v16
    v_lshlrev_b32 v162, 16, v17
    v_and_b32 v163, s46, v17
    v_lshlrev_b32 v164, 16, v18
    v_and_b32 v165, s46, v18
    v_lshlrev_b32 v166, 16, v19
    v_and_b32 v167, s46, v19
    s_waitcnt lgkmcnt(4)
    v_add_f32 v96, v96, v104
    v_mfma_f32_32x32x16_bf16 v[80:95], a[60:63], v[168:171], v[80:95]
    v_add_f32 v97, v97, v105
    v_add_f32 v98, v98, v106
    v_add_f32 v99, v99, v107
    v_add_f32 v100, v100, v108
    v_add_f32 v101, v101, v109
    v_add_f32 v102, v102, v110
    v_add_f32 v103, v103, v111
    s_waitcnt lgkmcnt(0)
    v_add_f32 v112, v112, v120
    v_add_f32 v113, v113, v121
    s_waitcnt vmcnt(6)
    v_mfma_f32_32x32x16_bf16 v[64:79], a[64:67], v[128:131], v[64:79]
    buffer_load_dwordx4 v[168:171], v0, s[4:7], s60 offen offset:3072 sc1
    v_add_f32 v114, v114, v122
    v_add_f32 v115, v115, v123
    v_add_f32 v116, v116, v124
    v_add_f32 v117, v117, v125
    v_add_f32 v118, v118, v126
    v_add_f32 v119, v119, v127
    v_add_f32 v96, v96, v112
    v_add_f32 v97, v97, v113
    v_add_f32 v98, v98, v114
    v_mfma_f32_32x32x16_bf16 v[80:95], a[68:71], v[128:131], v[80:95]
    v_add_f32 v99, v99, v115
    v_add_f32 v100, v100, v116
    v_add_f32 v101, v101, v117
    v_add_f32 v102, v102, v118
    v_add_f32 v103, v103, v119
    v_fmac_f32 v160, s61, v96
    v_fmac_f32 v161, s61, v97
    v_fmac_f32 v162, s61, v98
    v_fmac_f32 v163, s61, v99
    s_waitcnt vmcnt(6)
    v_mfma_f32_32x32x16_bf16 v[64:79], a[72:75], v[144:147], v[64:79]
    s_add_u32 s60, s49, 245760
    buffer_load_dwordx4 v[128:131], v0, s[4:7], s60 offen offset:0 sc1
    v_fmac_f32 v164, s61, v100
    v_fmac_f32 v165, s61, v101
    v_fmac_f32 v166, s61, v102
    v_fmac_f32 v167, s61, v103
    v_cvt_pk_bf16_f32 v16, v160, v161
    v_cvt_pk_bf16_f32 v17, v162, v163
    v_cvt_pk_bf16_f32 v18, v164, v165
    v_cvt_pk_bf16_f32 v19, v166, v167
    v_mfma_f32_32x32x16_bf16 v[80:95], a[76:79], v[144:147], v[80:95]
    s_waitcnt vmcnt(6)
    v_mfma_f32_32x32x16_bf16 v[64:79], a[80:83], v[148:151], v[64:79]
    buffer_load_dwordx4 v[144:147], v0, s[4:7], s60 offen offset:1024 sc1
    v_mfma_f32_32x32x16_bf16 v[80:95], a[84:87], v[148:151], v[80:95]
    s_waitcnt vmcnt(6)
    v_mfma_f32_32x32x16_bf16 v[64:79], a[88:91], v[172:175], v[64:79]
    buffer_load_dwordx4 v[148:151], v0, s[4:7], s60 offen offset:2048 sc1
    v_mfma_f32_32x32x16_bf16 v[80:95], a[92:95], v[172:175], v[80:95]
    s_waitcnt vmcnt(6)
    v_mfma_f32_32x32x16_bf16 v[64:79], a[96:99], v[132:135], v[64:79]
    buffer_load_dwordx4 v[172:175], v0, s[4:7], s60 offen offset:3072 sc1
    v_mfma_f32_32x32x16_bf16 v[80:95], a[100:103], v[132:135], v[80:95]
    s_waitcnt vmcnt(6)
    v_mfma_f32_32x32x16_bf16 v[64:79], a[104:107], v[136:139], v[64:79]
    s_add_u32 s60, s49, 249856
    buffer_load_dwordx4 v[132:135], v0, s[4:7], s60 offen offset:0 sc1
    v_mfma_f32_32x32x16_bf16 v[80:95], a[108:111], v[136:139], v[80:95]
    s_waitcnt vmcnt(6)
    v_mfma_f32_32x32x16_bf16 v[64:79], a[112:115], v[140:143], v[64:79]
    buffer_load_dwordx4 v[136:139], v0, s[4:7], s60 offen offset:1024 sc1
    s_barrier
    v_mfma_f32_32x32x16_bf16 v[80:95], a[116:119], v[140:143], v[80:95]
    s_waitcnt vmcnt(6)
    v_mfma_f32_32x32x16_bf16 v[64:79], a[120:123], v[168:171], v[64:79]
    buffer_load_dwordx4 v[140:143], v0, s[4:7], s60 offen offset:2048 sc1
    v_mfma_f32_32x32x16_bf16 v[80:95], a[124:127], v[168:171], v[80:95]
    buffer_load_dwordx4 v[168:171], v0, s[4:7], s60 offen offset:3072 sc1
    s_waitcnt vmcnt(7)
    v_mfma_f32_32x32x16_bf16 v[64:79], a[128:131], v[128:131], v[64:79]
    s_add_u32 s60, s49, 253952
    buffer_load_dwordx4 v[156:159], v0, s[4:7], s60 offen offset:0 sc1
    v_mfma_f32_32x32x16_bf16 v[80:95], a[132:135], v[128:131], v[80:95]
    buffer_load_dwordx4 v[128:131], v0, s[4:7], s60 offen offset:1024 sc1
    s_waitcnt vmcnt(8)
    v_mfma_f32_32x32x16_bf16 v[64:79], a[136:139], v[144:147], v[64:79]
    buffer_load_dwordx4 v[48:51], v0, s[4:7], s60 offen offset:2048 sc1
    v_mfma_f32_32x32x16_bf16 v[80:95], a[140:143], v[144:147], v[80:95]
    buffer_load_dwordx4 v[144:147], v0, s[4:7], s60 offen offset:3072 sc1
    s_waitcnt vmcnt(9)
    v_mfma_f32_32x32x16_bf16 v[64:79], a[144:147], v[148:151], v[64:79]
    v_mfma_f32_32x32x16_bf16 v[80:95], a[148:151], v[148:151], v[80:95]
    s_waitcnt vmcnt(8)
    v_mfma_f32_32x32x16_bf16 v[64:79], a[152:155], v[172:175], v[64:79]
    v_mfma_f32_32x32x16_bf16 v[80:95], a[156:159], v[172:175], v[80:95]
    s_waitcnt vmcnt(7)
    v_mfma_f32_32x32x16_bf16 v[64:79], a[160:163], v[132:135], v[64:79]
    v_mfma_f32_32x32x16_bf16 v[80:95], a[164:167], v[132:135], v[80:95]
    s_waitcnt vmcnt(6)
    v_mfma_f32_32x32x16_bf16 v[64:79], a[168:171], v[136:139], v[64:79]
    v_mfma_f32_32x32x16_bf16 v[80:95], a[172:175], v[136:139], v[80:95]
    s_waitcnt vmcnt(5)
    v_mfma_f32_32x32x16_bf16 v[64:79], a[176:179], v[140:143], v[64:79]
    s_waitcnt vmcnt(4)
    v_mfma_f32_32x32x16_bf16 v[64:79], a[184:187], v[168:171], v[64:79]
    s_waitcnt vmcnt(3)
    v_mfma_f32_32x32x16_bf16 v[64:79], a[192:195], v[156:159], v[64:79]
    s_mov_b32 s29, 0
    buffer_store_dwordx4 v[16:19], v8, s[12:15], s29 offen
    s_waitcnt vmcnt(3)
    v_mfma_f32_32x32x16_bf16 v[64:79], a[200:203], v[128:131], v[64:79]
    s_waitcnt vmcnt(2)
    v_mfma_f32_32x32x16_bf16 v[64:79], a[208:211], v[48:51], v[64:79]
    s_waitcnt vmcnt(1)
    v_mfma_f32_32x32x16_bf16 v[64:79], a[216:219], v[144:147], v[64:79]
    v_mfma_f32_32x32x16_bf16 v[80:95], a[180:183], v[140:143], v[80:95]
    v_mfma_f32_32x32x16_bf16 v[80:95], a[188:191], v[168:171], v[80:95]
    v_mfma_f32_32x32x16_bf16 v[80:95], a[196:199], v[156:159], v[80:95]
    v_xor_b32 v58, 0, v6
    s_nop 7
    ds_write_b128 v58, v[64:67]
    v_mfma_f32_32x32x16_bf16 v[80:95], a[204:207], v[128:131], v[80:95]
    v_xor_b32 v59, 32, v6
    ds_write_b128 v59, v[68:71]
    v_mfma_f32_32x32x16_bf16 v[80:95], a[212:215], v[48:51], v[80:95]
    v_xor_b32 v58, 64, v6
    ds_write_b128 v58, v[72:75]
    v_mfma_f32_32x32x16_bf16 v[80:95], a[220:223], v[144:147], v[80:95]
    v_xor_b32 v59, 96, v6
    ds_write_b128 v59, v[76:79]
    v_xor_b32 v58, 128, v6
    s_nop 8
    ds_write_b128 v58, v[80:83]
    v_xor_b32 v59, 160, v6
    ds_write_b128 v59, v[84:87]
    v_xor_b32 v58, 192, v6
    ds_write_b128 v58, v[88:91]
    v_xor_b32 v59, 224, v6
    ds_write_b128 v59, v[92:95]
    s_waitcnt lgkmcnt(0)
    s_barrier
    v_xor_b32 v58, 16, v7
    ds_read_b128 v[64:67], v7 offset:0
    ds_read_b128 v[68:71], v58 offset:0
    ds_read_b128 v[72:75], v7 offset:8192
    ds_read_b128 v[76:79], v58 offset:8192
    ds_read_b128 v[80:83], v7 offset:16384
    ds_read_b128 v[84:87], v58 offset:16384
    ds_read_b128 v[88:91], v7 offset:24576
    ds_read_b128 v[92:95], v58 offset:24576
    v_lshlrev_b32 v160, 16, v20
    v_and_b32 v161, s46, v20
    v_lshlrev_b32 v162, 16, v21
    v_and_b32 v163, s46, v21
    v_lshlrev_b32 v164, 16, v22
    v_and_b32 v165, s46, v22
    v_lshlrev_b32 v166, 16, v23
    v_and_b32 v167, s46, v23
    s_waitcnt lgkmcnt(4)
    v_add_f32 v64, v64, v72
    v_add_f32 v65, v65, v73
    v_add_f32 v66, v66, v74
    v_add_f32 v67, v67, v75
    v_add_f32 v68, v68, v76
    v_add_f32 v69, v69, v77
    v_add_f32 v70, v70, v78
    v_add_f32 v71, v71, v79
    s_waitcnt lgkmcnt(0)
    v_add_f32 v80, v80, v88
    v_add_f32 v81, v81, v89
    v_add_f32 v82, v82, v90
    v_add_f32 v83, v83, v91
    v_add_f32 v84, v84, v92
    v_add_f32 v85, v85, v93
    v_add_f32 v86, v86, v94
    v_add_f32 v87, v87, v95
    v_add_f32 v64, v64, v80
    v_add_f32 v65, v65, v81
    v_add_f32 v66, v66, v82
    v_add_f32 v67, v67, v83
    v_add_f32 v68, v68, v84
    v_add_f32 v69, v69, v85
    v_add_f32 v70, v70, v86
    v_add_f32 v71, v71, v87
    v_fmac_f32 v160, s61, v64
    v_fmac_f32 v161, s61, v65
    v_fmac_f32 v162, s61, v66
    v_fmac_f32 v163, s61, v67
    v_fmac_f32 v164, s61, v68
    v_fmac_f32 v165, s61, v69
    v_fmac_f32 v166, s61, v70
    v_fmac_f32 v167, s61, v71
    v_cvt_pk_bf16_f32 v20, v160, v161
    v_cvt_pk_bf16_f32 v21, v162, v163
    v_cvt_pk_bf16_f32 v22, v164, v165
    v_cvt_pk_bf16_f32 v23, v166, v167
    s_mov_b32 s29, 57344
    buffer_store_dwordx4 v[20:23], v8, s[12:15], s29 offen
L_end_farf:
    s_endpgm
L_spare:
    s_cmp_lg_u32 s63, 28
    s_cbranch_scc1 L_sp_nw
    s_cmp_lg_u32 s24, 2
    s_cbranch_scc1 L_sp_nw
    v_mov_b32 v132, v171
    s_getpc_b64 s[56:57]
Lpc_1:
    s_sub_u32 s56, s56, Lpc_1-L_code0
    s_subb_u32 s57, s57, 0
    v_lshlrev_b32 v132, 7, v132
    v_min_u32 v133, L_codeend-L_code0-4, v132
    global_load_dword v174, v133, s[56:57]
    v_add_u32 v132, 0x2000, v132
    v_min_u32 v133, L_codeend-L_code0-4, v132
    global_load_dword v174, v133, s[56:57]
    v_add_u32 v132, 0x2000, v132
    v_min_u32 v133, L_codeend-L_code0-4, v132
    global_load_dword v174, v133, s[56:57]
    v_add_u32 v132, 0x2000, v132
    v_min_u32 v133, L_codeend-L_code0-4, v132
    global_load_dword v174, v133, s[56:57]
    v_add_u32 v132, 0x2000, v132
    v_min_u32 v133, L_codeend-L_code0-4, v132
    global_load_dword v174, v133, s[56:57]
    v_add_u32 v132, 0x2000, v132
    v_min_u32 v133, L_codeend-L_code0-4, v132
    global_load_dword v174, v133, s[56:57]
    v_add_u32 v132, 0x2000, v132
L_sp_nw:
    s_sub_u32 s96, s63, 28
    s_lshl_b32 s96, s96, 2
    s_add_u32 s96, s96, s24
    s_mul_i32 s97, s62, 229376
    s_mul_i32 s98, s96, 14336
    s_add_u32 s97, s97, s98
    s_add_u32 s97, s97, 0
    v_lshlrev_b32 v12, 7, v171
    v_cmp_gt_u32 vcc, 48, v171
    s_nop 1
    v_cndmask_b32 v13, v9, v12, vcc
    buffer_load_dword v174, v12, s[4:7], s97 offen sc1
    s_add_u32 s97, s97, 8192
    buffer_load_dword v174, v13, s[4:7], s97 offen sc1
    s_waitcnt lgkmcnt(0)
    s_add_u32 s3, s3, 16
    s_cmp_lg_u32 s24, 0
    s_cbranch_scc1 L_aws
    s_lshl_b32 s98, s62, 7
    s_lshl_b32 s99, s63, 2
    s_add_u32 s98, s98, s99
    s_add_u32 s96, s98, 26220544
    s_add_u32 s99, s3, s88
    v_mov_b32 v147, s99
    buffer_store_dword v147, off, s[4:7], s96 sc0 sc1
L_aws:
    s_sub_u32 s96, s63, 28
    s_lshl_b32 s96, s96, 2
    s_add_u32 s96, s96, s24
    v_lshlrev_b32 v12, 7, v171
    v_mov_b32 v14, 0x7ffffff0
    v_cmp_gt_u32 vcc, 48, v171
    s_nop 1
    v_cndmask_b32 v13, v14, v12, vcc
    s_mul_i32 s97, s62, 229376
    s_mul_i32 s98, s96, 14336
    s_add_u32 s97, s97, s98
    s_add_u32 s97, s97, 6291456
    buffer_load_dword v174, v12, s[4:7], s97 offen sc1
    s_add_u32 s97, s97, 8192
    buffer_load_dword v174, v13, s[4:7], s97 offen sc1
    s_lshr_b32 s98, s96, 1
    s_lshl_b32 s98, s98, 18
    s_and_b32 s99, s96, 1
    s_lshl_b32 s99, s99, 13
    s_add_u32 s98, s98, s99
    s_lshl_b32 s99, s62, 14
    s_add_u32 s98, s98, s99
    s_add_u32 s97, s98, 25296896
    s_sub_u32 s98, s96, 4
    s_lshr_b32 s99, s98, 2
    s_lshl_b32 s99, s99, 18
    s_and_b32 s98, s98, 3
    s_lshl_b32 s98, s98, 13
    s_add_u32 s98, s98, s99
    s_lshl_b32 s99, s62, 15
    s_add_u32 s98, s98, s99
    s_add_u32 s98, s98, 25690112
    s_cmp_lt_u32 s96, 4
    s_cselect_b32 s97, s97, s98
    s_cmp_ge_u32 s96, 12
    s_cbranch_scc1 L_sp_nost
    buffer_load_dword v174, v12, s[4:7], s97 offen sc1
L_sp_nost:
    s_mul_i32 s97, s62, 917504
    s_mul_i32 s98, s96, 57344
    s_add_u32 s97, s97, s98
    s_add_u32 s97, s97, 8388608
    buffer_load_dword v174, v12, s[4:7], s97 offen sc1
    s_add_u32 s97, s97, 8192
    buffer_load_dword v174, v12, s[4:7], s97 offen sc1
    s_add_u32 s97, s97, 8192
    buffer_load_dword v174, v12, s[4:7], s97 offen sc1
    s_add_u32 s97, s97, 8192
    buffer_load_dword v174, v12, s[4:7], s97 offen sc1
    s_add_u32 s97, s97, 8192
    buffer_load_dword v174, v12, s[4:7], s97 offen sc1
    s_add_u32 s97, s97, 8192
    buffer_load_dword v174, v12, s[4:7], s97 offen sc1
    s_add_u32 s97, s97, 8192
    buffer_load_dword v174, v12, s[4:7], s97 offen sc1
    s_cmp_lg_u32 s63, 28
    s_cbranch_scc1 L_sp_end
    s_waitcnt vmcnt(0)
    v_mov_b32 v132, v171
    s_getpc_b64 s[56:57]
Lpc_2:
    s_sub_u32 s56, s56, Lpc_2-L_ffn0
    s_subb_u32 s57, s57, 0
    v_lshlrev_b32 v132, 7, v132
    v_min_u32 v133, L_codeend-L_ffn0-4, v132
    global_load_dword v174, v133, s[56:57]
    v_add_u32 v132, 0x2000, v132
    v_min_u32 v133, L_codeend-L_ffn0-4, v132
    global_load_dword v174, v133, s[56:57]
    v_add_u32 v132, 0x2000, v132
    v_min_u32 v133, L_codeend-L_ffn0-4, v132
    global_load_dword v174, v133, s[56:57]
    v_add_u32 v132, 0x2000, v132
    v_min_u32 v133, L_codeend-L_ffn0-4, v132
    global_load_dword v174, v133, s[56:57]
    v_add_u32 v132, 0x2000, v132
    v_min_u32 v133, L_codeend-L_ffn0-4, v132
    global_load_dword v174, v133, s[56:57]
    v_add_u32 v132, 0x2000, v132
L_sp_end:
    s_cmp_lg_u32 s2, 255
    s_cbranch_scc1 L_sp_fin
    s_cmp_lg_u32 s24, 0
    s_cbranch_scc1 L_sp_fin
    s_mov_b32 s30, 26220544
    s_add_u32 s31, s3, 1
    s_mov_b32 s55, 0
    v_lshlrev_b32 v12, 4, v171
L_sp_upd:
    buffer_load_dwordx4 v[16:19], v12, s[4:7], s30 offen sc1
    s_waitcnt vmcnt(0)
    v_subrev_u32 v16, s31, v16
    v_subrev_u32 v17, s31, v17
    v_subrev_u32 v18, s31, v18
    v_subrev_u32 v19, s31, v19
    v_max_u32 v16, v16, v17
    v_max_u32 v18, v18, v19
    v_max_u32 v16, v16, v18
    v_cmp_le_u32 vcc, 8, v16
    s_add_u32 s55, s55, 1
    s_and_b64 s[40:41], vcc, exec
    s_cbranch_scc0 L_sp_updok
    s_cmp_lt_u32 s55, 0x40000
    s_cbranch_scc1 L_sp_upd
L_sp_updok:
    v_mov_b32 v16, s3
    s_mov_b32 s30, 26218496
    buffer_store_dword v16, off, s[4:7], s30 sc0 sc1
L_sp_fin:
    s_endpgm
Lf_yspin_1:
    s_mov_b32 s55, 0
Lf_yloop_3:
    v_lshlrev_b32 v159, 3, v0
    v_and_b32 v159, 0xf80, v159
    buffer_load_dword v14, v159, s[4:7], s97 offen sc1
    s_waitcnt vmcnt(0)
    s_add_u32 s40, s3, 1
    v_cmp_ne_u32 vcc, s40, v14
    s_add_u32 s55, s55, 1
    s_and_b64 s[40:41], vcc, exec
    s_cbranch_scc0 Lf_yback_2
    s_cmp_lt_u32 s55, 262144
    s_cbranch_scc1 Lf_yloop_3
    s_branch Lf_yback_2
Lf_sspin_4:
    s_mov_b32 s55, 0
Lf_sloop_6:
    buffer_load_dwordx3 v[96:98], v2, s[4:7], s33 offen sc1
    s_waitcnt vmcnt(0)
    s_add_u32 s40, s3, 1
    v_cmp_eq_u32 vcc, s40, v98
    s_add_u32 s55, s55, 1
    s_andn2_b64 s[40:41], exec, vcc
    s_cbranch_scc0 Lf_sback_5
    s_cmp_lt_u32 s55, 262144
    s_cbranch_scc1 Lf_sloop_6
    s_branch Lf_sback_5
Lf_sspin_7:
    s_mov_b32 s55, 0
Lf_sloop_9:
    buffer_load_dwordx3 v[120:122], v2, s[4:7], s99 offen sc1
    s_waitcnt vmcnt(0)
    s_add_u32 s40, s3, 1
    v_cmp_eq_u32 vcc, s40, v122
    s_add_u32 s55, s55, 1
    s_andn2_b64 s[40:41], exec, vcc
    s_cbranch_scc0 Lf_sback_8
    s_cmp_lt_u32 s55, 262144
    s_cbranch_scc1 Lf_sloop_9
    s_branch Lf_sback_8
Lf_spin_10:
    s_mov_b32 s55, 0
Lf_loop_12:
    buffer_load_dword v13, v9, s[4:7], 0 offen sc1
    s_waitcnt vmcnt(0)
    s_add_u32 s40, s3, 1
    v_subrev_u32 v13, s40, v13
    v_cmp_gt_u32 vcc, 16, v13
    s_add_u32 s55, s55, 1
    s_andn2_b64 s[40:41], s[36:37], vcc
    s_cbranch_scc0 Lf_back_11
    s_cmp_lt_u32 s55, 262144
    s_cbranch_scc1 Lf_loop_12
    s_branch Lf_back_11
Lf_spin_13:
    s_mov_b32 s55, 0
Lf_loop_15:
    buffer_load_dword v13, v9, s[4:7], 0 offen sc1
    s_waitcnt vmcnt(0)
    s_add_u32 s40, s3, 2
    v_subrev_u32 v13, s40, v13
    v_cmp_gt_u32 vcc, 16, v13
    s_add_u32 s55, s55, 1
    s_andn2_b64 s[40:41], s[36:37], vcc
    s_cbranch_scc0 Lf_back_14
    s_cmp_lt_u32 s55, 262144
    s_cbranch_scc1 Lf_loop_15
    s_branch Lf_back_14
Lf_spin_16:
    s_mov_b32 s55, 0
Lf_loop_18:
    buffer_load_dword v14, v9, s[4:7], 0 offen sc1
    s_waitcnt vmcnt(0)
    s_add_u32 s40, s3, 3
    v_subrev_u32 v14, s40, v14
    v_cmp_gt_u32 vcc, 16, v14
    s_add_u32 s55, s55, 1
    s_andn2_b64 s[40:41], s[38:39], vcc
    s_cbranch_scc0 Lf_back_17
    s_cmp_lt_u32 s55, 262144
    s_cbranch_scc1 Lf_loop_18
    s_branch Lf_back_17
Lf_spin_19:
    s_mov_b32 s55, 0
Lf_loop_21:
    buffer_load_dword v15, v9, s[4:7], 0 offen sc1
    s_waitcnt vmcnt(0)
    s_add_u32 s40, s3, 4
    v_subrev_u32 v15, s40, v15
    v_cmp_gt_u32 vcc, 16, v15
    s_add_u32 s55, s55, 1
    s_andn2_b64 s[40:41], s[38:39], vcc
    s_cbranch_scc0 Lf_back_20
    s_cmp_lt_u32 s55, 262144
    s_cbranch_scc1 Lf_loop_21
    s_branch Lf_back_20
Lf_sspin_22:
    s_mov_b32 s55, 0
Lf_sloop_24:
    buffer_load_dwordx3 v[96:98], v2, s[4:7], s33 offen sc1
    s_waitcnt vmcnt(0)
    s_add_u32 s40, s3, 2
    v_cmp_eq_u32 vcc, s40, v98
    s_add_u32 s55, s55, 1
    s_andn2_b64 s[40:41], exec, vcc
    s_cbranch_scc0 Lf_sback_23
    s_cmp_lt_u32 s55, 262144
    s_cbranch_scc1 Lf_sloop_24
    s_branch Lf_sback_23
Lf_spin_25:
    s_mov_b32 s55, 0
Lf_loop_27:
    buffer_load_dword v13, v9, s[4:7], 0 offen sc1
    s_waitcnt vmcnt(0)
    s_add_u32 s40, s3, 5
    v_subrev_u32 v13, s40, v13
    v_cmp_gt_u32 vcc, 16, v13
    s_add_u32 s55, s55, 1
    s_andn2_b64 s[40:41], s[36:37], vcc
    s_cbranch_scc0 Lf_back_26
    s_cmp_lt_u32 s55, 262144
    s_cbranch_scc1 Lf_loop_27
    s_branch Lf_back_26
Lf_sspin_28:
    s_mov_b32 s55, 0
Lf_sloop_30:
    buffer_load_dwordx3 v[64:66], v2, s[4:7], s33 offen sc1
    s_waitcnt vmcnt(0)
    s_add_u32 s40, s3, 2
    v_cmp_eq_u32 vcc, s40, v66
    s_add_u32 s55, s55, 1
    s_andn2_b64 s[40:41], exec, vcc
    s_cbranch_scc0 Lf_sback_29
    s_cmp_lt_u32 s55, 262144
    s_cbranch_scc1 Lf_sloop_30
    s_branch Lf_sback_29
Lf_spin_31:
    s_mov_b32 s55, 0
Lf_loop_33:
    buffer_load_dword v13, v9, s[4:7], 0 offen sc1
    s_waitcnt vmcnt(0)
    s_add_u32 s40, s3, 6
    v_subrev_u32 v13, s40, v13
    v_cmp_gt_u32 vcc, 16, v13
    s_add_u32 s55, s55, 1
    s_andn2_b64 s[40:41], s[36:37], vcc
    s_cbranch_scc0 Lf_back_32
    s_cmp_lt_u32 s55, 262144
    s_cbranch_scc1 Lf_loop_33
    s_branch Lf_back_32
Lf_spin_34:
    s_mov_b32 s55, 0
Lf_loop_36:
    buffer_load_dword v14, v9, s[4:7], 0 offen sc1
    s_waitcnt vmcnt(0)
    s_add_u32 s40, s3, 7
    v_subrev_u32 v14, s40, v14
    v_cmp_gt_u32 vcc, 16, v14
    s_add_u32 s55, s55, 1
    s_andn2_b64 s[40:41], s[38:39], vcc
    s_cbranch_scc0 Lf_back_35
    s_cmp_lt_u32 s55, 262144
    s_cbranch_scc1 Lf_loop_36
    s_branch Lf_back_35
Lf_spin_37:
    s_mov_b32 s55, 0
Lf_loop_39:
    buffer_load_dword v15, v9, s[4:7], 0 offen sc1
    s_waitcnt vmcnt(0)
    s_add_u32 s40, s3, 8
    v_subrev_u32 v15, s40, v15
    v_cmp_gt_u32 vcc, 16, v15
    s_add_u32 s55, s55, 1
    s_andn2_b64 s[40:41], s[38:39], vcc
    s_cbranch_scc0 Lf_back_38
    s_cmp_lt_u32 s55, 262144
    s_cbranch_scc1 Lf_loop_39
    s_branch Lf_back_38
L_codeend:
L_far_slow:
    s_add_u32 m0, s56, 8192
    s_mov_b32 s59, 0
    buffer_load_dwordx4 v162, s[20:23], s59 offen lds
    v_mov_b32 v128, 0x3f803f80
    v_mov_b32 v129, 0x3f803f80
    v_mov_b32 v130, 0x3f803f80
    v_mov_b32 v131, 0x3f803f80
    s_add_u32 m0, s56, 9216
    s_mov_b32 s59, 7168
    buffer_load_dwordx4 v162, s[20:23], s59 offen lds
    s_add_u32 m0, s56, 10240
    s_mov_b32 s59, 14336
    buffer_load_dwordx4 v162, s[20:23], s59 offen lds
    s_add_u32 m0, s56, 11264
    s_mov_b32 s59, 21504
    buffer_load_dwordx4 v162, s[20:23], s59 offen lds
    v_mfma_f32_32x32x16_bf16 v[64:79], v[176:179], v[128:131], 0
    s_add_u32 m0, s56, 12288
    s_mov_b32 s59, 28672
    buffer_load_dwordx4 v162, s[20:23], s59 offen lds
    s_add_u32 m0, s56, 13312
    s_mov_b32 s59, 35840
    buffer_load_dwordx4 v162, s[20:23], s59 offen lds
    s_add_u32 m0, s56, 14336
    s_mov_b32 s59, 43008
    buffer_load_dwordx4 v162, s[20:23], s59 offen lds
    v_mfma_f32_32x32x16_bf16 v[64:79], v[180:183], v[128:131], v[64:79]
    s_add_u32 m0, s56, 15360
    s_mov_b32 s59, 50176
    buffer_load_dwordx4 v162, s[20:23], s59 offen lds
    s_add_u32 m0, s56, 16384
    s_mov_b32 s59, 57344
    buffer_load_dwordx4 v162, s[20:23], s59 offen lds
    s_add_u32 m0, s56, 17408
    s_mov_b32 s59, 64512
    buffer_load_dwordx4 v162, s[20:23], s59 offen lds
    v_mfma_f32_32x32x16_bf16 v[64:79], v[184:187], v[128:131], v[64:79]
    s_add_u32 m0, s56, 18432
    s_mov_b32 s59, 71680
    buffer_load_dwordx4 v162, s[20:23], s59 offen lds
    s_add_u32 m0, s56, 19456
    s_mov_b32 s59, 78848
    buffer_load_dwordx4 v162, s[20:23], s59 offen lds
    s_add_u32 m0, s56, 0
    s_mov_b32 s59, 86016
    buffer_load_dwordx4 v162, s[20:23], s59 offen lds
    v_mfma_f32_32x32x16_bf16 v[64:79], v[188:191], v[128:131], v[64:79]
    s_add_u32 m0, s56, 1024
    s_mov_b32 s59, 93184
    buffer_load_dwordx4 v162, s[20:23], s59 offen lds
    s_add_u32 m0, s56, 2048
    s_mov_b32 s59, 100352
    buffer_load_dwordx4 v162, s[20:23], s59 offen lds
    s_add_u32 m0, s56, 3072
    s_mov_b32 s59, 107520
    buffer_load_dwordx4 v162, s[20:23], s59 offen lds
    v_mfma_f32_32x32x16_bf16 v[64:79], v[192:195], v[128:131], v[64:79]
    v_dot2_f32_bf16 v152, v16, s54, 0
    v_dot2_f32_bf16 v153, v16, v16, 0
    v_dot2_f32_bf16 v152, v17, s54, v152
    v_mfma_f32_32x32x16_bf16 v[64:79], v[196:199], v[128:131], v[64:79]
    v_dot2_f32_bf16 v153, v17, v17, v153
    v_dot2_f32_bf16 v152, v18, s54, v152
    v_dot2_f32_bf16 v153, v18, v18, v153
    v_mfma_f32_32x32x16_bf16 v[64:79], v[200:203], v[128:131], v[64:79]
    v_dot2_f32_bf16 v152, v19, s54, v152
    v_dot2_f32_bf16 v153, v19, v19, v153
    s_nop 2
    v_permlane32_swap_b32 v152, v153
    v_mfma_f32_32x32x16_bf16 v[64:79], v[204:207], v[128:131], v[64:79]
    v_add_f32 v152, v152, v153
    v_mov_b32 v155, v152
    s_nop 1
    v_permlane16_swap_b32 v152, v155
    v_mfma_f32_32x32x16_bf16 v[64:79], v[208:211], v[128:131], v[64:79]
    v_add_f32 v152, v152, v155
    s_nop 1
    v_add_f32_dpp v152, v152, v152 row_ror:8 row_mask:0xf bank_mask:0xf
    v_mov_b32 v153, v152
    v_mfma_f32_32x32x16_bf16 v[64:79], v[212:215], v[128:131], v[64:79]
    s_nop 0
    v_permlane32_swap_b32 v152, v153
    v_cndmask_b32 v152, 0, v152, s[44:45]
    v_cndmask_b32 v153, 0, v153, s[44:45]
    v_mfma_f32_32x32x16_bf16 v[64:79], v[216:219], v[128:131], v[64:79]
    s_add_u32 s29, s3, 1
    v_mov_b32 v154, s29
    s_add_u32 s29, s35, 0
    s_mov_b64 exec, s[42:43]
    buffer_store_dwordx3 v[152:154], v11, s[4:7], s29 offen sc0 sc1
    s_mov_b64 exec, -1
    s_nop 0
    v_dot2_f32_bf16 v152, v20, s54, 0
    v_dot2_f32_bf16 v153, v20, v20, 0
    v_mfma_f32_32x32x16_bf16 v[64:79], v[220:223], v[128:131], v[64:79]
    v_dot2_f32_bf16 v152, v21, s54, v152
    v_dot2_f32_bf16 v153, v21, v21, v153
    v_dot2_f32_bf16 v152, v22, s54, v152
    v_mfma_f32_32x32x16_bf16 v[64:79], v[224:227], v[128:131], v[64:79]
    v_dot2_f32_bf16 v153, v22, v22, v153
    v_dot2_f32_bf16 v152, v23, s54, v152
    v_dot2_f32_bf16 v153, v23, v23, v153
    v_mfma_f32_32x32x16_bf16 v[64:79], v[228:231], v[128:131], v[64:79]
    s_nop 1
    v_permlane32_swap_b32 v152, v153
    v_add_f32 v152, v152, v153
    v_mov_b32 v155, v152
    v_mfma_f32_32x32x16_bf16 v[64:79], v[232:235], v[128:131], v[64:79]
    s_nop 0
    v_permlane16_swap_b32 v152, v155
    v_add_f32 v152, v152, v155
    s_nop 1
    v_add_f32_dpp v152, v152, v152 row_ror:8 row_mask:0xf bank_mask:0xf
    v_mfma_f32_32x32x16_bf16 v[64:79], v[236:239], v[128:131], v[64:79]
    v_mov_b32 v153, v152
    s_nop 1
    v_permlane32_swap_b32 v152, v153
    v_cndmask_b32 v152, 0, v152, s[44:45]
    v_mfma_f32_32x32x16_bf16 v[64:79], v[240:243], v[128:131], v[64:79]
    v_cndmask_b32 v153, 0, v153, s[44:45]
    s_add_u32 s29, s3, 1
    v_mov_b32 v154, s29
    s_add_u32 s29, s35, 8192
    s_mov_b64 exec, s[42:43]
    buffer_store_dwordx3 v[152:154], v11, s[4:7], s29 offen sc0 sc1
    s_mov_b64 exec, -1
    s_waitcnt vmcnt(14)
    v_mfma_f32_32x32x16_bf16 v[64:79], v[244:247], v[128:131], v[64:79]
    ds_read_b64_tr_b16 a[0:1], v168 offset:8192
    ds_read_b64_tr_b16 a[2:3], v168 offset:9216
    ds_read_b64_tr_b16 a[4:5], v169 offset:8192
    v_mfma_f32_32x32x16_bf16 v[64:79], v[248:251], v[128:131], v[64:79]
    ds_read_b64_tr_b16 a[6:7], v169 offset:9216
    ds_read_b64_tr_b16 a[8:9], v168 offset:10240
    ds_read_b64_tr_b16 a[10:11], v168 offset:11264
    v_mfma_f32_32x32x16_bf16 v[64:79], v[252:255], v[128:131], v[64:79]
    ds_read_b64_tr_b16 a[12:13], v169 offset:10240
    ds_read_b64_tr_b16 a[14:15], v169 offset:11264
    s_add_u32 m0, s56, 4096
    s_mov_b32 s59, 114688
    buffer_load_dwordx4 v162, s[20:23], s59 offen lds
    v_mfma_f32_32x32x16_bf16 v[64:79], a[224:227], v[128:131], v[64:79]
    s_add_u32 m0, s56, 5120
    s_mov_b32 s59, 121856
    buffer_load_dwordx4 v162, s[20:23], s59 offen lds
    s_add_u32 m0, s56, 6144
    s_mov_b32 s59, 129024
    buffer_load_dwordx4 v162, s[20:23], s59 offen lds
    s_add_u32 m0, s56, 7168
    s_mov_b32 s59, 136192
    buffer_load_dwordx4 v162, s[20:23], s59 offen lds
    v_mfma_f32_32x32x16_bf16 v[64:79], a[228:231], v[128:131], v[64:79]
    v_lshlrev_b32 v159, 3, v0
    v_and_b32 v159, 0xf80, v159
    buffer_load_dword v14, v159, s[4:7], s97 offen sc1
    s_waitcnt vmcnt(15)
    ds_read_b64_tr_b16 a[16:17], v168 offset:12288
    v_mfma_f32_32x32x16_bf16 v[64:79], a[232:235], v[128:131], v[64:79]
    ds_read_b64_tr_b16 a[18:19], v168 offset:13312
    ds_read_b64_tr_b16 a[20:21], v169 offset:12288
    ds_read_b64_tr_b16 a[22:23], v169 offset:13312
    v_mfma_f32_32x32x16_bf16 v[64:79], a[236:239], v[128:131], v[64:79]
    ds_read_b64_tr_b16 a[24:25], v168 offset:14336
    ds_read_b64_tr_b16 a[26:27], v168 offset:15360
    ds_read_b64_tr_b16 a[28:29], v169 offset:14336
    v_mfma_f32_32x32x16_bf16 v[64:79], a[240:243], v[128:131], v[64:79]
    ds_read_b64_tr_b16 a[30:31], v169 offset:15360
    s_waitcnt lgkmcnt(8)
    s_add_u32 m0, s56, 8192
    s_mov_b32 s59, 143360
    buffer_load_dwordx4 v162, s[20:23], s59 offen lds
    v_mfma_f32_32x32x16_bf16 v[64:79], a[244:247], v[128:131], v[64:79]
    s_add_u32 m0, s56, 9216
    s_mov_b32 s59, 150528
    buffer_load_dwordx4 v162, s[20:23], s59 offen lds
    s_add_u32 m0, s56, 10240
    s_mov_b32 s59, 157696
    buffer_load_dwordx4 v162, s[20:23], s59 offen lds
    s_add_u32 m0, s56, 11264
    s_mov_b32 s59, 164864
    buffer_load_dwordx4 v162, s[20:23], s59 offen lds
    v_mfma_f32_32x32x16_bf16 v[64:79], a[248:251], v[128:131], v[64:79]
    s_waitcnt vmcnt(15)
    ds_read_b64_tr_b16 a[32:33], v168 offset:16384
    ds_read_b64_tr_b16 a[34:35], v168 offset:17408
    v_mfma_f32_32x32x16_bf16 v[64:79], a[252:255], v[128:131], v[64:79]
    ds_read_b64_tr_b16 a[36:37], v169 offset:16384
    s_nop 10
    v_mov_b32 v32, v64
    v_mov_b32 v33, v65
    v_mov_b32 v34, v66
    v_mov_b32 v35, v67
    v_mov_b32 v36, v68
    v_mov_b32 v37, v69
    v_mov_b32 v38, v70
    v_mov_b32 v39, v71
    v_mov_b32 v40, v72
    v_mov_b32 v41, v73
    v_mov_b32 v42, v74
    v_mov_b32 v43, v75
    v_mov_b32 v44, v76
    v_mov_b32 v45, v77
    v_mov_b32 v46, v78
    v_mov_b32 v47, v79
    ds_read_b64_tr_b16 a[38:39], v169 offset:17408
    ds_read_b64_tr_b16 a[40:41], v168 offset:18432
    ds_read_b64_tr_b16 a[42:43], v168 offset:19456
    ds_read_b64_tr_b16 a[44:45], v169 offset:18432
    ds_read_b64_tr_b16 a[46:47], v169 offset:19456
    s_waitcnt lgkmcnt(8)
    s_add_u32 m0, s56, 12288
    s_mov_b32 s59, 172032
    buffer_load_dwordx4 v162, s[20:23], s59 offen lds
    s_add_u32 m0, s56, 13312
    s_mov_b32 s59, 179200
    buffer_load_dwordx4 v162, s[20:23], s59 offen lds
    s_add_u32 m0, s56, 14336
    s_mov_b32 s59, 186368
    buffer_load_dwordx4 v162, s[20:23], s59 offen lds
    s_add_u32 m0, s56, 15360
    s_mov_b32 s59, 193536
    buffer_load_dwordx4 v162, s[20:23], s59 offen lds
    s_waitcnt vmcnt(15)
    ds_read_b64_tr_b16 a[48:49], v168 offset:0
    ds_read_b64_tr_b16 a[50:51], v168 offset:1024
    ds_read_b64_tr_b16 a[52:53], v169 offset:0
    ds_read_b64_tr_b16 a[54:55], v169 offset:1024
    ds_read_b64_tr_b16 a[56:57], v168 offset:2048
    ds_read_b64_tr_b16 a[58:59], v168 offset:3072
    ds_read_b64_tr_b16 a[60:61], v169 offset:2048
    ds_read_b64_tr_b16 a[62:63], v169 offset:3072
    s_waitcnt lgkmcnt(8)
    s_add_u32 m0, s56, 16384
    s_mov_b32 s59, 200704
    buffer_load_dwordx4 v162, s[20:23], s59 offen lds
    s_add_u32 m0, s56, 17408
    s_mov_b32 s59, 207872
    buffer_load_dwordx4 v162, s[20:23], s59 offen lds
    s_add_u32 m0, s56, 18432
    s_mov_b32 s59, 215040
    buffer_load_dwordx4 v162, s[20:23], s59 offen lds
    s_add_u32 m0, s56, 19456
    s_mov_b32 s59, 222208
    buffer_load_dwordx4 v162, s[20:23], s59 offen lds
    s_waitcnt vmcnt(12)
    s_add_u32 s40, s3, 1
    v_cmp_ne_u32 vcc, s40, v14
    s_nop 0
    s_and_b64 s[40:41], vcc, exec
    s_cbranch_scc1 Ls_yspin_1
Ls_yback_2:
    s_mov_b32 s29, 0
    buffer_load_dword v24, v58, s[4:7], s29 offen sc1
    s_mov_b32 s29, 8192
    buffer_load_dword v25, v58, s[4:7], s29 offen sc1
    s_mov_b32 s29, 16384
    buffer_load_dword v26, v58, s[4:7], s29 offen sc1
    s_mov_b32 s29, 24576
    buffer_load_dword v27, v58, s[4:7], s29 offen sc1
    s_mov_b32 s29, 256
    buffer_load_dword v28, v58, s[4:7], s29 offen sc1
    s_mov_b32 s29, 8448
    buffer_load_dword v29, v58, s[4:7], s29 offen sc1
    s_mov_b32 s29, 16640
    buffer_load_dword v30, v58, s[4:7], s29 offen sc1
    s_mov_b32 s29, 24832
    buffer_load_dword v31, v58, s[4:7], s29 offen sc1
    s_add_u32 s33, s35, 0
    buffer_load_dwordx3 v[96:98], v2, s[4:7], s33 offen sc1
    s_add_u32 s99, s35, 8192
    buffer_load_dwordx3 v[120:122], v2, s[4:7], s99 offen sc1
    s_waitcnt vmcnt(23)
    ds_read_b64_tr_b16 a[64:65], v168 offset:4096
    ds_read_b64_tr_b16 a[66:67], v168 offset:5120
    ds_read_b64_tr_b16 a[68:69], v169 offset:4096
    ds_read_b64_tr_b16 a[70:71], v169 offset:5120
    ds_read_b64_tr_b16 a[72:73], v168 offset:6144
    ds_read_b64_tr_b16 a[74:75], v168 offset:7168
    ds_read_b64_tr_b16 a[76:77], v169 offset:6144
    ds_read_b64_tr_b16 a[78:79], v169 offset:7168
    s_waitcnt lgkmcnt(8)
    s_add_u32 m0, s56, 0
    s_mov_b32 s59, 229376
    buffer_load_dwordx4 v162, s[20:23], s59 offen lds
    s_add_u32 m0, s56, 1024
    s_mov_b32 s59, 236544
    buffer_load_dwordx4 v162, s[20:23], s59 offen lds
    s_add_u32 m0, s56, 2048
    s_mov_b32 s59, 243712
    buffer_load_dwordx4 v162, s[20:23], s59 offen lds
    s_add_u32 m0, s56, 3072
    s_mov_b32 s59, 250880
    buffer_load_dwordx4 v162, s[20:23], s59 offen lds
    s_waitcnt vmcnt(22)
    ds_read_b64_tr_b16 a[80:81], v168 offset:8192
    ds_read_b64_tr_b16 a[82:83], v168 offset:9216
    ds_read_b64_tr_b16 a[84:85], v169 offset:8192
    ds_read_b64_tr_b16 a[86:87], v169 offset:9216
    ds_read_b64_tr_b16 a[88:89], v168 offset:10240
    ds_read_b64_tr_b16 a[90:91], v168 offset:11264
    ds_read_b64_tr_b16 a[92:93], v169 offset:10240
    ds_read_b64_tr_b16 a[94:95], v169 offset:11264
    s_waitcnt lgkmcnt(8)
    s_add_u32 m0, s56, 4096
    s_mov_b32 s59, 258048
    buffer_load_dwordx4 v162, s[20:23], s59 offen lds
    s_add_u32 m0, s56, 5120
    s_mov_b32 s59, 265216
    buffer_load_dwordx4 v162, s[20:23], s59 offen lds
    s_add_u32 m0, s56, 6144
    s_mov_b32 s59, 272384
    buffer_load_dwordx4 v162, s[20:23], s59 offen lds
    s_add_u32 m0, s56, 7168
    s_mov_b32 s59, 279552
    buffer_load_dwordx4 v162, s[20:23], s59 offen lds
    s_waitcnt vmcnt(14)
    v_lshlrev_b32 v104, 16, v16
    v_and_b32 v105, s46, v16
    v_lshlrev_b32 v112, 16, v24
    v_and_b32 v113, s46, v24
    v_lshlrev_b32 v106, 16, v17
    v_and_b32 v107, s46, v17
    v_lshlrev_b32 v114, 16, v25
    v_and_b32 v115, s46, v25
    v_lshlrev_b32 v108, 16, v18
    v_and_b32 v109, s46, v18
    v_lshlrev_b32 v116, 16, v26
    v_and_b32 v117, s46, v26
    v_lshlrev_b32 v110, 16, v19
    v_and_b32 v111, s46, v19
    v_lshlrev_b32 v118, 16, v27
    v_and_b32 v119, s46, v27
    s_waitcnt vmcnt(9)
    s_add_u32 s40, s3, 1
    v_cmp_eq_u32 vcc, s40, v98
    s_nop 0
    s_andn2_b64 s[40:41], exec, vcc
    s_cbranch_scc1 Ls_sspin_4
Ls_sback_5:
    v_permlane32_swap_b32 v96, v97
    v_add_f32 v96, v96, v97
    v_mov_b32 v99, v96
    s_nop 1
    v_permlane16_swap_b32 v96, v99
    v_add_f32 v96, v96, v99
    s_nop 1
    v_add_f32_dpp v96, v96, v96 row_ror:8 row_mask:0xf bank_mask:0xf
    v_mov_b32 v99, v96
    s_nop 1
    v_permlane32_swap_b32 v96, v99
    v_mul_f32 v100, 0.002232142857142857, v96
    v_mul_f32 v99, 0.002232142857142857, v99
    v_fma_f32 v99, -v100, v100, v99
    v_max_f32 v99, 0, v99
    v_add_f32 v99, 0x3727c5ac, v99
    v_rsq_f32 v101, v99
    s_nop 0
    v_mul_f32 v112, v101, v112
    v_mul_f32 v113, v101, v113
    v_mul_f32 v114, v101, v114
    v_mul_f32 v115, v101, v115
    v_mul_f32 v116, v101, v116
    v_mul_f32 v117, v101, v117
    v_mul_f32 v118, v101, v118
    v_mul_f32 v119, v101, v119
    v_sub_f32 v96, v104, v100
    v_sub_f32 v97, v105, v100
    v_fmac_f32 v104, v96, v112
    v_fmac_f32 v105, v97, v113
    v_sub_f32 v96, v106, v100
    v_sub_f32 v97, v107, v100
    v_fmac_f32 v106, v96, v114
    v_fmac_f32 v107, v97, v115
    v_sub_f32 v96, v108, v100
    v_sub_f32 v97, v109, v100
    v_fmac_f32 v108, v96, v116
    v_fmac_f32 v109, v97, v117
    v_sub_f32 v96, v110, v100
    v_sub_f32 v97, v111, v100
    v_fmac_f32 v110, v96, v118
    v_fmac_f32 v111, v97, v119
    v_cvt_pk_bf16_f32 v16, v104, v105
    v_cvt_pk_bf16_f32 v17, v106, v107
    v_cvt_pk_bf16_f32 v18, v108, v109
    v_cvt_pk_bf16_f32 v19, v110, v111
    s_add_u32 s29, s48, 0
    buffer_store_dwordx4 v[16:19], v4, s[4:7], s29 offen sc0 sc1
    v_dot2_f32_bf16 v96, v16, s54, 0
    v_dot2_f32_bf16 v97, v16, v16, 0
    v_dot2_f32_bf16 v96, v17, s54, v96
    v_dot2_f32_bf16 v97, v17, v17, v97
    v_dot2_f32_bf16 v96, v18, s54, v96
    v_dot2_f32_bf16 v97, v18, v18, v97
    v_dot2_f32_bf16 v96, v19, s54, v96
    v_dot2_f32_bf16 v97, v19, v19, v97
    s_nop 2
    v_permlane32_swap_b32 v96, v97
    v_add_f32 v96, v96, v97
    v_mov_b32 v99, v96
    s_nop 1
    v_permlane16_swap_b32 v96, v99
    v_add_f32 v96, v96, v99
    s_nop 1
    v_add_f32_dpp v96, v96, v96 row_ror:8 row_mask:0xf bank_mask:0xf
    v_mov_b32 v97, v96
    s_nop 1
    v_permlane32_swap_b32 v96, v97
    v_cndmask_b32 v96, 0, v96, s[44:45]
    v_cndmask_b32 v97, 0, v97, s[44:45]
    s_add_u32 s29, s52, 131072
    s_mov_b64 exec, s[42:43]
    buffer_store_dwordx2 v[96:97], v3, s[4:7], s29 offen sc0 sc1
    s_mov_b64 exec, -1
    s_waitcnt vmcnt(24)
    ds_read_b64_tr_b16 a[96:97], v168 offset:12288
    ds_read_b64_tr_b16 a[98:99], v168 offset:13312
    ds_read_b64_tr_b16 a[100:101], v169 offset:12288
    ds_read_b64_tr_b16 a[102:103], v169 offset:13312
    ds_read_b64_tr_b16 a[104:105], v168 offset:14336
    ds_read_b64_tr_b16 a[106:107], v168 offset:15360
    ds_read_b64_tr_b16 a[108:109], v169 offset:14336
    ds_read_b64_tr_b16 a[110:111], v169 offset:15360
    s_waitcnt lgkmcnt(8)
    s_add_u32 m0, s56, 8192
    s_mov_b32 s59, 286720
    buffer_load_dwordx4 v162, s[20:23], s59 offen lds
    s_add_u32 m0, s56, 9216
    s_mov_b32 s59, 293888
    buffer_load_dwordx4 v162, s[20:23], s59 offen lds
    s_add_u32 m0, s56, 10240
    s_mov_b32 s59, 301056
    buffer_load_dwordx4 v162, s[20:23], s59 offen lds
    s_add_u32 m0, s56, 11264
    s_mov_b32 s59, 308224
    buffer_load_dwordx4 v162, s[20:23], s59 offen lds
    s_waitcnt vmcnt(16)
    v_lshlrev_b32 v128, 16, v20
    v_and_b32 v129, s46, v20
    v_lshlrev_b32 v136, 16, v28
    v_and_b32 v137, s46, v28
    v_lshlrev_b32 v130, 16, v21
    v_and_b32 v131, s46, v21
    v_lshlrev_b32 v138, 16, v29
    v_and_b32 v139, s46, v29
    v_lshlrev_b32 v132, 16, v22
    v_and_b32 v133, s46, v22
    v_lshlrev_b32 v140, 16, v30
    v_and_b32 v141, s46, v30
    v_lshlrev_b32 v134, 16, v23
    v_and_b32 v135, s46, v23
    v_lshlrev_b32 v142, 16, v31
    v_and_b32 v143, s46, v31
    s_waitcnt vmcnt(14)
    s_add_u32 s40, s3, 1
    v_cmp_eq_u32 vcc, s40, v122
    s_nop 0
    s_andn2_b64 s[40:41], exec, vcc
    s_cbranch_scc1 Ls_sspin_7
Ls_sback_8:
    v_permlane32_swap_b32 v120, v121
    v_add_f32 v120, v120, v121
    v_mov_b32 v123, v120
    s_nop 1
    v_permlane16_swap_b32 v120, v123
    v_add_f32 v120, v120, v123
    s_nop 1
    v_add_f32_dpp v120, v120, v120 row_ror:8 row_mask:0xf bank_mask:0xf
    v_mov_b32 v123, v120
    s_nop 1
    v_permlane32_swap_b32 v120, v123
    v_mul_f32 v124, 0.002232142857142857, v120
    v_mul_f32 v123, 0.002232142857142857, v123
    v_fma_f32 v123, -v124, v124, v123
    v_max_f32 v123, 0, v123
    v_add_f32 v123, 0x3727c5ac, v123
    v_rsq_f32 v125, v123
    s_nop 0
    v_mul_f32 v136, v125, v136
    v_mul_f32 v137, v125, v137
    v_mul_f32 v138, v125, v138
    v_mul_f32 v139, v125, v139
    v_mul_f32 v140, v125, v140
    v_mul_f32 v141, v125, v141
    v_mul_f32 v142, v125, v142
    v_mul_f32 v143, v125, v143
    v_sub_f32 v120, v128, v124
    v_sub_f32 v121, v129, v124
    v_fmac_f32 v128, v120, v136
    v_fmac_f32 v129, v121, v137
    v_sub_f32 v120, v130, v124
    v_sub_f32 v121, v131, v124
    v_fmac_f32 v130, v120, v138
    v_fmac_f32 v131, v121, v139
    s_add_u32 s29, s3, 1
    v_mov_b32 v12, s29
    s_waitcnt vmcnt(4)
    buffer_store_dword v12, off, s[4:7], s34 sc0 sc1
    v_sub_f32 v120, v132, v124
    v_sub_f32 v121, v133, v124
    v_fmac_f32 v132, v120, v140
    v_fmac_f32 v133, v121, v141
    v_sub_f32 v120, v134, v124
    v_sub_f32 v121, v135, v124
    v_fmac_f32 v134, v120, v142
    v_fmac_f32 v135, v121, v143
    v_cvt_pk_bf16_f32 v20, v128, v129
    v_cvt_pk_bf16_f32 v21, v130, v131
    v_cvt_pk_bf16_f32 v22, v132, v133
    v_cvt_pk_bf16_f32 v23, v134, v135
    s_add_u32 s29, s48, 57344
    buffer_store_dwordx4 v[20:23], v4, s[4:7], s29 offen sc0 sc1
    v_dot2_f32_bf16 v120, v20, s54, 0
    v_dot2_f32_bf16 v121, v20, v20, 0
    v_dot2_f32_bf16 v120, v21, s54, v120
    v_dot2_f32_bf16 v121, v21, v21, v121
    v_dot2_f32_bf16 v120, v22, s54, v120
    v_dot2_f32_bf16 v121, v22, v22, v121
    v_dot2_f32_bf16 v120, v23, s54, v120
    v_dot2_f32_bf16 v121, v23, v23, v121
    s_nop 2
    v_permlane32_swap_b32 v120, v121
    v_add_f32 v120, v120, v121
    v_mov_b32 v123, v120
    s_nop 1
    v_permlane16_swap_b32 v120, v123
    v_add_f32 v120, v120, v123
    s_nop 1
    v_add_f32_dpp v120, v120, v120 row_ror:8 row_mask:0xf bank_mask:0xf
    v_mov_b32 v121, v120
    s_nop 1
    v_permlane32_swap_b32 v120, v121
    v_cndmask_b32 v120, 0, v120, s[44:45]
    v_cndmask_b32 v121, 0, v121, s[44:45]
    s_add_u32 s29, s52, 135168
    s_mov_b64 exec, s[42:43]
    buffer_store_dwordx2 v[120:121], v3, s[4:7], s29 offen sc0 sc1
    s_mov_b64 exec, -1
    s_waitcnt vmcnt(27)
    ds_read_b64_tr_b16 a[112:113], v168 offset:16384
    ds_read_b64_tr_b16 a[114:115], v168 offset:17408
    ds_read_b64_tr_b16 a[116:117], v169 offset:16384
    ds_read_b64_tr_b16 a[118:119], v169 offset:17408
    ds_read_b64_tr_b16 a[120:121], v168 offset:18432
    ds_read_b64_tr_b16 a[122:123], v168 offset:19456
    ds_read_b64_tr_b16 a[124:125], v169 offset:18432
    ds_read_b64_tr_b16 a[126:127], v169 offset:19456
    s_waitcnt lgkmcnt(8)
    s_add_u32 m0, s56, 12288
    s_mov_b32 s59, 315392
    buffer_load_dwordx4 v162, s[20:23], s59 offen lds
    s_add_u32 m0, s56, 13312
    s_mov_b32 s59, 322560
    buffer_load_dwordx4 v162, s[20:23], s59 offen lds
    s_add_u32 m0, s56, 14336
    s_mov_b32 s59, 329728
    buffer_load_dwordx4 v162, s[20:23], s59 offen lds
    s_add_u32 m0, s56, 15360
    s_mov_b32 s59, 336896
    buffer_load_dwordx4 v162, s[20:23], s59 offen lds
    s_add_u32 s29, s3, 2
    v_mov_b32 v12, s29
    s_waitcnt vmcnt(4)
    buffer_store_dword v12, off, s[4:7], s34 sc0 sc1
    s_waitcnt vmcnt(18)
    ds_read_b64_tr_b16 a[128:129], v168 offset:0
    ds_read_b64_tr_b16 a[130:131], v168 offset:1024
    ds_read_b64_tr_b16 a[132:133], v169 offset:0
    ds_read_b64_tr_b16 a[134:135], v169 offset:1024
    ds_read_b64_tr_b16 a[136:137], v168 offset:2048
    ds_read_b64_tr_b16 a[138:139], v168 offset:3072
    ds_read_b64_tr_b16 a[140:141], v169 offset:2048
    ds_read_b64_tr_b16 a[142:143], v169 offset:3072
    s_waitcnt lgkmcnt(8)
    s_add_u32 m0, s56, 16384
    s_mov_b32 s59, 344064
    buffer_load_dwordx4 v162, s[20:23], s59 offen lds
    s_add_u32 m0, s56, 17408
    s_mov_b32 s59, 351232
    buffer_load_dwordx4 v162, s[20:23], s59 offen lds
    s_add_u32 m0, s56, 18432
    s_mov_b32 s59, 358400
    buffer_load_dwordx4 v162, s[20:23], s59 offen lds
    s_add_u32 m0, s56, 19456
    s_mov_b32 s59, 365568
    buffer_load_dwordx4 v162, s[20:23], s59 offen lds
    s_barrier
    buffer_load_dword v13, v9, s[4:7], 0 offen sc1
    s_waitcnt vmcnt(19)
    ds_read_b64_tr_b16 a[144:145], v168 offset:4096
    ds_read_b64_tr_b16 a[146:147], v168 offset:5120
    ds_read_b64_tr_b16 a[148:149], v169 offset:4096
    ds_read_b64_tr_b16 a[150:151], v169 offset:5120
    ds_read_b64_tr_b16 a[152:153], v168 offset:6144
    ds_read_b64_tr_b16 a[154:155], v168 offset:7168
    ds_read_b64_tr_b16 a[156:157], v169 offset:6144
    ds_read_b64_tr_b16 a[158:159], v169 offset:7168
    s_waitcnt lgkmcnt(8)
    s_add_u32 m0, s56, 0
    s_mov_b32 s59, 372736
    buffer_load_dwordx4 v162, s[20:23], s59 offen lds
    s_add_u32 m0, s56, 1024
    s_mov_b32 s59, 379904
    buffer_load_dwordx4 v162, s[20:23], s59 offen lds
    s_add_u32 m0, s56, 2048
    s_mov_b32 s59, 387072
    buffer_load_dwordx4 v162, s[20:23], s59 offen lds
    s_add_u32 m0, s56, 3072
    s_mov_b32 s59, 394240
    buffer_load_dwordx4 v162, s[20:23], s59 offen lds
    s_waitcnt vmcnt(17)
    ds_read_b64_tr_b16 a[160:161], v168 offset:8192
    ds_read_b64_tr_b16 a[162:163], v168 offset:9216
    ds_read_b64_tr_b16 a[164:165], v169 offset:8192
    ds_read_b64_tr_b16 a[166:167], v169 offset:9216
    ds_read_b64_tr_b16 a[168:169], v168 offset:10240
    ds_read_b64_tr_b16 a[170:171], v168 offset:11264
    ds_read_b64_tr_b16 a[172:173], v169 offset:10240
    ds_read_b64_tr_b16 a[174:175], v169 offset:11264
    s_waitcnt vmcnt(10)
    ds_read_b64_tr_b16 a[176:177], v168 offset:12288
    ds_read_b64_tr_b16 a[178:179], v168 offset:13312
    ds_read_b64_tr_b16 a[180:181], v169 offset:12288
    ds_read_b64_tr_b16 a[182:183], v169 offset:13312
    ds_read_b64_tr_b16 a[184:185], v168 offset:14336
    ds_read_b64_tr_b16 a[186:187], v168 offset:15360
    ds_read_b64_tr_b16 a[188:189], v169 offset:14336
    ds_read_b64_tr_b16 a[190:191], v169 offset:15360
    s_waitcnt vmcnt(4)
    s_add_u32 s40, s3, 1
    v_subrev_u32 v13, s40, v13
    v_cmp_gt_u32 vcc, 16, v13
    s_nop 0
    s_andn2_b64 s[40:41], s[36:37], vcc
    s_cbranch_scc1 Ls_spin_10
Ls_back_11:
    s_add_u32 m0, s53, 0
    s_add_u32 s57, s47, 0
    buffer_load_dwordx4 v0, s[4:7], s57 offen offset:0 sc1 lds
    s_add_u32 m0, s53, 0
    s_nop 0
    buffer_load_dwordx4 v0, s[4:7], s57 offen offset:1024 sc1 lds
    s_add_u32 m0, s53, 0
    s_nop 0
    buffer_load_dwordx4 v0, s[4:7], s57 offen offset:2048 sc1 lds
    s_add_u32 m0, s53, 0
    s_nop 0
    buffer_load_dwordx4 v0, s[4:7], s57 offen offset:3072 sc1 lds
    s_add_u32 m0, s53, 4096
    s_add_u32 s57, s47, 4096
    buffer_load_dwordx4 v0, s[4:7], s57 offen offset:0 sc1 lds
    s_add_u32 m0, s53, 4096
    s_nop 0
    buffer_load_dwordx4 v0, s[4:7], s57 offen offset:1024 sc1 lds
    s_add_u32 m0, s53, 4096
    s_nop 0
    buffer_load_dwordx4 v0, s[4:7], s57 offen offset:2048 sc1 lds
    s_add_u32 s58, s51, 131072
    buffer_load_dwordx4 v[112:115], v5, s[4:7], s58 offen offset:0 sc1
    buffer_load_dwordx4 v[116:119], v5, s[4:7], s58 offen offset:512 sc1
    buffer_load_dwordx4 v[120:123], v5, s[4:7], s58 offen offset:1024 sc1
    buffer_load_dwordx4 v[124:127], v5, s[4:7], s58 offen offset:1536 sc1
    s_waitcnt vmcnt(16)
    ds_read_b64_tr_b16 a[192:193], v168 offset:16384
    ds_read_b64_tr_b16 a[194:195], v168 offset:17408
    ds_read_b64_tr_b16 a[196:197], v169 offset:16384
    ds_read_b64_tr_b16 a[198:199], v169 offset:17408
    ds_read_b64_tr_b16 a[200:201], v168 offset:18432
    ds_read_b64_tr_b16 a[202:203], v168 offset:19456
    ds_read_b64_tr_b16 a[204:205], v169 offset:18432
    ds_read_b64_tr_b16 a[206:207], v169 offset:19456
    s_waitcnt vmcnt(11)
    ds_read_b64_tr_b16 a[208:209], v168 offset:0
    ds_read_b64_tr_b16 a[210:211], v168 offset:1024
    ds_read_b64_tr_b16 a[212:213], v169 offset:0
    ds_read_b64_tr_b16 a[214:215], v169 offset:1024
    ds_read_b64_tr_b16 a[216:217], v168 offset:2048
    ds_read_b64_tr_b16 a[218:219], v168 offset:3072
    ds_read_b64_tr_b16 a[220:221], v169 offset:2048
    ds_read_b64_tr_b16 a[222:223], v169 offset:3072
    s_waitcnt lgkmcnt(0)
    s_barrier
    s_add_u32 m0, s53, 28672
    s_add_u32 s57, s47, 28672
    buffer_load_dwordx4 v0, s[4:7], s57 offen offset:0 sc1 lds
    s_add_u32 m0, s53, 28672
    s_nop 0
    buffer_load_dwordx4 v0, s[4:7], s57 offen offset:1024 sc1 lds
    s_add_u32 m0, s53, 28672
    s_nop 0
    buffer_load_dwordx4 v0, s[4:7], s57 offen offset:2048 sc1 lds
    s_add_u32 m0, s53, 28672
    s_nop 0
    buffer_load_dwordx4 v0, s[4:7], s57 offen offset:3072 sc1 lds
    s_add_u32 m0, s53, 32768
    s_add_u32 s57, s47, 32768
    buffer_load_dwordx4 v0, s[4:7], s57 offen offset:0 sc1 lds
    s_add_u32 m0, s53, 32768
    s_nop 0
    buffer_load_dwordx4 v0, s[4:7], s57 offen offset:1024 sc1 lds
    s_add_u32 m0, s53, 32768
    s_nop 0
    buffer_load_dwordx4 v0, s[4:7], s57 offen offset:2048 sc1 lds
    s_waitcnt vmcnt(11)
    s_barrier
    ds_read_b128 v[128:131], v0 offset:0
    ds_read_b128 v[132:135], v0 offset:1024
    ds_read_b128 v[136:139], v0 offset:2048
    ds_read_b128 v[140:143], v0 offset:3072
    ds_read_b128 v[144:147], v0 offset:4096
    s_waitcnt lgkmcnt(3)
    v_mfma_f32_32x32x16_bf16 v[96:111], v[176:179], v[128:131], 0
    ds_read_b128 v[148:151], v0 offset:5120
    s_waitcnt vmcnt(7)
    v_add_f32 v58, v112, v114
    v_add_f32 v59, v113, v115
    v_add_f32 v60, v116, v118
    v_add_f32 v61, v117, v119
    v_mfma_f32_32x32x16_bf16 v[96:111], v[180:183], v[132:135], v[96:111]
    ds_read_b128 v[128:131], v0 offset:6144
    v_add_f32 v58, v58, v120
    v_add_f32 v59, v59, v121
    v_add_f32 v60, v60, v122
    s_waitcnt lgkmcnt(3)
    v_mfma_f32_32x32x16_bf16 v[96:111], v[184:187], v[136:139], v[96:111]
    ds_read_b128 v[132:135], v0 offset:7168
    v_add_f32 v61, v61, v123
    v_add_f32 v58, v58, v124
    v_add_f32 v59, v59, v125
    v_mfma_f32_32x32x16_bf16 v[96:111], v[188:191], v[140:143], v[96:111]
    ds_read_b128 v[136:139], v0 offset:8192
    v_add_f32 v58, v58, v60
    v_add_f32 v59, v59, v61
    v_mul_f32 v60, 0.002232142857142857, v58
    s_waitcnt lgkmcnt(3)
    v_mfma_f32_32x32x16_bf16 v[96:111], v[192:195], v[144:147], v[96:111]
    ds_read_b128 v[140:143], v0 offset:9216
    v_mul_f32 v59, 0.002232142857142857, v59
    v_fma_f32 v59, -v60, v60, v59
    v_max_f32 v59, 0, v59
    v_mfma_f32_32x32x16_bf16 v[96:111], v[196:199], v[148:151], v[96:111]
    ds_read_b128 v[144:147], v0 offset:10240
    v_add_f32 v59, 0x3727c5ac, v59
    v_rsq_f32 v61, v59
    s_nop 0
    v_mul_f32 v49, 0xbfb8aa3b, v61
    s_waitcnt lgkmcnt(3)
    v_mfma_f32_32x32x16_bf16 v[96:111], v[200:203], v[128:131], v[96:111]
    ds_read_b128 v[148:151], v0 offset:11264
    v_mul_f32 v48, v60, v49
    v_mov_b32 v51, v49
    v_sub_f32 v48, 0, v48
    buffer_load_dword v13, v9, s[4:7], 0 offen sc1
    v_mfma_f32_32x32x16_bf16 v[96:111], v[204:207], v[132:135], v[96:111]
    ds_read_b128 v[128:131], v0 offset:12288
    v_permlane32_swap_b32 v49, v51
    v_mov_b32 v50, v48
    s_nop 1
    v_permlane32_swap_b32 v48, v50
    s_waitcnt lgkmcnt(3)
    v_mfma_f32_32x32x16_bf16 v[96:111], v[208:211], v[136:139], v[96:111]
    ds_read_b128 v[132:135], v0 offset:13312
    v_mfma_f32_32x32x16_bf16 v[96:111], v[212:215], v[140:143], v[96:111]
    ds_read_b128 v[136:139], v0 offset:14336
    s_waitcnt lgkmcnt(3)
    v_mfma_f32_32x32x16_bf16 v[96:111], v[216:219], v[144:147], v[96:111]
    ds_read_b128 v[140:143], v0 offset:15360
    v_mfma_f32_32x32x16_bf16 v[96:111], v[220:223], v[148:151], v[96:111]
    ds_read_b128 v[144:147], v0 offset:16384
    s_waitcnt lgkmcnt(3)
    v_mfma_f32_32x32x16_bf16 v[96:111], v[224:227], v[128:131], v[96:111]
    ds_read_b128 v[148:151], v0 offset:17408
    v_mfma_f32_32x32x16_bf16 v[96:111], v[228:231], v[132:135], v[96:111]
    ds_read_b128 v[128:131], v0 offset:18432
    s_waitcnt lgkmcnt(3)
    v_mfma_f32_32x32x16_bf16 v[96:111], v[232:235], v[136:139], v[96:111]
    ds_read_b128 v[132:135], v0 offset:19456
    v_mfma_f32_32x32x16_bf16 v[96:111], v[236:239], v[140:143], v[96:111]
    ds_read_b128 v[136:139], v0 offset:20480
    s_waitcnt vmcnt(0)
    s_add_u32 s40, s3, 2
    v_subrev_u32 v13, s40, v13
    v_cmp_gt_u32 vcc, 16, v13
    s_nop 0
    s_andn2_b64 s[40:41], s[36:37], vcc
    s_cbranch_scc1 Ls_spin_13
Ls_back_14:
    s_waitcnt lgkmcnt(3)
    v_mfma_f32_32x32x16_bf16 v[96:111], v[240:243], v[144:147], v[96:111]
    ds_read_b128 v[140:143], v0 offset:21504
    v_mfma_f32_32x32x16_bf16 v[96:111], v[244:247], v[148:151], v[96:111]
    ds_read_b128 v[144:147], v0 offset:22528
    s_add_u32 m0, s53, 57344
    s_add_u32 s57, s47, 57344
    buffer_load_dwordx4 v0, s[4:7], s57 offen offset:0 sc1 lds
    s_waitcnt lgkmcnt(3)
    v_mfma_f32_32x32x16_bf16 v[96:111], v[248:251], v[128:131], v[96:111]
    ds_read_b128 v[148:151], v0 offset:23552
    s_add_u32 m0, s53, 57344
    s_nop 0
    buffer_load_dwordx4 v0, s[4:7], s57 offen offset:1024 sc1 lds
    v_mfma_f32_32x32x16_bf16 v[96:111], v[252:255], v[132:135], v[96:111]
    ds_read_b128 v[128:131], v0 offset:24576
    s_waitcnt lgkmcnt(3)
    v_mfma_f32_32x32x16_bf16 v[96:111], a[224:227], v[136:139], v[96:111]
    ds_read_b128 v[132:135], v0 offset:25600
    s_add_u32 m0, s53, 57344
    s_nop 0
    buffer_load_dwordx4 v0, s[4:7], s57 offen offset:2048 sc1 lds
    v_mfma_f32_32x32x16_bf16 v[96:111], a[228:231], v[140:143], v[96:111]
    ds_read_b128 v[136:139], v0 offset:26624
    s_waitcnt lgkmcnt(3)
    v_mfma_f32_32x32x16_bf16 v[96:111], a[232:235], v[144:147], v[96:111]
    ds_read_b128 v[140:143], v0 offset:27648
    s_add_u32 m0, s53, 57344
    s_nop 0
    buffer_load_dwordx4 v0, s[4:7], s57 offen offset:3072 sc1 lds
    v_mfma_f32_32x32x16_bf16 v[96:111], a[236:239], v[148:151], v[96:111]
    s_waitcnt vmcnt(5)
    s_barrier
    ds_read_b128 v[144:147], v0 offset:28672
    s_waitcnt lgkmcnt(3)
    v_mfma_f32_32x32x16_bf16 v[96:111], a[240:243], v[128:131], v[96:111]
    ds_read_b128 v[148:151], v0 offset:29696
    s_add_u32 m0, s53, 61440
    s_add_u32 s57, s47, 61440
    buffer_load_dwordx4 v0, s[4:7], s57 offen offset:0 sc1 lds
    v_mfma_f32_32x32x16_bf16 v[96:111], a[244:247], v[132:135], v[96:111]
    ds_read_b128 v[128:131], v0 offset:30720
    s_waitcnt lgkmcnt(3)
    v_mfma_f32_32x32x16_bf16 v[96:111], a[248:251], v[136:139], v[96:111]
    ds_read_b128 v[132:135], v0 offset:31744
    s_add_u32 m0, s53, 61440
    s_nop 0
    buffer_load_dwordx4 v0, s[4:7], s57 offen offset:1024 sc1 lds
    v_mfma_f32_32x32x16_bf16 v[96:111], a[252:255], v[140:143], v[96:111]
    ds_read_b128 v[136:139], v0 offset:32768
    s_waitcnt lgkmcnt(3)
    v_mfma_f32_32x32x16_bf16 v[112:127], v[176:179], v[144:147], 0
    ds_read_b128 v[140:143], v0 offset:33792
    s_add_u32 m0, s53, 61440
    s_nop 0
    buffer_load_dwordx4 v0, s[4:7], s57 offen offset:2048 sc1 lds
    v_mfma_f32_32x32x16_bf16 v[112:127], v[180:183], v[148:151], v[112:127]
    ds_read_b128 v[144:147], v0 offset:34816
    s_waitcnt lgkmcnt(3)
    v_mfma_f32_32x32x16_bf16 v[112:127], v[184:187], v[128:131], v[112:127]
    ds_read_b128 v[148:151], v0 offset:35840
    s_add_u32 m0, s53, 86016
    s_add_u32 s57, s47, 86016
    buffer_load_dwordx4 v0, s[4:7], s57 offen offset:0 sc1 lds
    v_mfma_f32_32x32x16_bf16 v[112:127], v[188:191], v[132:135], v[112:127]
    ds_read_b128 v[128:131], v0 offset:36864
    v_mul_f32 v152, v48, v32
    v_mul_f32 v153, v48, v33
    v_mul_f32 v154, v48, v34
    v_mul_f32 v155, v48, v35
    v_fma_f32 v96, v49, v96, v152
    s_waitcnt lgkmcnt(3)
    v_mfma_f32_32x32x16_bf16 v[112:127], v[192:195], v[136:139], v[112:127]
    ds_read_b128 v[132:135], v0 offset:37888
    s_add_u32 m0, s53, 86016
    s_nop 0
    buffer_load_dwordx4 v0, s[4:7], s57 offen offset:1024 sc1 lds
    v_fma_f32 v97, v49, v97, v153
    v_fma_f32 v98, v49, v98, v154
    v_fma_f32 v99, v49, v99, v155
    v_exp_f32 v152, v96
    v_mfma_f32_32x32x16_bf16 v[112:127], v[196:199], v[140:143], v[112:127]
    ds_read_b128 v[136:139], v0 offset:38912
    v_exp_f32 v153, v97
    v_exp_f32 v154, v98
    v_exp_f32 v155, v99
    v_add_f32 v152, 1.0, v152
    s_waitcnt lgkmcnt(3)
    v_mfma_f32_32x32x16_bf16 v[112:127], v[200:203], v[144:147], v[112:127]
    ds_read_b128 v[140:143], v0 offset:39936
    s_add_u32 m0, s53, 86016
    s_nop 0
    buffer_load_dwordx4 v0, s[4:7], s57 offen offset:2048 sc1 lds
    v_add_f32 v153, 1.0, v153
    v_add_f32 v154, 1.0, v154
    v_add_f32 v155, 1.0, v155
    v_rcp_f32 v152, v152
    v_mfma_f32_32x32x16_bf16 v[112:127], v[204:207], v[148:151], v[112:127]
    ds_read_b128 v[144:147], v0 offset:40960
    v_rcp_f32 v153, v153
    v_rcp_f32 v154, v154
    v_rcp_f32 v155, v155
    v_mul_f32 v96, v96, v152
    v_mul_f32 v97, v97, v153
    s_waitcnt lgkmcnt(3)
    v_mfma_f32_32x32x16_bf16 v[112:127], v[208:211], v[128:131], v[112:127]
    ds_read_b128 v[148:151], v0 offset:41984
    s_add_u32 m0, s53, 86016
    s_nop 0
    buffer_load_dwordx4 v0, s[4:7], s57 offen offset:3072 sc1 lds
    v_mul_f32 v98, v98, v154
    v_mul_f32 v99, v99, v155
    v_cvt_pk_bf16_f32 v160, v96, v97
    v_cvt_pk_bf16_f32 v161, v98, v99
    v_mfma_f32_32x32x16_bf16 v[112:127], v[212:215], v[132:135], v[112:127]
    ds_read_b128 v[128:131], v0 offset:43008
    v_mul_f32 v152, v48, v36
    v_mul_f32 v153, v48, v37
    v_mul_f32 v154, v48, v38
    v_mul_f32 v155, v48, v39
    s_waitcnt lgkmcnt(3)
    v_mfma_f32_32x32x16_bf16 v[112:127], v[216:219], v[136:139], v[112:127]
    ds_read_b128 v[132:135], v0 offset:44032
    s_add_u32 m0, s53, 90112
    s_add_u32 s57, s47, 90112
    buffer_load_dwordx4 v0, s[4:7], s57 offen offset:0 sc1 lds
    v_fma_f32 v100, v49, v100, v152
    v_fma_f32 v101, v49, v101, v153
    v_fma_f32 v102, v49, v102, v154
    v_fma_f32 v103, v49, v103, v155
    v_mfma_f32_32x32x16_bf16 v[112:127], v[220:223], v[140:143], v[112:127]
    ds_read_b128 v[136:139], v0 offset:45056
    v_exp_f32 v152, v100
    v_exp_f32 v153, v101
    v_exp_f32 v154, v102
    v_exp_f32 v155, v103
    v_add_f32 v152, 1.0, v152
    s_waitcnt lgkmcnt(3)
    v_mfma_f32_32x32x16_bf16 v[112:127], v[224:227], v[144:147], v[112:127]
    ds_read_b128 v[140:143], v0 offset:46080
    s_add_u32 m0, s53, 90112
    s_nop 0
    buffer_load_dwordx4 v0, s[4:7], s57 offen offset:1024 sc1 lds
    v_add_f32 v153, 1.0, v153
    v_add_f32 v154, 1.0, v154
    v_add_f32 v155, 1.0, v155
    v_rcp_f32 v152, v152
    v_mfma_f32_32x32x16_bf16 v[112:127], v[228:231], v[148:151], v[112:127]
    ds_read_b128 v[144:147], v0 offset:47104
    v_rcp_f32 v153, v153
    v_rcp_f32 v154, v154
    v_rcp_f32 v155, v155
    v_mul_f32 v100, v100, v152
    s_waitcnt lgkmcnt(3)
    v_mfma_f32_32x32x16_bf16 v[112:127], v[232:235], v[128:131], v[112:127]
    ds_read_b128 v[148:151], v0 offset:48128
    s_add_u32 m0, s53, 90112
    s_nop 0
    buffer_load_dwordx4 v0, s[4:7], s57 offen offset:2048 sc1 lds
    v_mul_f32 v101, v101, v153
    v_mul_f32 v102, v102, v154
    v_mul_f32 v103, v103, v155
    v_cvt_pk_bf16_f32 v162, v100, v101
    v_mfma_f32_32x32x16_bf16 v[112:127], v[236:239], v[132:135], v[112:127]
    ds_read_b128 v[128:131], v0 offset:49152
    v_cvt_pk_bf16_f32 v163, v102, v103
    s_add_u32 s30, s50, 0
    buffer_store_dwordx4 v[160:163], v0, s[4:7], s30 offen sc0 sc1
    v_mul_f32 v152, v48, v40
    v_mul_f32 v153, v48, v41
    v_mul_f32 v154, v48, v42
    s_waitcnt lgkmcnt(3)
    v_mfma_f32_32x32x16_bf16 v[112:127], v[240:243], v[136:139], v[112:127]
    ds_read_b128 v[132:135], v0 offset:50176
    v_mul_f32 v155, v48, v43
    v_fma_f32 v104, v49, v104, v152
    v_fma_f32 v105, v49, v105, v153
    v_fma_f32 v106, v49, v106, v154
    v_mfma_f32_32x32x16_bf16 v[112:127], v[244:247], v[140:143], v[112:127]
    ds_read_b128 v[136:139], v0 offset:51200
    v_fma_f32 v107, v49, v107, v155
    v_exp_f32 v152, v104
    v_exp_f32 v153, v105
    v_exp_f32 v154, v106
    s_waitcnt lgkmcnt(3)
    v_mfma_f32_32x32x16_bf16 v[112:127], v[248:251], v[144:147], v[112:127]
    ds_read_b128 v[140:143], v0 offset:52224
    v_exp_f32 v155, v107
    v_add_f32 v152, 1.0, v152
    v_add_f32 v153, 1.0, v153
    v_add_f32 v154, 1.0, v154
    v_mfma_f32_32x32x16_bf16 v[112:127], v[252:255], v[148:151], v[112:127]
    ds_read_b128 v[144:147], v0 offset:53248
    v_add_f32 v155, 1.0, v155
    v_rcp_f32 v152, v152
    v_rcp_f32 v153, v153
    v_rcp_f32 v154, v154
    v_rcp_f32 v155, v155
    s_waitcnt lgkmcnt(3)
    v_mfma_f32_32x32x16_bf16 v[112:127], a[224:227], v[128:131], v[112:127]
    ds_read_b128 v[148:151], v0 offset:54272
    v_mul_f32 v104, v104, v152
    v_mul_f32 v105, v105, v153
    v_mul_f32 v106, v106, v154
    v_mul_f32 v107, v107, v155
    v_mfma_f32_32x32x16_bf16 v[112:127], a[228:231], v[132:135], v[112:127]
    ds_read_b128 v[128:131], v0 offset:55296
    v_cvt_pk_bf16_f32 v164, v104, v105
    v_cvt_pk_bf16_f32 v165, v106, v107
    v_mul_f32 v152, v48, v44
    v_mul_f32 v153, v48, v45
    s_waitcnt lgkmcnt(3)
    v_mfma_f32_32x32x16_bf16 v[112:127], a[232:235], v[136:139], v[112:127]
    ds_read_b128 v[132:135], v0 offset:56320
    v_mul_f32 v154, v48, v46
    v_mul_f32 v155, v48, v47
    v_fma_f32 v108, v49, v108, v152
    v_fma_f32 v109, v49, v109, v153
    v_mfma_f32_32x32x16_bf16 v[112:127], a[236:239], v[140:143], v[112:127]
    s_waitcnt vmcnt(8)
    s_barrier
    ds_read_b128 v[136:139], v1 offset:0
    v_fma_f32 v110, v49, v110, v154
    v_fma_f32 v111, v49, v111, v155
    v_exp_f32 v152, v108
    v_exp_f32 v153, v109
    v_exp_f32 v154, v110
    s_waitcnt lgkmcnt(3)
    v_mfma_f32_32x32x16_bf16 v[112:127], a[240:243], v[144:147], v[112:127]
    ds_read_b128 v[140:143], v1 offset:1024
    v_exp_f32 v155, v111
    v_add_f32 v152, 1.0, v152
    v_add_f32 v153, 1.0, v153
    v_add_f32 v154, 1.0, v154
    v_mfma_f32_32x32x16_bf16 v[112:127], a[244:247], v[148:151], v[112:127]
    ds_read_b128 v[144:147], v1 offset:2048
    v_add_f32 v155, 1.0, v155
    v_rcp_f32 v152, v152
    v_rcp_f32 v153, v153
    v_rcp_f32 v154, v154
    s_waitcnt lgkmcnt(3)
    v_mfma_f32_32x32x16_bf16 v[112:127], a[248:251], v[128:131], v[112:127]
    ds_read_b128 v[148:151], v1 offset:3072
    v_rcp_f32 v155, v155
    v_mul_f32 v108, v108, v152
    v_mul_f32 v109, v109, v153
    v_mul_f32 v110, v110, v154
    v_mfma_f32_32x32x16_bf16 v[112:127], a[252:255], v[132:135], v[112:127]
    ds_read_b128 v[128:131], v1 offset:4096
    v_mul_f32 v111, v111, v155
    v_cvt_pk_bf16_f32 v166, v108, v109
    v_cvt_pk_bf16_f32 v167, v110, v111
    s_add_u32 s30, s50, 0
    buffer_store_dwordx4 v[164:167], v0, s[4:7], s30 offen offset:1024 sc0 sc1
    s_waitcnt lgkmcnt(3)
    v_mfma_f32_32x32x16_bf16 v[64:79], v[176:179], v[136:139], 0
    ds_read_b128 v[132:135], v1 offset:5120
    v_mfma_f32_32x32x16_bf16 v[64:79], v[180:183], v[140:143], v[64:79]
    ds_read_b128 v[136:139], v1 offset:6144
    s_waitcnt lgkmcnt(3)
    v_mfma_f32_32x32x16_bf16 v[64:79], v[184:187], v[144:147], v[64:79]
    ds_read_b128 v[140:143], v1 offset:7168
    v_mfma_f32_32x32x16_bf16 v[64:79], v[188:191], v[148:151], v[64:79]
    ds_read_b128 v[144:147], v1 offset:8192
    v_mul_f32 v152, v50, v32
    v_mul_f32 v153, v50, v33
    v_mul_f32 v154, v50, v34
    v_mul_f32 v155, v50, v35
    v_fma_f32 v112, v51, v112, v152
    v_fma_f32 v113, v51, v113, v153
    s_waitcnt lgkmcnt(3)
    v_mfma_f32_32x32x16_bf16 v[64:79], v[192:195], v[128:131], v[64:79]
    ds_read_b128 v[148:151], v1 offset:9216
    v_fma_f32 v114, v51, v114, v154
    v_fma_f32 v115, v51, v115, v155
    v_exp_f32 v152, v112
    v_exp_f32 v153, v113
    v_exp_f32 v154, v114
    v_mfma_f32_32x32x16_bf16 v[64:79], v[196:199], v[132:135], v[64:79]
    ds_read_b128 v[128:131], v1 offset:10240
    v_exp_f32 v155, v115
    v_add_f32 v152, 1.0, v152
    v_add_f32 v153, 1.0, v153
    v_add_f32 v154, 1.0, v154
    v_add_f32 v155, 1.0, v155
    s_waitcnt lgkmcnt(3)
    v_mfma_f32_32x32x16_bf16 v[64:79], v[200:203], v[136:139], v[64:79]
    ds_read_b128 v[132:135], v1 offset:11264
    v_rcp_f32 v152, v152
    v_rcp_f32 v153, v153
    v_rcp_f32 v154, v154
    v_rcp_f32 v155, v155
    v_mul_f32 v112, v112, v152
    v_mul_f32 v113, v113, v153
    v_mfma_f32_32x32x16_bf16 v[64:79], v[204:207], v[140:143], v[64:79]
    ds_read_b128 v[136:139], v1 offset:12288
    v_mul_f32 v114, v114, v154
    v_mul_f32 v115, v115, v155
    v_cvt_pk_bf16_f32 v160, v112, v113
    v_cvt_pk_bf16_f32 v161, v114, v115
    v_mul_f32 v152, v50, v36
    s_waitcnt lgkmcnt(3)
    v_mfma_f32_32x32x16_bf16 v[64:79], v[208:211], v[144:147], v[64:79]
    ds_read_b128 v[140:143], v1 offset:13312
    v_mul_f32 v153, v50, v37
    v_mul_f32 v154, v50, v38
    v_mul_f32 v155, v50, v39
    v_fma_f32 v116, v51, v116, v152
    v_fma_f32 v117, v51, v117, v153
    v_mfma_f32_32x32x16_bf16 v[64:79], v[212:215], v[148:151], v[64:79]
    ds_read_b128 v[144:147], v1 offset:14336
    v_fma_f32 v118, v51, v118, v154
    v_fma_f32 v119, v51, v119, v155
    v_exp_f32 v152, v116
    v_exp_f32 v153, v117
    v_exp_f32 v154, v118
    v_exp_f32 v155, v119
    s_waitcnt lgkmcnt(3)
    v_mfma_f32_32x32x16_bf16 v[64:79], v[216:219], v[128:131], v[64:79]
    ds_read_b128 v[148:151], v1 offset:15360
    v_add_f32 v152, 1.0, v152
    v_add_f32 v153, 1.0, v153
    v_add_f32 v154, 1.0, v154
    v_add_f32 v155, 1.0, v155
    v_rcp_f32 v152, v152
    v_mfma_f32_32x32x16_bf16 v[64:79], v[220:223], v[132:135], v[64:79]
    ds_read_b128 v[128:131], v1 offset:16384
    v_rcp_f32 v153, v153
    v_rcp_f32 v154, v154
    v_rcp_f32 v155, v155
    v_mul_f32 v116, v116, v152
    v_mul_f32 v117, v117, v153
    s_waitcnt lgkmcnt(3)
    v_mfma_f32_32x32x16_bf16 v[64:79], v[224:227], v[136:139], v[64:79]
    ds_read_b128 v[132:135], v1 offset:17408
    v_mul_f32 v118, v118, v154
    v_mul_f32 v119, v119, v155
    v_cvt_pk_bf16_f32 v162, v116, v117
    v_cvt_pk_bf16_f32 v163, v118, v119
    s_add_u32 s30, s50, 114688
    buffer_store_dwordx4 v[160:163], v0, s[4:7], s30 offen sc0 sc1
    v_mfma_f32_32x32x16_bf16 v[64:79], v[228:231], v[140:143], v[64:79]
    ds_read_b128 v[136:139], v1 offset:18432
    v_mul_f32 v152, v50, v40
    v_mul_f32 v153, v50, v41
    v_mul_f32 v154, v50, v42
    v_mul_f32 v155, v50, v43
    v_fma_f32 v120, v51, v120, v152
    v_fma_f32 v121, v51, v121, v153
    s_waitcnt lgkmcnt(3)
    v_mfma_f32_32x32x16_bf16 v[64:79], v[232:235], v[144:147], v[64:79]
    ds_read_b128 v[140:143], v1 offset:19456
    s_add_u32 s58, s51, 135168
    buffer_load_dwordx4 v[96:99], v5, s[4:7], s58 offen offset:0 sc1
    buffer_load_dwordx4 v[100:103], v5, s[4:7], s58 offen offset:512 sc1
    buffer_load_dwordx4 v[104:107], v5, s[4:7], s58 offen offset:1024 sc1
    buffer_load_dwordx4 v[108:111], v5, s[4:7], s58 offen offset:1536 sc1
    v_fma_f32 v122, v51, v122, v154
    v_fma_f32 v123, v51, v123, v155
    v_exp_f32 v152, v120
    v_exp_f32 v153, v121
    v_exp_f32 v154, v122
    v_mfma_f32_32x32x16_bf16 v[64:79], v[236:239], v[148:151], v[64:79]
    ds_read_b128 v[144:147], v1 offset:20480
    v_exp_f32 v155, v123
    v_add_f32 v152, 1.0, v152
    v_add_f32 v153, 1.0, v153
    v_add_f32 v154, 1.0, v154
    v_add_f32 v155, 1.0, v155
    s_waitcnt lgkmcnt(3)
    v_mfma_f32_32x32x16_bf16 v[64:79], v[240:243], v[128:131], v[64:79]
    ds_read_b128 v[148:151], v1 offset:21504
    v_rcp_f32 v152, v152
    v_rcp_f32 v153, v153
    v_rcp_f32 v154, v154
    v_rcp_f32 v155, v155
    v_mul_f32 v120, v120, v152
    v_mul_f32 v121, v121, v153
    v_mfma_f32_32x32x16_bf16 v[64:79], v[244:247], v[132:135], v[64:79]
    ds_read_b128 v[128:131], v1 offset:22528
    v_mul_f32 v122, v122, v154
    v_mul_f32 v123, v123, v155
    v_cvt_pk_bf16_f32 v164, v120, v121
    v_cvt_pk_bf16_f32 v165, v122, v123
    v_mul_f32 v152, v50, v44
    s_waitcnt lgkmcnt(3)
    v_mfma_f32_32x32x16_bf16 v[64:79], v[248:251], v[136:139], v[64:79]
    ds_read_b128 v[132:135], v1 offset:23552
    v_mul_f32 v153, v50, v45
    v_mul_f32 v154, v50, v46
    v_mul_f32 v155, v50, v47
    v_fma_f32 v124, v51, v124, v152
    v_fma_f32 v125, v51, v125, v153
    v_mfma_f32_32x32x16_bf16 v[64:79], v[252:255], v[140:143], v[64:79]
    ds_read_b128 v[136:139], v1 offset:24576
    v_fma_f32 v126, v51, v126, v154
    v_fma_f32 v127, v51, v127, v155
    v_exp_f32 v152, v124
    v_exp_f32 v153, v125
    v_exp_f32 v154, v126
    v_exp_f32 v155, v127
    s_waitcnt lgkmcnt(3)
    v_mfma_f32_32x32x16_bf16 v[64:79], a[224:227], v[144:147], v[64:79]
    ds_read_b128 v[140:143], v1 offset:25600
    v_add_f32 v152, 1.0, v152
    v_add_f32 v153, 1.0, v153
    v_add_f32 v154, 1.0, v154
    v_add_f32 v155, 1.0, v155
    v_rcp_f32 v152, v152
    v_mfma_f32_32x32x16_bf16 v[64:79], a[228:231], v[148:151], v[64:79]
    ds_read_b128 v[144:147], v1 offset:26624
    v_rcp_f32 v153, v153
    v_rcp_f32 v154, v154
    v_rcp_f32 v155, v155
    v_mul_f32 v124, v124, v152
    v_mul_f32 v125, v125, v153
    s_waitcnt lgkmcnt(3)
    v_mfma_f32_32x32x16_bf16 v[64:79], a[232:235], v[128:131], v[64:79]
    ds_read_b128 v[148:151], v1 offset:27648
    v_mul_f32 v126, v126, v154
    v_mul_f32 v127, v127, v155
    v_cvt_pk_bf16_f32 v166, v124, v125
    v_cvt_pk_bf16_f32 v167, v126, v127
    s_add_u32 s30, s50, 114688
    buffer_store_dwordx4 v[164:167], v0, s[4:7], s30 offen offset:1024 sc0 sc1
    v_mfma_f32_32x32x16_bf16 v[64:79], a[236:239], v[132:135], v[64:79]
    s_waitcnt vmcnt(8)
    s_barrier
    ds_read_b128 v[128:131], v1 offset:28672
    s_waitcnt lgkmcnt(3)
    v_mfma_f32_32x32x16_bf16 v[64:79], a[240:243], v[136:139], v[64:79]
    ds_read_b128 v[132:135], v1 offset:29696
    s_waitcnt vmcnt(1)
    v_add_f32 v58, v96, v98
    v_add_f32 v59, v97, v99
    v_add_f32 v60, v100, v102
    v_add_f32 v61, v101, v103
    v_mfma_f32_32x32x16_bf16 v[64:79], a[244:247], v[140:143], v[64:79]
    ds_read_b128 v[136:139], v1 offset:30720
    v_add_f32 v58, v58, v104
    v_add_f32 v59, v59, v105
    v_add_f32 v60, v60, v106
    v_add_f32 v61, v61, v107
    s_waitcnt lgkmcnt(3)
    v_mfma_f32_32x32x16_bf16 v[64:79], a[248:251], v[144:147], v[64:79]
    ds_read_b128 v[140:143], v1 offset:31744
    v_add_f32 v58, v58, v108
    v_add_f32 v59, v59, v109
    v_add_f32 v58, v58, v60
    v_mfma_f32_32x32x16_bf16 v[64:79], a[252:255], v[148:151], v[64:79]
    ds_read_b128 v[144:147], v1 offset:32768
    v_add_f32 v59, v59, v61
    v_mul_f32 v60, 0.002232142857142857, v58
    v_mul_f32 v59, 0.002232142857142857, v59
    v_fma_f32 v59, -v60, v60, v59
    s_waitcnt lgkmcnt(3)
    v_mfma_f32_32x32x16_bf16 v[80:95], v[176:179], v[128:131], 0
    ds_read_b128 v[148:151], v1 offset:33792
    v_max_f32 v59, 0, v59
    v_add_f32 v59, 0x3727c5ac, v59
    v_rsq_f32 v61, v59
    s_add_u32 s29, s3, 3
    v_mov_b32 v12, s29
    s_waitcnt vmcnt(0)
    buffer_store_dword v12, off, s[4:7], s34 sc0 sc1
    v_mfma_f32_32x32x16_bf16 v[80:95], v[180:183], v[132:135], v[80:95]
    ds_read_b128 v[128:131], v1 offset:34816
    v_mul_f32 v53, 0xbfb8aa3b, v61
    v_mul_f32 v52, v60, v53
    v_mov_b32 v55, v53
    v_sub_f32 v52, 0, v52
    s_waitcnt lgkmcnt(3)
    v_mfma_f32_32x32x16_bf16 v[80:95], v[184:187], v[136:139], v[80:95]
    ds_read_b128 v[132:135], v1 offset:35840
    v_permlane32_swap_b32 v53, v55
    v_mov_b32 v54, v52
    s_nop 1
    v_permlane32_swap_b32 v52, v54
    v_mfma_f32_32x32x16_bf16 v[80:95], v[188:191], v[140:143], v[80:95]
    ds_read_b128 v[136:139], v1 offset:36864
    s_waitcnt lgkmcnt(3)
    v_mfma_f32_32x32x16_bf16 v[80:95], v[192:195], v[144:147], v[80:95]
    ds_read_b128 v[140:143], v1 offset:37888
    v_mul_f32 v152, v52, v32
    v_mul_f32 v153, v52, v33
    v_mul_f32 v154, v52, v34
    v_mul_f32 v155, v52, v35
    v_fma_f32 v64, v53, v64, v152
    v_mfma_f32_32x32x16_bf16 v[80:95], v[196:199], v[148:151], v[80:95]
    ds_read_b128 v[144:147], v1 offset:38912
    v_fma_f32 v65, v53, v65, v153
    v_fma_f32 v66, v53, v66, v154
    v_fma_f32 v67, v53, v67, v155
    v_exp_f32 v152, v64
    s_waitcnt lgkmcnt(3)
    v_mfma_f32_32x32x16_bf16 v[80:95], v[200:203], v[128:131], v[80:95]
    ds_read_b128 v[148:151], v1 offset:39936
    v_exp_f32 v153, v65
    v_exp_f32 v154, v66
    v_exp_f32 v155, v67
    v_add_f32 v152, 1.0, v152
    v_add_f32 v153, 1.0, v153
    v_mfma_f32_32x32x16_bf16 v[80:95], v[204:207], v[132:135], v[80:95]
    ds_read_b128 v[128:131], v1 offset:40960
    v_add_f32 v154, 1.0, v154
    v_add_f32 v155, 1.0, v155
    v_rcp_f32 v152, v152
    v_rcp_f32 v153, v153
    buffer_load_dword v14, v9, s[4:7], 0 offen sc1
    s_waitcnt lgkmcnt(3)
    v_mfma_f32_32x32x16_bf16 v[80:95], v[208:211], v[136:139], v[80:95]
    ds_read_b128 v[132:135], v1 offset:41984
    v_rcp_f32 v154, v154
    v_rcp_f32 v155, v155
    v_mul_f32 v64, v64, v152
    v_mul_f32 v65, v65, v153
    v_mul_f32 v66, v66, v154
    v_mfma_f32_32x32x16_bf16 v[80:95], v[212:215], v[140:143], v[80:95]
    ds_read_b128 v[136:139], v1 offset:43008
    v_mul_f32 v67, v67, v155
    v_cvt_pk_bf16_f32 v160, v64, v65
    v_cvt_pk_bf16_f32 v161, v66, v67
    v_mul_f32 v152, v52, v36
    s_waitcnt lgkmcnt(3)
    v_mfma_f32_32x32x16_bf16 v[80:95], v[216:219], v[144:147], v[80:95]
    ds_read_b128 v[140:143], v1 offset:44032
    v_mul_f32 v153, v52, v37
    v_mul_f32 v154, v52, v38
    v_mul_f32 v155, v52, v39
    v_fma_f32 v68, v53, v68, v152
    v_mfma_f32_32x32x16_bf16 v[80:95], v[220:223], v[148:151], v[80:95]
    ds_read_b128 v[144:147], v1 offset:45056
    v_fma_f32 v69, v53, v69, v153
    v_fma_f32 v70, v53, v70, v154
    v_fma_f32 v71, v53, v71, v155
    v_exp_f32 v152, v68
    v_exp_f32 v153, v69
    s_waitcnt lgkmcnt(3)
    v_mfma_f32_32x32x16_bf16 v[80:95], v[224:227], v[128:131], v[80:95]
    ds_read_b128 v[148:151], v1 offset:46080
    v_exp_f32 v154, v70
    v_exp_f32 v155, v71
    v_add_f32 v152, 1.0, v152
    v_add_f32 v153, 1.0, v153
    v_mfma_f32_32x32x16_bf16 v[80:95], v[228:231], v[132:135], v[80:95]
    ds_read_b128 v[128:131], v1 offset:47104
    v_add_f32 v154, 1.0, v154
    v_add_f32 v155, 1.0, v155
    v_rcp_f32 v152, v152
    v_rcp_f32 v153, v153
    v_rcp_f32 v154, v154
    s_waitcnt lgkmcnt(3)
    v_mfma_f32_32x32x16_bf16 v[80:95], v[232:235], v[136:139], v[80:95]
    ds_read_b128 v[132:135], v1 offset:48128
    v_rcp_f32 v155, v155
    v_mul_f32 v68, v68, v152
    v_mul_f32 v69, v69, v153
    v_mul_f32 v70, v70, v154
    v_mfma_f32_32x32x16_bf16 v[80:95], v[236:239], v[140:143], v[80:95]
    ds_read_b128 v[136:139], v1 offset:49152
    v_mul_f32 v71, v71, v155
    v_cvt_pk_bf16_f32 v162, v68, v69
    v_cvt_pk_bf16_f32 v163, v70, v71
    s_add_u32 s30, s50, 229376
    buffer_store_dwordx4 v[160:163], v0, s[4:7], s30 offen sc0 sc1
    s_waitcnt vmcnt(1)
    s_add_u32 s40, s3, 3
    v_subrev_u32 v14, s40, v14
    v_cmp_gt_u32 vcc, 16, v14
    s_nop 0
    s_andn2_b64 s[40:41], s[38:39], vcc
    s_cbranch_scc1 Ls_spin_16
Ls_back_17:
    s_add_u32 s60, s49, 0
    buffer_load_dwordx4 v[168:171], v0, s[4:7], s60 offen offset:0 sc1
    s_waitcnt lgkmcnt(3)
    v_mfma_f32_32x32x16_bf16 v[80:95], v[240:243], v[144:147], v[80:95]
    ds_read_b128 v[140:143], v1 offset:50176
    v_mul_f32 v152, v52, v40
    v_mul_f32 v153, v52, v41
    v_mul_f32 v154, v52, v42
    v_mul_f32 v155, v52, v43
    v_fma_f32 v72, v53, v72, v152
    buffer_load_dwordx4 v[172:175], v0, s[4:7], s60 offen offset:1024 sc1
    v_mfma_f32_32x32x16_bf16 v[80:95], v[244:247], v[148:151], v[80:95]
    ds_read_b128 v[144:147], v1 offset:51200
    v_fma_f32 v73, v53, v73, v153
    v_fma_f32 v74, v53, v74, v154
    v_fma_f32 v75, v53, v75, v155
    v_exp_f32 v152, v72
    s_waitcnt lgkmcnt(3)
    v_mfma_f32_32x32x16_bf16 v[80:95], v[248:251], v[128:131], v[80:95]
    ds_read_b128 v[148:151], v1 offset:52224
    v_exp_f32 v153, v73
    v_exp_f32 v154, v74
    v_exp_f32 v155, v75
    v_add_f32 v152, 1.0, v152
    v_add_f32 v153, 1.0, v153
    buffer_load_dwordx4 v[156:159], v0, s[4:7], s60 offen offset:2048 sc1
    v_mfma_f32_32x32x16_bf16 v[80:95], v[252:255], v[132:135], v[80:95]
    ds_read_b128 v[128:131], v1 offset:53248
    v_add_f32 v154, 1.0, v154
    v_add_f32 v155, 1.0, v155
    v_rcp_f32 v152, v152
    v_rcp_f32 v153, v153
    s_waitcnt lgkmcnt(3)
    v_mfma_f32_32x32x16_bf16 v[80:95], a[224:227], v[136:139], v[80:95]
    ds_read_b128 v[132:135], v1 offset:54272
    v_rcp_f32 v154, v154
    v_rcp_f32 v155, v155
    v_mul_f32 v72, v72, v152
    v_mul_f32 v73, v73, v153
    v_mul_f32 v74, v74, v154
    v_mfma_f32_32x32x16_bf16 v[80:95], a[228:231], v[140:143], v[80:95]
    ds_read_b128 v[136:139], v1 offset:55296
    v_mul_f32 v75, v75, v155
    v_cvt_pk_bf16_f32 v164, v72, v73
    v_cvt_pk_bf16_f32 v165, v74, v75
    v_mul_f32 v152, v52, v44
    s_waitcnt lgkmcnt(3)
    v_mfma_f32_32x32x16_bf16 v[80:95], a[232:235], v[144:147], v[80:95]
    ds_read_b128 v[140:143], v1 offset:56320
    v_mul_f32 v153, v52, v45
    v_mul_f32 v154, v52, v46
    v_mul_f32 v155, v52, v47
    v_fma_f32 v76, v53, v76, v152
    buffer_load_dwordx4 v[144:147], v0, s[4:7], s60 offen offset:3072 sc1
    v_mfma_f32_32x32x16_bf16 v[80:95], a[236:239], v[148:151], v[80:95]
    v_fma_f32 v77, v53, v77, v153
    v_fma_f32 v78, v53, v78, v154
    v_fma_f32 v79, v53, v79, v155
    v_exp_f32 v152, v76
    v_exp_f32 v153, v77
    s_add_u32 s60, s49, 4096
    buffer_load_dwordx4 v[148:151], v0, s[4:7], s60 offen offset:0 sc1
    s_waitcnt lgkmcnt(2)
    v_mfma_f32_32x32x16_bf16 v[80:95], a[240:243], v[128:131], v[80:95]
    v_exp_f32 v154, v78
    v_exp_f32 v155, v79
    v_add_f32 v152, 1.0, v152
    v_add_f32 v153, 1.0, v153
    buffer_load_dwordx4 v[128:131], v0, s[4:7], s60 offen offset:1024 sc1
    v_mfma_f32_32x32x16_bf16 v[80:95], a[244:247], v[132:135], v[80:95]
    v_add_f32 v154, 1.0, v154
    v_add_f32 v155, 1.0, v155
    v_rcp_f32 v152, v152
    v_rcp_f32 v153, v153
    v_rcp_f32 v154, v154
    s_waitcnt lgkmcnt(0)
    v_mfma_f32_32x32x16_bf16 v[80:95], a[248:251], v[136:139], v[80:95]
    v_rcp_f32 v155, v155
    v_mul_f32 v76, v76, v152
    v_mul_f32 v77, v77, v153
    v_mul_f32 v78, v78, v154
    buffer_load_dwordx4 v[132:135], v0, s[4:7], s60 offen offset:2048 sc1
    v_mfma_f32_32x32x16_bf16 v[80:95], a[252:255], v[140:143], v[80:95]
    v_mul_f32 v79, v79, v155
    v_cvt_pk_bf16_f32 v166, v76, v77
    v_cvt_pk_bf16_f32 v167, v78, v79
    s_add_u32 s30, s50, 229376
    buffer_store_dwordx4 v[164:167], v0, s[4:7], s30 offen offset:1024 sc0 sc1
    s_waitcnt vmcnt(7)
    v_mfma_f32_32x32x16_bf16 v[96:111], a[0:3], v[168:171], 0
    buffer_load_dwordx4 v[136:139], v0, s[4:7], s60 offen offset:3072 sc1
    v_mfma_f32_32x32x16_bf16 v[112:127], a[4:7], v[168:171], 0
    v_mul_f32 v152, v54, v32
    v_mul_f32 v153, v54, v33
    v_mul_f32 v154, v54, v34
    v_mul_f32 v155, v54, v35
    v_fma_f32 v80, v55, v80, v152
    v_fma_f32 v81, v55, v81, v153
    v_fma_f32 v82, v55, v82, v154
    v_fma_f32 v83, v55, v83, v155
    v_exp_f32 v152, v80
    s_waitcnt vmcnt(7)
    v_mfma_f32_32x32x16_bf16 v[96:111], a[8:11], v[172:175], v[96:111]
    v_exp_f32 v153, v81
    v_exp_f32 v154, v82
    v_exp_f32 v155, v83
    v_add_f32 v152, 1.0, v152
    v_add_f32 v153, 1.0, v153
    v_add_f32 v154, 1.0, v154
    v_add_f32 v155, 1.0, v155
    v_rcp_f32 v152, v152
    s_add_u32 s60, s49, 8192
    buffer_load_dwordx4 v[140:143], v0, s[4:7], s60 offen offset:0 sc1
    v_mfma_f32_32x32x16_bf16 v[112:127], a[12:15], v[172:175], v[112:127]
    v_rcp_f32 v153, v153
    v_rcp_f32 v154, v154
    v_rcp_f32 v155, v155
    v_mul_f32 v80, v80, v152
    v_mul_f32 v81, v81, v153
    v_mul_f32 v82, v82, v154
    v_mul_f32 v83, v83, v155
    v_cvt_pk_bf16_f32 v160, v80, v81
    s_waitcnt vmcnt(7)
    v_mfma_f32_32x32x16_bf16 v[96:111], a[16:19], v[156:159], v[96:111]
    v_cvt_pk_bf16_f32 v161, v82, v83
    v_mul_f32 v152, v54, v36
    v_mul_f32 v153, v54, v37
    v_mul_f32 v154, v54, v38
    v_mul_f32 v155, v54, v39
    v_fma_f32 v84, v55, v84, v152
    v_fma_f32 v85, v55, v85, v153
    v_fma_f32 v86, v55, v86, v154
    buffer_load_dwordx4 v[168:171], v0, s[4:7], s60 offen offset:1024 sc1
    v_mfma_f32_32x32x16_bf16 v[112:127], a[20:23], v[156:159], v[112:127]
    v_fma_f32 v87, v55, v87, v155
    v_exp_f32 v152, v84
    v_exp_f32 v153, v85
    v_exp_f32 v154, v86
    v_exp_f32 v155, v87
    v_add_f32 v152, 1.0, v152
    v_add_f32 v153, 1.0, v153
    v_add_f32 v154, 1.0, v154
    s_waitcnt vmcnt(7)
    v_mfma_f32_32x32x16_bf16 v[96:111], a[24:27], v[144:147], v[96:111]
    v_add_f32 v155, 1.0, v155
    v_rcp_f32 v152, v152
    v_rcp_f32 v153, v153
    v_rcp_f32 v154, v154
    v_rcp_f32 v155, v155
    v_mul_f32 v84, v84, v152
    v_mul_f32 v85, v85, v153
    v_mul_f32 v86, v86, v154
    buffer_load_dwordx4 v[172:175], v0, s[4:7], s60 offen offset:2048 sc1
    v_mfma_f32_32x32x16_bf16 v[112:127], a[28:31], v[144:147], v[112:127]
    v_mul_f32 v87, v87, v155
    v_cvt_pk_bf16_f32 v162, v84, v85
    v_cvt_pk_bf16_f32 v163, v86, v87
    s_add_u32 s30, s50, 344064
    buffer_store_dwordx4 v[160:163], v0, s[4:7], s30 offen sc0 sc1
    v_mul_f32 v152, v54, v40
    v_mul_f32 v153, v54, v41
    v_mul_f32 v154, v54, v42
    v_mul_f32 v155, v54, v43
    v_fma_f32 v88, v55, v88, v152
    s_waitcnt vmcnt(8)
    v_mfma_f32_32x32x16_bf16 v[96:111], a[32:35], v[148:151], v[96:111]
    v_fma_f32 v89, v55, v89, v153
    v_fma_f32 v90, v55, v90, v154
    v_fma_f32 v91, v55, v91, v155
    v_exp_f32 v152, v88
    v_exp_f32 v153, v89
    v_exp_f32 v154, v90
    v_exp_f32 v155, v91
    v_add_f32 v152, 1.0, v152
    buffer_load_dwordx4 v[144:147], v0, s[4:7], s60 offen offset:3072 sc1
    v_mfma_f32_32x32x16_bf16 v[112:127], a[36:39], v[148:151], v[112:127]
    v_add_f32 v153, 1.0, v153
    v_add_f32 v154, 1.0, v154
    v_add_f32 v155, 1.0, v155
    v_rcp_f32 v152, v152
    v_rcp_f32 v153, v153
    v_rcp_f32 v154, v154
    v_rcp_f32 v155, v155
    v_mul_f32 v88, v88, v152
    s_waitcnt vmcnt(8)
    v_mfma_f32_32x32x16_bf16 v[96:111], a[40:43], v[128:131], v[96:111]
    v_mul_f32 v89, v89, v153
    v_mul_f32 v90, v90, v154
    v_mul_f32 v91, v91, v155
    v_cvt_pk_bf16_f32 v164, v88, v89
    v_cvt_pk_bf16_f32 v165, v90, v91
    v_mul_f32 v152, v54, v44
    v_mul_f32 v153, v54, v45
    v_mul_f32 v154, v54, v46
    s_add_u32 s60, s49, 12288
    buffer_load_dwordx4 v[148:151], v0, s[4:7], s60 offen offset:0 sc1
    v_mfma_f32_32x32x16_bf16 v[112:127], a[44:47], v[128:131], v[112:127]
    v_mul_f32 v155, v54, v47
    v_fma_f32 v92, v55, v92, v152
    v_fma_f32 v93, v55, v93, v153
    v_fma_f32 v94, v55, v94, v154
    v_fma_f32 v95, v55, v95, v155
    v_exp_f32 v152, v92
    v_exp_f32 v153, v93
    v_exp_f32 v154, v94
    s_waitcnt vmcnt(8)
    v_mfma_f32_32x32x16_bf16 v[96:111], a[48:51], v[132:135], v[96:111]
    v_exp_f32 v155, v95
    v_add_f32 v152, 1.0, v152
    v_add_f32 v153, 1.0, v153
    v_add_f32 v154, 1.0, v154
    v_add_f32 v155, 1.0, v155
    v_rcp_f32 v152, v152
    v_rcp_f32 v153, v153
    v_rcp_f32 v154, v154
    buffer_load_dwordx4 v[128:131], v0, s[4:7], s60 offen offset:1024 sc1
    v_mfma_f32_32x32x16_bf16 v[112:127], a[52:55], v[132:135], v[112:127]
    v_rcp_f32 v155, v155
    v_mul_f32 v92, v92, v152
    v_mul_f32 v93, v93, v153
    v_mul_f32 v94, v94, v154
    v_mul_f32 v95, v95, v155
    v_cvt_pk_bf16_f32 v166, v92, v93
    v_cvt_pk_bf16_f32 v167, v94, v95
    s_add_u32 s30, s50, 344064
    buffer_store_dwordx4 v[164:167], v0, s[4:7], s30 offen offset:1024 sc0 sc1
    s_waitcnt vmcnt(8)
    v_mfma_f32_32x32x16_bf16 v[96:111], a[56:59], v[136:139], v[96:111]
    buffer_load_dwordx4 v[132:135], v0, s[4:7], s60 offen offset:2048 sc1
    v_mfma_f32_32x32x16_bf16 v[112:127], a[60:63], v[136:139], v[112:127]
    s_waitcnt vmcnt(8)
    v_mfma_f32_32x32x16_bf16 v[96:111], a[64:67], v[140:143], v[96:111]
    buffer_load_dwordx4 v[136:139], v0, s[4:7], s60 offen offset:3072 sc1
    v_mfma_f32_32x32x16_bf16 v[112:127], a[68:71], v[140:143], v[112:127]
    s_waitcnt vmcnt(8)
    v_mfma_f32_32x32x16_bf16 v[96:111], a[72:75], v[168:171], v[96:111]
    s_add_u32 s60, s49, 16384
    buffer_load_dwordx4 v[140:143], v0, s[4:7], s60 offen offset:0 sc1
    v_mfma_f32_32x32x16_bf16 v[112:127], a[76:79], v[168:171], v[112:127]
    s_waitcnt vmcnt(8)
    v_mfma_f32_32x32x16_bf16 v[96:111], a[80:83], v[172:175], v[96:111]
    s_add_u32 s29, s3, 4
    v_mov_b32 v12, s29
    s_waitcnt vmcnt(3)
    buffer_store_dword v12, off, s[4:7], s34 sc0 sc1
    buffer_load_dwordx4 v[168:171], v0, s[4:7], s60 offen offset:1024 sc1
    v_mfma_f32_32x32x16_bf16 v[112:127], a[84:87], v[172:175], v[112:127]
    s_waitcnt vmcnt(8)
    v_mfma_f32_32x32x16_bf16 v[96:111], a[88:91], v[144:147], v[96:111]
    buffer_load_dwordx4 v[172:175], v0, s[4:7], s60 offen offset:2048 sc1
    v_mfma_f32_32x32x16_bf16 v[112:127], a[92:95], v[144:147], v[112:127]
    s_waitcnt vmcnt(8)
    v_mfma_f32_32x32x16_bf16 v[96:111], a[96:99], v[148:151], v[96:111]
    buffer_load_dwordx4 v[144:147], v0, s[4:7], s60 offen offset:3072 sc1
    v_mfma_f32_32x32x16_bf16 v[112:127], a[100:103], v[148:151], v[112:127]
    s_waitcnt vmcnt(8)
    v_mfma_f32_32x32x16_bf16 v[96:111], a[104:107], v[128:131], v[96:111]
    s_add_u32 s60, s49, 20480
    buffer_load_dwordx4 v[148:151], v0, s[4:7], s60 offen offset:0 sc1
    v_mfma_f32_32x32x16_bf16 v[112:127], a[108:111], v[128:131], v[112:127]
    s_waitcnt vmcnt(7)
    v_mfma_f32_32x32x16_bf16 v[96:111], a[112:115], v[132:135], v[96:111]
    buffer_load_dwordx4 v[128:131], v0, s[4:7], s60 offen offset:1024 sc1
    v_mfma_f32_32x32x16_bf16 v[112:127], a[116:119], v[132:135], v[112:127]
    s_waitcnt vmcnt(7)
    v_mfma_f32_32x32x16_bf16 v[96:111], a[120:123], v[136:139], v[96:111]
    buffer_load_dwordx4 v[132:135], v0, s[4:7], s60 offen offset:2048 sc1
    v_mfma_f32_32x32x16_bf16 v[112:127], a[124:127], v[136:139], v[112:127]
    buffer_load_dwordx4 v[136:139], v0, s[4:7], s60 offen offset:3072 sc1
    s_waitcnt vmcnt(8)
    v_mfma_f32_32x32x16_bf16 v[96:111], a[128:131], v[140:143], v[96:111]
    s_add_u32 s60, s49, 24576
    buffer_load_dwordx4 v[156:159], v0, s[4:7], s60 offen offset:0 sc1
    v_mfma_f32_32x32x16_bf16 v[112:127], a[132:135], v[140:143], v[112:127]
    buffer_load_dwordx4 v[140:143], v0, s[4:7], s60 offen offset:1024 sc1
    s_waitcnt vmcnt(8)
    v_mfma_f32_32x32x16_bf16 v[96:111], a[136:139], v[168:171], v[96:111]
    buffer_load_dwordx4 v[64:67], v0, s[4:7], s60 offen offset:2048 sc1
    v_mfma_f32_32x32x16_bf16 v[112:127], a[140:143], v[168:171], v[112:127]
    buffer_load_dwordx4 v[168:171], v0, s[4:7], s60 offen offset:3072 sc1
    s_waitcnt vmcnt(9)
    v_mfma_f32_32x32x16_bf16 v[96:111], a[144:147], v[172:175], v[96:111]
    buffer_load_dword v15, v9, s[4:7], 0 offen sc1
    v_mfma_f32_32x32x16_bf16 v[112:127], a[148:151], v[172:175], v[112:127]
    s_waitcnt vmcnt(9)
    v_mfma_f32_32x32x16_bf16 v[96:111], a[152:155], v[144:147], v[96:111]
    v_mfma_f32_32x32x16_bf16 v[112:127], a[156:159], v[144:147], v[112:127]
    s_waitcnt vmcnt(8)
    v_mfma_f32_32x32x16_bf16 v[96:111], a[160:163], v[148:151], v[96:111]
    v_mfma_f32_32x32x16_bf16 v[112:127], a[164:167], v[148:151], v[112:127]
    s_waitcnt vmcnt(7)
    v_mfma_f32_32x32x16_bf16 v[96:111], a[168:171], v[128:131], v[96:111]
    v_mfma_f32_32x32x16_bf16 v[112:127], a[172:175], v[128:131], v[112:127]
    s_waitcnt vmcnt(6)
    v_mfma_f32_32x32x16_bf16 v[96:111], a[176:179], v[132:135], v[96:111]
    s_waitcnt vmcnt(5)
    v_mfma_f32_32x32x16_bf16 v[96:111], a[184:187], v[136:139], v[96:111]
    s_waitcnt vmcnt(0)
    s_add_u32 s40, s3, 4
    v_subrev_u32 v15, s40, v15
    v_cmp_gt_u32 vcc, 16, v15
    s_nop 0
    s_andn2_b64 s[40:41], s[38:39], vcc
    s_cbranch_scc1 Ls_spin_19
Ls_back_20:
    s_add_u32 s60, s49, 229376
    buffer_load_dwordx4 v[128:131], v0, s[4:7], s60 offen offset:0 sc1
    buffer_load_dwordx4 v[144:147], v0, s[4:7], s60 offen offset:1024 sc1
    s_waitcnt vmcnt(6)
    v_mfma_f32_32x32x16_bf16 v[96:111], a[192:195], v[156:159], v[96:111]
    buffer_load_dwordx4 v[148:151], v0, s[4:7], s60 offen offset:2048 sc1
    s_waitcnt vmcnt(6)
    v_mfma_f32_32x32x16_bf16 v[96:111], a[200:203], v[140:143], v[96:111]
    s_waitcnt vmcnt(5)
    v_mfma_f32_32x32x16_bf16 v[96:111], a[208:211], v[64:67], v[96:111]
    buffer_load_dwordx4 v[172:175], v0, s[4:7], s60 offen offset:3072 sc1
    s_waitcnt vmcnt(5)
    v_mfma_f32_32x32x16_bf16 v[96:111], a[216:219], v[168:171], v[96:111]
    v_mfma_f32_32x32x16_bf16 v[112:127], a[180:183], v[132:135], v[112:127]
    s_add_u32 s60, s49, 233472
    buffer_load_dwordx4 v[132:135], v0, s[4:7], s60 offen offset:0 sc1
    v_mfma_f32_32x32x16_bf16 v[112:127], a[188:191], v[136:139], v[112:127]
    v_mfma_f32_32x32x16_bf16 v[112:127], a[196:199], v[156:159], v[112:127]
    buffer_load_dwordx4 v[136:139], v0, s[4:7], s60 offen offset:1024 sc1
    v_xor_b32 v58, 0, v6
    s_nop 4
    ds_write_b128 v58, v[96:99]
    v_mfma_f32_32x32x16_bf16 v[112:127], a[204:207], v[140:143], v[112:127]
    v_xor_b32 v59, 32, v6
    ds_write_b128 v59, v[100:103]
    v_mfma_f32_32x32x16_bf16 v[112:127], a[212:215], v[64:67], v[112:127]
    buffer_load_dwordx4 v[140:143], v0, s[4:7], s60 offen offset:2048 sc1
    v_xor_b32 v58, 64, v6
    ds_write_b128 v58, v[104:107]
    v_mfma_f32_32x32x16_bf16 v[112:127], a[220:223], v[168:171], v[112:127]
    v_xor_b32 v59, 96, v6
    ds_write_b128 v59, v[108:111]
    s_waitcnt vmcnt(6)
    v_mfma_f32_32x32x16_bf16 v[64:79], a[0:3], v[128:131], 0
    buffer_load_dwordx4 v[168:171], v0, s[4:7], s60 offen offset:3072 sc1
    v_mfma_f32_32x32x16_bf16 v[80:95], a[4:7], v[128:131], 0
    s_waitcnt vmcnt(6)
    v_mfma_f32_32x32x16_bf16 v[64:79], a[8:11], v[144:147], v[64:79]
    s_add_u32 s60, s49, 237568
    buffer_load_dwordx4 v[128:131], v0, s[4:7], s60 offen offset:0 sc1
    v_mfma_f32_32x32x16_bf16 v[80:95], a[12:15], v[144:147], v[80:95]
    v_xor_b32 v58, 128, v6
    s_nop 1
    ds_write_b128 v58, v[112:115]
    v_xor_b32 v59, 160, v6
    ds_write_b128 v59, v[116:119]
    s_waitcnt vmcnt(6)
    v_mfma_f32_32x32x16_bf16 v[64:79], a[16:19], v[148:151], v[64:79]
    buffer_load_dwordx4 v[144:147], v0, s[4:7], s60 offen offset:1024 sc1
    v_xor_b32 v58, 192, v6
    ds_write_b128 v58, v[120:123]
    v_mfma_f32_32x32x16_bf16 v[80:95], a[20:23], v[148:151], v[80:95]
    v_xor_b32 v59, 224, v6
    ds_write_b128 v59, v[124:127]
    s_waitcnt vmcnt(6)
    v_mfma_f32_32x32x16_bf16 v[64:79], a[24:27], v[172:175], v[64:79]
    buffer_load_dwordx4 v[148:151], v0, s[4:7], s60 offen offset:2048 sc1
    v_mfma_f32_32x32x16_bf16 v[80:95], a[28:31], v[172:175], v[80:95]
    s_waitcnt vmcnt(6)
    v_mfma_f32_32x32x16_bf16 v[64:79], a[32:35], v[132:135], v[64:79]
    buffer_load_dwordx4 v[172:175], v0, s[4:7], s60 offen offset:3072 sc1
    v_mfma_f32_32x32x16_bf16 v[80:95], a[36:39], v[132:135], v[80:95]
    s_waitcnt vmcnt(6)
    v_mfma_f32_32x32x16_bf16 v[64:79], a[40:43], v[136:139], v[64:79]
    s_add_u32 s60, s49, 241664
    buffer_load_dwordx4 v[132:135], v0, s[4:7], s60 offen offset:0 sc1
    v_mfma_f32_32x32x16_bf16 v[80:95], a[44:47], v[136:139], v[80:95]
    s_waitcnt lgkmcnt(0)
    s_barrier
    v_xor_b32 v58, 16, v7
    ds_read_b128 v[96:99], v7 offset:0
    ds_read_b128 v[100:103], v58 offset:0
    ds_read_b128 v[104:107], v7 offset:8192
    s_waitcnt vmcnt(6)
    v_mfma_f32_32x32x16_bf16 v[64:79], a[48:51], v[140:143], v[64:79]
    buffer_load_dwordx4 v[136:139], v0, s[4:7], s60 offen offset:1024 sc1
    ds_read_b128 v[108:111], v58 offset:8192
    ds_read_b128 v[112:115], v7 offset:16384
    ds_read_b128 v[116:119], v58 offset:16384
    ds_read_b128 v[120:123], v7 offset:24576
    ds_read_b128 v[124:127], v58 offset:24576
    v_mfma_f32_32x32x16_bf16 v[80:95], a[52:55], v[140:143], v[80:95]
    s_waitcnt vmcnt(6)
    v_mfma_f32_32x32x16_bf16 v[64:79], a[56:59], v[168:171], v[64:79]
    buffer_load_dwordx4 v[140:143], v0, s[4:7], s60 offen offset:2048 sc1
    v_lshlrev_b32 v160, 16, v16
    v_and_b32 v161, s46, v16
    v_lshlrev_b32 v162, 16, v17
    v_and_b32 v163, s46, v17
    v_lshlrev_b32 v164, 16, v18
    v_and_b32 v165, s46, v18
    v_lshlrev_b32 v166, 16, v19
    v_and_b32 v167, s46, v19
    s_waitcnt lgkmcnt(4)
    v_add_f32 v96, v96, v104
    v_mfma_f32_32x32x16_bf16 v[80:95], a[60:63], v[168:171], v[80:95]
    v_add_f32 v97, v97, v105
    v_add_f32 v98, v98, v106
    v_add_f32 v99, v99, v107
    v_add_f32 v100, v100, v108
    v_add_f32 v101, v101, v109
    v_add_f32 v102, v102, v110
    v_add_f32 v103, v103, v111
    s_waitcnt lgkmcnt(0)
    v_add_f32 v112, v112, v120
    v_add_f32 v113, v113, v121
    s_waitcnt vmcnt(6)
    v_mfma_f32_32x32x16_bf16 v[64:79], a[64:67], v[128:131], v[64:79]
    buffer_load_dwordx4 v[168:171], v0, s[4:7], s60 offen offset:3072 sc1
    v_add_f32 v114, v114, v122
    v_add_f32 v115, v115, v123
    v_add_f32 v116, v116, v124
    v_add_f32 v117, v117, v125
    v_add_f32 v118, v118, v126
    v_add_f32 v119, v119, v127
    v_add_f32 v96, v96, v112
    v_add_f32 v97, v97, v113
    v_add_f32 v98, v98, v114
    v_mfma_f32_32x32x16_bf16 v[80:95], a[68:71], v[128:131], v[80:95]
    v_add_f32 v99, v99, v115
    v_add_f32 v100, v100, v116
    v_add_f32 v101, v101, v117
    v_add_f32 v102, v102, v118
    v_add_f32 v103, v103, v119
    v_fmac_f32 v160, s61, v96
    v_fmac_f32 v161, s61, v97
    v_fmac_f32 v162, s61, v98
    v_fmac_f32 v163, s61, v99
    s_waitcnt vmcnt(6)
    v_mfma_f32_32x32x16_bf16 v[64:79], a[72:75], v[144:147], v[64:79]
    s_add_u32 s60, s49, 245760
    buffer_load_dwordx4 v[128:131], v0, s[4:7], s60 offen offset:0 sc1
    v_fmac_f32 v164, s61, v100
    v_fmac_f32 v165, s61, v101
    v_fmac_f32 v166, s61, v102
    v_fmac_f32 v167, s61, v103
    v_cvt_pk_bf16_f32 v16, v160, v161
    v_cvt_pk_bf16_f32 v17, v162, v163
    v_cvt_pk_bf16_f32 v18, v164, v165
    v_cvt_pk_bf16_f32 v19, v166, v167
    v_mfma_f32_32x32x16_bf16 v[80:95], a[76:79], v[144:147], v[80:95]
    v_dot2_f32_bf16 v60, v16, s54, 0
    v_dot2_f32_bf16 v61, v16, v16, 0
    v_dot2_f32_bf16 v60, v17, s54, v60
    v_dot2_f32_bf16 v61, v17, v17, v61
    v_dot2_f32_bf16 v60, v18, s54, v60
    s_waitcnt vmcnt(6)
    v_mfma_f32_32x32x16_bf16 v[64:79], a[80:83], v[148:151], v[64:79]
    buffer_load_dwordx4 v[144:147], v0, s[4:7], s60 offen offset:1024 sc1
    v_dot2_f32_bf16 v61, v18, v18, v61
    v_dot2_f32_bf16 v60, v19, s54, v60
    v_dot2_f32_bf16 v61, v19, v19, v61
    s_nop 2
    v_permlane32_swap_b32 v60, v61
    v_add_f32 v60, v60, v61
    v_mfma_f32_32x32x16_bf16 v[80:95], a[84:87], v[148:151], v[80:95]
    v_mov_b32 v63, v60
    s_nop 1
    v_permlane16_swap_b32 v60, v63
    v_add_f32 v60, v60, v63
    s_nop 1
    v_add_f32_dpp v60, v60, v60 row_ror:8 row_mask:0xf bank_mask:0xf
    v_mov_b32 v61, v60
    s_waitcnt vmcnt(6)
    v_mfma_f32_32x32x16_bf16 v[64:79], a[88:91], v[172:175], v[64:79]
    buffer_load_dwordx4 v[148:151], v0, s[4:7], s60 offen offset:2048 sc1
    v_permlane32_swap_b32 v60, v61
    v_cndmask_b32 v60, 0, v60, s[44:45]
    v_cndmask_b32 v61, 0, v61, s[44:45]
    s_add_u32 s29, s3, 2
    v_mov_b32 v62, s29
    s_add_u32 s29, s35, 262144
    s_mov_b64 exec, s[42:43]
    buffer_store_dwordx3 v[60:62], v11, s[4:7], s29 offen sc0 sc1
    s_mov_b64 exec, -1
    v_mfma_f32_32x32x16_bf16 v[80:95], a[92:95], v[172:175], v[80:95]
    s_waitcnt vmcnt(7)
    v_mfma_f32_32x32x16_bf16 v[64:79], a[96:99], v[132:135], v[64:79]
    buffer_load_dwordx4 v[172:175], v0, s[4:7], s60 offen offset:3072 sc1
    v_mfma_f32_32x32x16_bf16 v[80:95], a[100:103], v[132:135], v[80:95]
    s_waitcnt vmcnt(7)
    v_mfma_f32_32x32x16_bf16 v[64:79], a[104:107], v[136:139], v[64:79]
    s_add_u32 s60, s49, 249856
    buffer_load_dwordx4 v[132:135], v0, s[4:7], s60 offen offset:0 sc1
    v_mfma_f32_32x32x16_bf16 v[80:95], a[108:111], v[136:139], v[80:95]
    s_waitcnt vmcnt(7)
    v_mfma_f32_32x32x16_bf16 v[64:79], a[112:115], v[140:143], v[64:79]
    buffer_load_dwordx4 v[136:139], v0, s[4:7], s60 offen offset:1024 sc1
    s_barrier
    v_mfma_f32_32x32x16_bf16 v[80:95], a[116:119], v[140:143], v[80:95]
    s_add_u32 s33, s35, 262144
    buffer_load_dwordx3 v[96:98], v2, s[4:7], s33 offen sc1
    s_waitcnt vmcnt(8)
    v_mfma_f32_32x32x16_bf16 v[64:79], a[120:123], v[168:171], v[64:79]
    buffer_load_dwordx4 v[140:143], v0, s[4:7], s60 offen offset:2048 sc1
    v_mfma_f32_32x32x16_bf16 v[80:95], a[124:127], v[168:171], v[80:95]
    buffer_load_dwordx4 v[168:171], v0, s[4:7], s60 offen offset:3072 sc1
    s_waitcnt vmcnt(9)
    v_mfma_f32_32x32x16_bf16 v[64:79], a[128:131], v[128:131], v[64:79]
    s_add_u32 s60, s49, 253952
    buffer_load_dwordx4 v[156:159], v0, s[4:7], s60 offen offset:0 sc1
    v_mfma_f32_32x32x16_bf16 v[80:95], a[132:135], v[128:131], v[80:95]
    buffer_load_dwordx4 v[128:131], v0, s[4:7], s60 offen offset:1024 sc1
    s_waitcnt vmcnt(10)
    v_mfma_f32_32x32x16_bf16 v[64:79], a[136:139], v[144:147], v[64:79]
    buffer_load_dwordx4 v[48:51], v0, s[4:7], s60 offen offset:2048 sc1
    v_mfma_f32_32x32x16_bf16 v[80:95], a[140:143], v[144:147], v[80:95]
    buffer_load_dwordx4 v[144:147], v0, s[4:7], s60 offen offset:3072 sc1
    s_waitcnt vmcnt(11)
    v_mfma_f32_32x32x16_bf16 v[64:79], a[144:147], v[148:151], v[64:79]
    v_mfma_f32_32x32x16_bf16 v[80:95], a[148:151], v[148:151], v[80:95]
    s_waitcnt vmcnt(9)
    v_mfma_f32_32x32x16_bf16 v[64:79], a[152:155], v[172:175], v[64:79]
    v_mfma_f32_32x32x16_bf16 v[80:95], a[156:159], v[172:175], v[80:95]
    s_waitcnt vmcnt(8)
    v_mfma_f32_32x32x16_bf16 v[64:79], a[160:163], v[132:135], v[64:79]
    v_mfma_f32_32x32x16_bf16 v[80:95], a[164:167], v[132:135], v[80:95]
    s_waitcnt vmcnt(7)
    v_mfma_f32_32x32x16_bf16 v[64:79], a[168:171], v[136:139], v[64:79]
    v_mfma_f32_32x32x16_bf16 v[80:95], a[172:175], v[136:139], v[80:95]
    s_waitcnt vmcnt(5)
    v_mfma_f32_32x32x16_bf16 v[64:79], a[176:179], v[140:143], v[64:79]
    s_waitcnt vmcnt(4)
    v_mfma_f32_32x32x16_bf16 v[64:79], a[184:187], v[168:171], v[64:79]
    v_lshlrev_b32 v104, 16, v16
    v_and_b32 v105, s46, v16
    v_lshlrev_b32 v112, 16, v24
    v_and_b32 v113, s46, v24
    v_lshlrev_b32 v106, 16, v17
    v_and_b32 v107, s46, v17
    v_lshlrev_b32 v114, 16, v25
    v_and_b32 v115, s46, v25
    s_waitcnt vmcnt(3)
    v_mfma_f32_32x32x16_bf16 v[64:79], a[192:195], v[156:159], v[64:79]
    v_lshlrev_b32 v108, 16, v18
    v_and_b32 v109, s46, v18
    v_lshlrev_b32 v116, 16, v26
    v_and_b32 v117, s46, v26
    v_lshlrev_b32 v110, 16, v19
    v_and_b32 v111, s46, v19
    v_lshlrev_b32 v118, 16, v27
    v_and_b32 v119, s46, v27
    s_waitcnt vmcnt(2)
    v_mfma_f32_32x32x16_bf16 v[64:79], a[200:203], v[128:131], v[64:79]
    s_waitcnt vmcnt(6)
    s_add_u32 s40, s3, 2
    v_cmp_eq_u32 vcc, s40, v98
    s_nop 0
    s_andn2_b64 s[40:41], exec, vcc
    s_cbranch_scc1 Ls_sspin_22
Ls_sback_23:
    v_permlane32_swap_b32 v96, v97
    v_add_f32 v96, v96, v97
    v_mov_b32 v99, v96
    s_nop 1
    v_permlane16_swap_b32 v96, v99
    v_add_f32 v96, v96, v99
    s_nop 1
    v_add_f32_dpp v96, v96, v96 row_ror:8 row_mask:0xf bank_mask:0xf
    v_mov_b32 v99, v96
    s_waitcnt vmcnt(1)
    v_mfma_f32_32x32x16_bf16 v[64:79], a[208:211], v[48:51], v[64:79]
    s_nop 0
    v_permlane32_swap_b32 v96, v99
    v_mul_f32 v100, 0.002232142857142857, v96
    v_mul_f32 v99, 0.002232142857142857, v99
    v_fma_f32 v99, -v100, v100, v99
    v_max_f32 v99, 0, v99
    v_add_f32 v99, 0x3727c5ac, v99
    v_rsq_f32 v101, v99
    s_nop 0
    v_mul_f32 v112, v101, v112
    s_waitcnt vmcnt(0)
    v_mfma_f32_32x32x16_bf16 v[64:79], a[216:219], v[144:147], v[64:79]
    v_mul_f32 v113, v101, v113
    v_mul_f32 v114, v101, v114
    v_mul_f32 v115, v101, v115
    v_mul_f32 v116, v101, v116
    v_mul_f32 v117, v101, v117
    v_mul_f32 v118, v101, v118
    v_mul_f32 v119, v101, v119
    v_sub_f32 v96, v104, v100
    v_mfma_f32_32x32x16_bf16 v[80:95], a[180:183], v[140:143], v[80:95]
    v_sub_f32 v97, v105, v100
    v_fmac_f32 v104, v96, v112
    v_fmac_f32 v105, v97, v113
    v_sub_f32 v96, v106, v100
    v_sub_f32 v97, v107, v100
    v_fmac_f32 v106, v96, v114
    v_fmac_f32 v107, v97, v115
    v_sub_f32 v96, v108, v100
    v_mfma_f32_32x32x16_bf16 v[80:95], a[188:191], v[168:171], v[80:95]
    v_sub_f32 v97, v109, v100
    v_fmac_f32 v108, v96, v116
    v_fmac_f32 v109, v97, v117
    v_sub_f32 v96, v110, v100
    v_sub_f32 v97, v111, v100
    v_fmac_f32 v110, v96, v118
    v_fmac_f32 v111, v97, v119
    v_cvt_pk_bf16_f32 v16, v104, v105
    v_mfma_f32_32x32x16_bf16 v[80:95], a[196:199], v[156:159], v[80:95]
    v_xor_b32 v58, 0, v6
    ds_write_b128 v58, v[64:67]
    v_cvt_pk_bf16_f32 v17, v106, v107
    v_cvt_pk_bf16_f32 v18, v108, v109
    v_cvt_pk_bf16_f32 v19, v110, v111
    s_add_u32 s29, s48, 0
    buffer_store_dwordx4 v[16:19], v4, s[4:7], s29 offen sc0 sc1
    v_dot2_f32_bf16 v96, v16, s54, 0
    v_dot2_f32_bf16 v97, v16, v16, 0
    v_dot2_f32_bf16 v96, v17, s54, v96
    v_dot2_f32_bf16 v97, v17, v17, v97
    v_mfma_f32_32x32x16_bf16 v[80:95], a[204:207], v[128:131], v[80:95]
    v_xor_b32 v59, 32, v6
    ds_write_b128 v59, v[68:71]
    v_dot2_f32_bf16 v96, v18, s54, v96
    v_dot2_f32_bf16 v97, v18, v18, v97
    v_dot2_f32_bf16 v96, v19, s54, v96
    v_dot2_f32_bf16 v97, v19, v19, v97
    s_nop 2
    v_permlane32_swap_b32 v96, v97
    v_add_f32 v96, v96, v97
    v_mov_b32 v99, v96
    s_nop 1
    v_permlane16_swap_b32 v96, v99
    v_mfma_f32_32x32x16_bf16 v[80:95], a[212:215], v[48:51], v[80:95]
    v_xor_b32 v58, 64, v6
    ds_write_b128 v58, v[72:75]
    v_add_f32 v96, v96, v99
    s_nop 1
    v_add_f32_dpp v96, v96, v96 row_ror:8 row_mask:0xf bank_mask:0xf
    v_mov_b32 v97, v96
    s_nop 1
    v_permlane32_swap_b32 v96, v97
    v_cndmask_b32 v96, 0, v96, s[44:45]
    v_cndmask_b32 v97, 0, v97, s[44:45]
    s_add_u32 s29, s52, 393216
    s_mov_b64 exec, s[42:43]
    buffer_store_dwordx2 v[96:97], v3, s[4:7], s29 offen sc0 sc1
    s_mov_b64 exec, -1
    v_mfma_f32_32x32x16_bf16 v[80:95], a[220:223], v[144:147], v[80:95]
    v_xor_b32 v59, 96, v6
    ds_write_b128 v59, v[76:79]
    v_xor_b32 v58, 128, v6
    s_nop 8
    ds_write_b128 v58, v[80:83]
    v_xor_b32 v59, 160, v6
    ds_write_b128 v59, v[84:87]
    v_xor_b32 v58, 192, v6
    ds_write_b128 v58, v[88:91]
    v_xor_b32 v59, 224, v6
    ds_write_b128 v59, v[92:95]
    s_add_u32 s29, s3, 5
    v_mov_b32 v12, s29
    s_waitcnt vmcnt(0)
    buffer_store_dword v12, off, s[4:7], s34 sc0 sc1
    s_waitcnt lgkmcnt(0)
    s_barrier
    v_xor_b32 v58, 16, v7
    ds_read_b128 v[64:67], v7 offset:0
    ds_read_b128 v[68:71], v58 offset:0
    ds_read_b128 v[72:75], v7 offset:8192
    ds_read_b128 v[76:79], v58 offset:8192
    ds_read_b128 v[80:83], v7 offset:16384
    ds_read_b128 v[84:87], v58 offset:16384
    ds_read_b128 v[88:91], v7 offset:24576
    ds_read_b128 v[92:95], v58 offset:24576
    buffer_load_dword v13, v9, s[4:7], 0 offen sc1
    v_lshlrev_b32 v160, 16, v20
    v_and_b32 v161, s46, v20
    v_lshlrev_b32 v162, 16, v21
    v_and_b32 v163, s46, v21
    v_lshlrev_b32 v164, 16, v22
    v_and_b32 v165, s46, v22
    v_lshlrev_b32 v166, 16, v23
    v_and_b32 v167, s46, v23
    s_waitcnt lgkmcnt(4)
    v_add_f32 v64, v64, v72
    v_add_f32 v65, v65, v73
    v_add_f32 v66, v66, v74
    v_add_f32 v67, v67, v75
    v_add_f32 v68, v68, v76
    v_add_f32 v69, v69, v77
    v_add_f32 v70, v70, v78
    v_add_f32 v71, v71, v79
    s_waitcnt lgkmcnt(0)
    v_add_f32 v80, v80, v88
    v_add_f32 v81, v81, v89
    v_add_f32 v82, v82, v90
    v_add_f32 v83, v83, v91
    v_add_f32 v84, v84, v92
    v_add_f32 v85, v85, v93
    v_add_f32 v86, v86, v94
    v_add_f32 v87, v87, v95
    v_add_f32 v64, v64, v80
    v_add_f32 v65, v65, v81
    v_add_f32 v66, v66, v82
    v_add_f32 v67, v67, v83
    v_add_f32 v68, v68, v84
    v_add_f32 v69, v69, v85
    v_add_f32 v70, v70, v86
    v_add_f32 v71, v71, v87
    v_fmac_f32 v160, s61, v64
    v_fmac_f32 v161, s61, v65
    v_fmac_f32 v162, s61, v66
    v_fmac_f32 v163, s61, v67
    v_fmac_f32 v164, s61, v68
    v_fmac_f32 v165, s61, v69
    v_fmac_f32 v166, s61, v70
    v_fmac_f32 v167, s61, v71
    v_cvt_pk_bf16_f32 v20, v160, v161
    v_cvt_pk_bf16_f32 v21, v162, v163
    v_cvt_pk_bf16_f32 v22, v164, v165
    v_cvt_pk_bf16_f32 v23, v166, v167
    s_waitcnt vmcnt(0)
    s_add_u32 s40, s3, 5
    v_subrev_u32 v13, s40, v13
    v_cmp_gt_u32 vcc, 16, v13
    s_nop 0
    s_andn2_b64 s[40:41], s[36:37], vcc
    s_cbranch_scc1 Ls_spin_25
Ls_back_26:
    s_add_u32 m0, s53, 0
    s_add_u32 s57, s47, 0
    buffer_load_dwordx4 v0, s[4:7], s57 offen offset:0 sc1 lds
    s_add_u32 m0, s53, 0
    s_nop 0
    buffer_load_dwordx4 v0, s[4:7], s57 offen offset:1024 sc1 lds
    s_add_u32 m0, s53, 0
    s_nop 0
    buffer_load_dwordx4 v0, s[4:7], s57 offen offset:2048 sc1 lds
    s_add_u32 m0, s53, 0
    s_nop 0
    buffer_load_dwordx4 v0, s[4:7], s57 offen offset:3072 sc1 lds
    s_add_u32 m0, s53, 4096
    s_add_u32 s57, s47, 4096
    buffer_load_dwordx4 v0, s[4:7], s57 offen offset:0 sc1 lds
    s_add_u32 m0, s53, 4096
    s_nop 0
    buffer_load_dwordx4 v0, s[4:7], s57 offen offset:1024 sc1 lds
    s_add_u32 m0, s53, 4096
    s_nop 0
    buffer_load_dwordx4 v0, s[4:7], s57 offen offset:2048 sc1 lds
    v_dot2_f32_bf16 v60, v20, s54, 0
    v_dot2_f32_bf16 v61, v20, v20, 0
    v_dot2_f32_bf16 v60, v21, s54, v60
    v_dot2_f32_bf16 v61, v21, v21, v61
    v_dot2_f32_bf16 v60, v22, s54, v60
    v_dot2_f32_bf16 v61, v22, v22, v61
    v_dot2_f32_bf16 v60, v23, s54, v60
    v_dot2_f32_bf16 v61, v23, v23, v61
    s_nop 2
    v_permlane32_swap_b32 v60, v61
    v_add_f32 v60, v60, v61
    v_mov_b32 v63, v60
    s_nop 1
    v_permlane16_swap_b32 v60, v63
    v_add_f32 v60, v60, v63
    s_nop 1
    v_add_f32_dpp v60, v60, v60 row_ror:8 row_mask:0xf bank_mask:0xf
    v_mov_b32 v61, v60
    s_nop 1
    v_permlane32_swap_b32 v60, v61
    v_cndmask_b32 v60, 0, v60, s[44:45]
    v_cndmask_b32 v61, 0, v61, s[44:45]
    s_add_u32 s29, s3, 2
    v_mov_b32 v62, s29
    s_add_u32 s29, s35, 270336
    s_mov_b64 exec, s[42:43]
    buffer_store_dwordx3 v[60:62], v11, s[4:7], s29 offen sc0 sc1
    s_mov_b64 exec, -1
    s_add_u32 s58, s51, 393216
    buffer_load_dwordx4 v[112:115], v5, s[4:7], s58 offen offset:0 sc1
    buffer_load_dwordx4 v[116:119], v5, s[4:7], s58 offen offset:512 sc1
    buffer_load_dwordx4 v[120:123], v5, s[4:7], s58 offen offset:1024 sc1
    buffer_load_dwordx4 v[124:127], v5, s[4:7], s58 offen offset:1536 sc1
    s_waitcnt vmcnt(5)
    s_barrier
    ds_read_b128 v[128:131], v0 offset:0
    ds_read_b128 v[132:135], v0 offset:1024
    ds_read_b128 v[136:139], v0 offset:2048
    ds_read_b128 v[140:143], v0 offset:3072
    ds_read_b128 v[144:147], v0 offset:4096
    s_waitcnt lgkmcnt(3)
    v_mfma_f32_32x32x16_bf16 v[96:111], v[176:179], v[128:131], 0
    ds_read_b128 v[148:151], v0 offset:5120
    v_mfma_f32_32x32x16_bf16 v[96:111], v[180:183], v[132:135], v[96:111]
    ds_read_b128 v[128:131], v0 offset:6144
    s_waitcnt lgkmcnt(3)
    v_mfma_f32_32x32x16_bf16 v[96:111], v[184:187], v[136:139], v[96:111]
    ds_read_b128 v[132:135], v0 offset:7168
    s_add_u32 m0, s53, 28672
    s_add_u32 s57, s47, 28672
    buffer_load_dwordx4 v0, s[4:7], s57 offen offset:0 sc1 lds
    s_add_u32 s33, s35, 270336
    buffer_load_dwordx3 v[64:66], v2, s[4:7], s33 offen sc1
    v_mfma_f32_32x32x16_bf16 v[96:111], v[188:191], v[140:143], v[96:111]
    ds_read_b128 v[136:139], v0 offset:8192
    s_waitcnt lgkmcnt(3)
    v_mfma_f32_32x32x16_bf16 v[96:111], v[192:195], v[144:147], v[96:111]
    ds_read_b128 v[140:143], v0 offset:9216
    s_add_u32 m0, s53, 28672
    s_nop 0
    buffer_load_dwordx4 v0, s[4:7], s57 offen offset:1024 sc1 lds
    v_mfma_f32_32x32x16_bf16 v[96:111], v[196:199], v[148:151], v[96:111]
    ds_read_b128 v[144:147], v0 offset:10240
    s_waitcnt lgkmcnt(3)
    v_mfma_f32_32x32x16_bf16 v[96:111], v[200:203], v[128:131], v[96:111]
    ds_read_b128 v[148:151], v0 offset:11264
    v_mfma_f32_32x32x16_bf16 v[96:111], v[204:207], v[132:135], v[96:111]
    ds_read_b128 v[128:131], v0 offset:12288
    s_add_u32 m0, s53, 28672
    s_nop 0
    buffer_load_dwordx4 v0, s[4:7], s57 offen offset:2048 sc1 lds
    s_waitcnt lgkmcnt(3)
    v_mfma_f32_32x32x16_bf16 v[96:111], v[208:211], v[136:139], v[96:111]
    ds_read_b128 v[132:135], v0 offset:13312
    v_mfma_f32_32x32x16_bf16 v[96:111], v[212:215], v[140:143], v[96:111]
    ds_read_b128 v[136:139], v0 offset:14336
    s_add_u32 m0, s53, 28672
    s_nop 0
    buffer_load_dwordx4 v0, s[4:7], s57 offen offset:3072 sc1 lds
    s_waitcnt lgkmcnt(3)
    v_mfma_f32_32x32x16_bf16 v[96:111], v[216:219], v[144:147], v[96:111]
    ds_read_b128 v[140:143], v0 offset:15360
    v_mfma_f32_32x32x16_bf16 v[96:111], v[220:223], v[148:151], v[96:111]
    ds_read_b128 v[144:147], v0 offset:16384
    v_lshlrev_b32 v72, 16, v20
    v_and_b32 v73, s46, v20
    v_lshlrev_b32 v80, 16, v28
    v_and_b32 v81, s46, v28
    v_lshlrev_b32 v74, 16, v21
    v_and_b32 v75, s46, v21
    v_lshlrev_b32 v82, 16, v29
    v_and_b32 v83, s46, v29
    v_lshlrev_b32 v76, 16, v22
    v_and_b32 v77, s46, v22
    v_lshlrev_b32 v84, 16, v30
    v_and_b32 v85, s46, v30
    s_waitcnt lgkmcnt(3)
    v_mfma_f32_32x32x16_bf16 v[96:111], v[224:227], v[128:131], v[96:111]
    ds_read_b128 v[148:151], v0 offset:17408
    s_add_u32 m0, s53, 32768
    s_add_u32 s57, s47, 32768
    buffer_load_dwordx4 v0, s[4:7], s57 offen offset:0 sc1 lds
    v_lshlrev_b32 v78, 16, v23
    v_and_b32 v79, s46, v23
    v_lshlrev_b32 v86, 16, v31
    v_and_b32 v87, s46, v31
    s_waitcnt vmcnt(4)
    s_add_u32 s40, s3, 2
    v_cmp_eq_u32 vcc, s40, v66
    s_nop 0
    s_andn2_b64 s[40:41], exec, vcc
    s_cbranch_scc1 Ls_sspin_28
Ls_sback_29:
    v_permlane32_swap_b32 v64, v65
    v_add_f32 v64, v64, v65
    v_mov_b32 v67, v64
    s_nop 1
    v_permlane16_swap_b32 v64, v67
    v_add_f32 v64, v64, v67
    s_nop 1
    v_add_f32_dpp v64, v64, v64 row_ror:8 row_mask:0xf bank_mask:0xf
    v_mfma_f32_32x32x16_bf16 v[96:111], v[228:231], v[132:135], v[96:111]
    ds_read_b128 v[128:131], v0 offset:18432
    v_mov_b32 v67, v64
    s_nop 1
    v_permlane32_swap_b32 v64, v67
    v_mul_f32 v68, 0.002232142857142857, v64
    v_mul_f32 v67, 0.002232142857142857, v67
    v_fma_f32 v67, -v68, v68, v67
    v_max_f32 v67, 0, v67
    v_add_f32 v67, 0x3727c5ac, v67
    v_rsq_f32 v69, v67
    s_nop 0
    v_mul_f32 v80, v69, v80
    v_mul_f32 v81, v69, v81
    v_mul_f32 v82, v69, v82
    s_waitcnt lgkmcnt(3)
    v_mfma_f32_32x32x16_bf16 v[96:111], v[232:235], v[136:139], v[96:111]
    ds_read_b128 v[132:135], v0 offset:19456
    s_add_u32 m0, s53, 32768
    s_nop 0
    buffer_load_dwordx4 v0, s[4:7], s57 offen offset:1024 sc1 lds
    v_mul_f32 v83, v69, v83
    v_mul_f32 v84, v69, v84
    v_mul_f32 v85, v69, v85
    v_mul_f32 v86, v69, v86
    v_mul_f32 v87, v69, v87
    v_sub_f32 v64, v72, v68
    v_sub_f32 v65, v73, v68
    v_fmac_f32 v72, v64, v80
    v_fmac_f32 v73, v65, v81
    v_sub_f32 v64, v74, v68
    v_sub_f32 v65, v75, v68
    v_fmac_f32 v74, v64, v82
    v_mfma_f32_32x32x16_bf16 v[96:111], v[236:239], v[140:143], v[96:111]
    ds_read_b128 v[136:139], v0 offset:20480
    v_fmac_f32 v75, v65, v83
    v_sub_f32 v64, v76, v68
    v_sub_f32 v65, v77, v68
    v_fmac_f32 v76, v64, v84
    v_fmac_f32 v77, v65, v85
    v_sub_f32 v64, v78, v68
    v_sub_f32 v65, v79, v68
    v_fmac_f32 v78, v64, v86
    v_fmac_f32 v79, v65, v87
    v_cvt_pk_bf16_f32 v20, v72, v73
    v_cvt_pk_bf16_f32 v21, v74, v75
    s_waitcnt lgkmcnt(3)
    v_mfma_f32_32x32x16_bf16 v[96:111], v[240:243], v[144:147], v[96:111]
    ds_read_b128 v[140:143], v0 offset:21504
    v_cvt_pk_bf16_f32 v22, v76, v77
    v_cvt_pk_bf16_f32 v23, v78, v79
    s_add_u32 s29, s48, 57344
    buffer_store_dwordx4 v[20:23], v4, s[4:7], s29 offen sc0 sc1
    v_dot2_f32_bf16 v64, v20, s54, 0
    v_dot2_f32_bf16 v65, v20, v20, 0
    v_dot2_f32_bf16 v64, v21, s54, v64
    v_dot2_f32_bf16 v65, v21, v21, v65
    v_dot2_f32_bf16 v64, v22, s54, v64
    v_dot2_f32_bf16 v65, v22, v22, v65
    v_dot2_f32_bf16 v64, v23, s54, v64
    v_dot2_f32_bf16 v65, v23, v23, v65
    v_mfma_f32_32x32x16_bf16 v[96:111], v[244:247], v[148:151], v[96:111]
    ds_read_b128 v[144:147], v0 offset:22528
    s_add_u32 m0, s53, 32768
    s_nop 0
    buffer_load_dwordx4 v0, s[4:7], s57 offen offset:2048 sc1 lds
    v_permlane32_swap_b32 v64, v65
    v_add_f32 v64, v64, v65
    v_mov_b32 v67, v64
    s_nop 1
    v_permlane16_swap_b32 v64, v67
    v_add_f32 v64, v64, v67
    s_nop 1
    v_add_f32_dpp v64, v64, v64 row_ror:8 row_mask:0xf bank_mask:0xf
    v_mov_b32 v65, v64
    s_nop 1
    v_permlane32_swap_b32 v64, v65
    v_cndmask_b32 v64, 0, v64, s[44:45]
    v_cndmask_b32 v65, 0, v65, s[44:45]
    s_add_u32 s29, s52, 397312
    s_mov_b64 exec, s[42:43]
    buffer_store_dwordx2 v[64:65], v3, s[4:7], s29 offen sc0 sc1
    s_mov_b64 exec, -1
    s_waitcnt lgkmcnt(3)
    v_mfma_f32_32x32x16_bf16 v[96:111], v[248:251], v[128:131], v[96:111]
    ds_read_b128 v[148:151], v0 offset:23552
    s_waitcnt vmcnt(10)
    v_add_f32 v58, v112, v114
    v_add_f32 v59, v113, v115
    v_add_f32 v60, v116, v118
    v_add_f32 v61, v117, v119
    v_mfma_f32_32x32x16_bf16 v[96:111], v[252:255], v[132:135], v[96:111]
    ds_read_b128 v[128:131], v0 offset:24576
    v_add_f32 v58, v58, v120
    v_add_f32 v59, v59, v121
    v_add_f32 v60, v60, v122
    s_waitcnt lgkmcnt(3)
    v_mfma_f32_32x32x16_bf16 v[96:111], a[224:227], v[136:139], v[96:111]
    ds_read_b128 v[132:135], v0 offset:25600
    v_add_f32 v61, v61, v123
    v_add_f32 v58, v58, v124
    v_add_f32 v59, v59, v125
    v_mfma_f32_32x32x16_bf16 v[96:111], a[228:231], v[140:143], v[96:111]
    ds_read_b128 v[136:139], v0 offset:26624
    v_add_f32 v58, v58, v60
    v_add_f32 v59, v59, v61
    v_mul_f32 v60, 0.002232142857142857, v58
    s_waitcnt lgkmcnt(3)
    v_mfma_f32_32x32x16_bf16 v[96:111], a[232:235], v[144:147], v[96:111]
    ds_read_b128 v[140:143], v0 offset:27648
    v_mul_f32 v59, 0.002232142857142857, v59
    v_fma_f32 v59, -v60, v60, v59
    v_max_f32 v59, 0, v59
    v_mfma_f32_32x32x16_bf16 v[96:111], a[236:239], v[148:151], v[96:111]
    s_waitcnt vmcnt(1)
    s_barrier
    ds_read_b128 v[144:147], v0 offset:28672
    v_add_f32 v59, 0x3727c5ac, v59
    v_rsq_f32 v61, v59
    s_nop 0
    v_mul_f32 v49, 0xbfb8aa3b, v61
    s_waitcnt lgkmcnt(3)
    v_mfma_f32_32x32x16_bf16 v[96:111], a[240:243], v[128:131], v[96:111]
    ds_read_b128 v[148:151], v0 offset:29696
    v_mul_f32 v48, v60, v49
    v_mov_b32 v51, v49
    v_sub_f32 v48, 0, v48
    s_add_u32 s29, s3, 6
    v_mov_b32 v12, s29
    s_waitcnt vmcnt(0)
    buffer_store_dword v12, off, s[4:7], s34 sc0 sc1
    v_mfma_f32_32x32x16_bf16 v[96:111], a[244:247], v[132:135], v[96:111]
    ds_read_b128 v[128:131], v0 offset:30720
    v_permlane32_swap_b32 v49, v51
    v_mov_b32 v50, v48
    s_nop 1
    v_permlane32_swap_b32 v48, v50
    s_waitcnt lgkmcnt(3)
    v_mfma_f32_32x32x16_bf16 v[96:111], a[248:251], v[136:139], v[96:111]
    ds_read_b128 v[132:135], v0 offset:31744
    v_mfma_f32_32x32x16_bf16 v[96:111], a[252:255], v[140:143], v[96:111]
    ds_read_b128 v[136:139], v0 offset:32768
    buffer_load_dword v13, v9, s[4:7], 0 offen sc1
    s_waitcnt lgkmcnt(3)
    v_mfma_f32_32x32x16_bf16 v[112:127], v[176:179], v[144:147], 0
    ds_read_b128 v[140:143], v0 offset:33792
    v_mfma_f32_32x32x16_bf16 v[112:127], v[180:183], v[148:151], v[112:127]
    ds_read_b128 v[144:147], v0 offset:34816
    s_waitcnt lgkmcnt(3)
    v_mfma_f32_32x32x16_bf16 v[112:127], v[184:187], v[128:131], v[112:127]
    ds_read_b128 v[148:151], v0 offset:35840
    v_mfma_f32_32x32x16_bf16 v[112:127], v[188:191], v[132:135], v[112:127]
    ds_read_b128 v[128:131], v0 offset:36864
    s_waitcnt lgkmcnt(3)
    v_mfma_f32_32x32x16_bf16 v[112:127], v[192:195], v[136:139], v[112:127]
    ds_read_b128 v[132:135], v0 offset:37888
    v_mul_f32 v152, v48, v32
    v_mul_f32 v153, v48, v33
    v_mul_f32 v154, v48, v34
    v_mul_f32 v155, v48, v35
    v_fma_f32 v96, v49, v96, v152
    v_mfma_f32_32x32x16_bf16 v[112:127], v[196:199], v[140:143], v[112:127]
    ds_read_b128 v[136:139], v0 offset:38912
    v_fma_f32 v97, v49, v97, v153
    v_fma_f32 v98, v49, v98, v154
    v_fma_f32 v99, v49, v99, v155
    v_exp_f32 v152, v96
    s_waitcnt lgkmcnt(3)
    v_mfma_f32_32x32x16_bf16 v[112:127], v[200:203], v[144:147], v[112:127]
    ds_read_b128 v[140:143], v0 offset:39936
    v_exp_f32 v153, v97
    v_exp_f32 v154, v98
    v_exp_f32 v155, v99
    v_add_f32 v152, 1.0, v152
    v_mfma_f32_32x32x16_bf16 v[112:127], v[204:207], v[148:151], v[112:127]
    ds_read_b128 v[144:147], v0 offset:40960
    s_waitcnt vmcnt(0)
    s_add_u32 s40, s3, 6
    v_subrev_u32 v13, s40, v13
    v_cmp_gt_u32 vcc, 16, v13
    s_nop 0
    s_andn2_b64 s[40:41], s[36:37], vcc
    s_cbranch_scc1 Ls_spin_31
Ls_back_32:
    s_add_u32 m0, s53, 57344
    s_add_u32 s57, s47, 57344
    buffer_load_dwordx4 v0, s[4:7], s57 offen offset:0 sc1 lds
    v_add_f32 v153, 1.0, v153
    v_add_f32 v154, 1.0, v154
    v_add_f32 v155, 1.0, v155
    v_rcp_f32 v152, v152
    s_waitcnt lgkmcnt(3)
    v_mfma_f32_32x32x16_bf16 v[112:127], v[208:211], v[128:131], v[112:127]
    ds_read_b128 v[148:151], v0 offset:41984
    s_add_u32 m0, s53, 57344
    s_nop 0
    buffer_load_dwordx4 v0, s[4:7], s57 offen offset:1024 sc1 lds
    s_add_u32 m0, s53, 57344
    s_nop 0
    buffer_load_dwordx4 v0, s[4:7], s57 offen offset:2048 sc1 lds
    v_rcp_f32 v153, v153
    v_rcp_f32 v154, v154
    v_rcp_f32 v155, v155
    v_mul_f32 v96, v96, v152
    v_mul_f32 v97, v97, v153
    v_mfma_f32_32x32x16_bf16 v[112:127], v[212:215], v[132:135], v[112:127]
    ds_read_b128 v[128:131], v0 offset:43008
    s_add_u32 m0, s53, 57344
    s_nop 0
    buffer_load_dwordx4 v0, s[4:7], s57 offen offset:3072 sc1 lds
    s_add_u32 m0, s53, 61440
    s_add_u32 s57, s47, 61440
    buffer_load_dwordx4 v0, s[4:7], s57 offen offset:0 sc1 lds
    v_mul_f32 v98, v98, v154
    v_mul_f32 v99, v99, v155
    v_cvt_pk_bf16_f32 v160, v96, v97
    v_cvt_pk_bf16_f32 v161, v98, v99
    s_waitcnt lgkmcnt(3)
    v_mfma_f32_32x32x16_bf16 v[112:127], v[216:219], v[136:139], v[112:127]
    ds_read_b128 v[132:135], v0 offset:44032
    s_add_u32 m0, s53, 61440
    s_nop 0
    buffer_load_dwordx4 v0, s[4:7], s57 offen offset:1024 sc1 lds
    s_add_u32 m0, s53, 61440
    s_nop 0
    buffer_load_dwordx4 v0, s[4:7], s57 offen offset:2048 sc1 lds
    v_mul_f32 v152, v48, v36
    v_mul_f32 v153, v48, v37
    v_mul_f32 v154, v48, v38
    v_mul_f32 v155, v48, v39
    v_mfma_f32_32x32x16_bf16 v[112:127], v[220:223], v[140:143], v[112:127]
    ds_read_b128 v[136:139], v0 offset:45056
    v_fma_f32 v100, v49, v100, v152
    v_fma_f32 v101, v49, v101, v153
    v_fma_f32 v102, v49, v102, v154
    v_fma_f32 v103, v49, v103, v155
    s_waitcnt lgkmcnt(3)
    v_mfma_f32_32x32x16_bf16 v[112:127], v[224:227], v[144:147], v[112:127]
    ds_read_b128 v[140:143], v0 offset:46080
    v_exp_f32 v152, v100
    v_exp_f32 v153, v101
    v_exp_f32 v154, v102
    v_exp_f32 v155, v103
    v_add_f32 v152, 1.0, v152
    v_mfma_f32_32x32x16_bf16 v[112:127], v[228:231], v[148:151], v[112:127]
    ds_read_b128 v[144:147], v0 offset:47104
    v_add_f32 v153, 1.0, v153
    v_add_f32 v154, 1.0, v154
    v_add_f32 v155, 1.0, v155
    v_rcp_f32 v152, v152
    s_waitcnt lgkmcnt(3)
    v_mfma_f32_32x32x16_bf16 v[112:127], v[232:235], v[128:131], v[112:127]
    ds_read_b128 v[148:151], v0 offset:48128
    v_rcp_f32 v153, v153
    v_rcp_f32 v154, v154
    v_rcp_f32 v155, v155
    v_mul_f32 v100, v100, v152
    v_mfma_f32_32x32x16_bf16 v[112:127], v[236:239], v[132:135], v[112:127]
    ds_read_b128 v[128:131], v0 offset:49152
    v_mul_f32 v101, v101, v153
    v_mul_f32 v102, v102, v154
    v_mul_f32 v103, v103, v155
    v_cvt_pk_bf16_f32 v162, v100, v101
    s_waitcnt lgkmcnt(3)
    v_mfma_f32_32x32x16_bf16 v[112:127], v[240:243], v[136:139], v[112:127]
    ds_read_b128 v[132:135], v0 offset:50176
    v_cvt_pk_bf16_f32 v163, v102, v103
    s_add_u32 s30, s50, 0
    buffer_store_dwordx4 v[160:163], v0, s[4:7], s30 offen sc0 sc1
    v_mul_f32 v152, v48, v40
    v_mul_f32 v153, v48, v41
    v_mul_f32 v154, v48, v42
    v_mfma_f32_32x32x16_bf16 v[112:127], v[244:247], v[140:143], v[112:127]
    ds_read_b128 v[136:139], v0 offset:51200
    v_mul_f32 v155, v48, v43
    v_fma_f32 v104, v49, v104, v152
    v_fma_f32 v105, v49, v105, v153
    v_fma_f32 v106, v49, v106, v154
    s_waitcnt lgkmcnt(3)
    v_mfma_f32_32x32x16_bf16 v[112:127], v[248:251], v[144:147], v[112:127]
    ds_read_b128 v[140:143], v0 offset:52224
    v_fma_f32 v107, v49, v107, v155
    v_exp_f32 v152, v104
    v_exp_f32 v153, v105
    v_exp_f32 v154, v106
    v_mfma_f32_32x32x16_bf16 v[112:127], v[252:255], v[148:151], v[112:127]
    ds_read_b128 v[144:147], v0 offset:53248
    v_exp_f32 v155, v107
    v_add_f32 v152, 1.0, v152
    v_add_f32 v153, 1.0, v153
    v_add_f32 v154, 1.0, v154
    s_waitcnt lgkmcnt(3)
    v_mfma_f32_32x32x16_bf16 v[112:127], a[224:227], v[128:131], v[112:127]
    ds_read_b128 v[148:151], v0 offset:54272
    v_add_f32 v155, 1.0, v155
    v_rcp_f32 v152, v152
    v_rcp_f32 v153, v153
    v_rcp_f32 v154, v154
    v_rcp_f32 v155, v155
    v_mfma_f32_32x32x16_bf16 v[112:127], a[228:231], v[132:135], v[112:127]
    ds_read_b128 v[128:131], v0 offset:55296
    v_mul_f32 v104, v104, v152
    v_mul_f32 v105, v105, v153
    v_mul_f32 v106, v106, v154
    v_mul_f32 v107, v107, v155
    s_waitcnt lgkmcnt(3)
    v_mfma_f32_32x32x16_bf16 v[112:127], a[232:235], v[136:139], v[112:127]
    ds_read_b128 v[132:135], v0 offset:56320
    v_cvt_pk_bf16_f32 v164, v104, v105
    v_cvt_pk_bf16_f32 v165, v106, v107
    v_mul_f32 v152, v48, v44
    v_mul_f32 v153, v48, v45
    v_mfma_f32_32x32x16_bf16 v[112:127], a[236:239], v[140:143], v[112:127]
    s_waitcnt vmcnt(1)
    s_barrier
    ds_read_b128 v[136:139], v1 offset:0
    v_mul_f32 v154, v48, v46
    v_mul_f32 v155, v48, v47
    v_fma_f32 v108, v49, v108, v152
    v_fma_f32 v109, v49, v109, v153
    s_waitcnt lgkmcnt(3)
    v_mfma_f32_32x32x16_bf16 v[112:127], a[240:243], v[144:147], v[112:127]
    ds_read_b128 v[140:143], v1 offset:1024
    v_fma_f32 v110, v49, v110, v154
    v_fma_f32 v111, v49, v111, v155
    v_exp_f32 v152, v108
    v_exp_f32 v153, v109
    v_exp_f32 v154, v110
    v_mfma_f32_32x32x16_bf16 v[112:127], a[244:247], v[148:151], v[112:127]
    ds_read_b128 v[144:147], v1 offset:2048
    s_add_u32 m0, s53, 86016
    s_add_u32 s57, s47, 86016
    buffer_load_dwordx4 v0, s[4:7], s57 offen offset:0 sc1 lds
    v_exp_f32 v155, v111
    v_add_f32 v152, 1.0, v152
    v_add_f32 v153, 1.0, v153
    v_add_f32 v154, 1.0, v154
    s_waitcnt lgkmcnt(3)
    v_mfma_f32_32x32x16_bf16 v[112:127], a[248:251], v[128:131], v[112:127]
    ds_read_b128 v[148:151], v1 offset:3072
    s_add_u32 m0, s53, 86016
    s_nop 0
    buffer_load_dwordx4 v0, s[4:7], s57 offen offset:1024 sc1 lds
    v_add_f32 v155, 1.0, v155
    v_rcp_f32 v152, v152
    v_rcp_f32 v153, v153
    v_rcp_f32 v154, v154
    v_mfma_f32_32x32x16_bf16 v[112:127], a[252:255], v[132:135], v[112:127]
    ds_read_b128 v[128:131], v1 offset:4096
    v_rcp_f32 v155, v155
    v_mul_f32 v108, v108, v152
    v_mul_f32 v109, v109, v153
    v_mul_f32 v110, v110, v154
    s_waitcnt lgkmcnt(3)
    v_mfma_f32_32x32x16_bf16 v[64:79], v[176:179], v[136:139], 0
    ds_read_b128 v[132:135], v1 offset:5120
    s_add_u32 m0, s53, 86016
    s_nop 0
    buffer_load_dwordx4 v0, s[4:7], s57 offen offset:2048 sc1 lds
    v_mul_f32 v111, v111, v155
    v_cvt_pk_bf16_f32 v166, v108, v109
    v_cvt_pk_bf16_f32 v167, v110, v111
    s_add_u32 s30, s50, 0
    buffer_store_dwordx4 v[164:167], v0, s[4:7], s30 offen offset:1024 sc0 sc1
    v_mfma_f32_32x32x16_bf16 v[64:79], v[180:183], v[140:143], v[64:79]
    ds_read_b128 v[136:139], v1 offset:6144
    s_waitcnt lgkmcnt(3)
    v_mfma_f32_32x32x16_bf16 v[64:79], v[184:187], v[144:147], v[64:79]
    ds_read_b128 v[140:143], v1 offset:7168
    s_add_u32 m0, s53, 86016
    s_nop 0
    buffer_load_dwordx4 v0, s[4:7], s57 offen offset:3072 sc1 lds
    v_mfma_f32_32x32x16_bf16 v[64:79], v[188:191], v[148:151], v[64:79]
    ds_read_b128 v[144:147], v1 offset:8192
    v_mul_f32 v152, v50, v32
    v_mul_f32 v153, v50, v33
    v_mul_f32 v154, v50, v34
    v_mul_f32 v155, v50, v35
    v_fma_f32 v112, v51, v112, v152
    v_fma_f32 v113, v51, v113, v153
    s_waitcnt lgkmcnt(3)
    v_mfma_f32_32x32x16_bf16 v[64:79], v[192:195], v[128:131], v[64:79]
    ds_read_b128 v[148:151], v1 offset:9216
    s_add_u32 m0, s53, 90112
    s_add_u32 s57, s47, 90112
    buffer_load_dwordx4 v0, s[4:7], s57 offen offset:0 sc1 lds
    v_fma_f32 v114, v51, v114, v154
    v_fma_f32 v115, v51, v115, v155
    v_exp_f32 v152, v112
    v_exp_f32 v153, v113
    v_exp_f32 v154, v114
    v_mfma_f32_32x32x16_bf16 v[64:79], v[196:199], v[132:135], v[64:79]
    ds_read_b128 v[128:131], v1 offset:10240
    v_exp_f32 v155, v115
    v_add_f32 v152, 1.0, v152
    v_add_f32 v153, 1.0, v153
    v_add_f32 v154, 1.0, v154
    v_add_f32 v155, 1.0, v155
    s_waitcnt lgkmcnt(3)
    v_mfma_f32_32x32x16_bf16 v[64:79], v[200:203], v[136:139], v[64:79]
    ds_read_b128 v[132:135], v1 offset:11264
    s_add_u32 m0, s53, 90112
    s_nop 0
    buffer_load_dwordx4 v0, s[4:7], s57 offen offset:1024 sc1 lds
    v_rcp_f32 v152, v152
    v_rcp_f32 v153, v153
    v_rcp_f32 v154, v154
    v_rcp_f32 v155, v155
    v_mul_f32 v112, v112, v152
    v_mul_f32 v113, v113, v153
    v_mfma_f32_32x32x16_bf16 v[64:79], v[204:207], v[140:143], v[64:79]
    ds_read_b128 v[136:139], v1 offset:12288
    v_mul_f32 v114, v114, v154
    v_mul_f32 v115, v115, v155
    v_cvt_pk_bf16_f32 v160, v112, v113
    v_cvt_pk_bf16_f32 v161, v114, v115
    v_mul_f32 v152, v50, v36
    s_waitcnt lgkmcnt(3)
    v_mfma_f32_32x32x16_bf16 v[64:79], v[208:211], v[144:147], v[64:79]
    ds_read_b128 v[140:143], v1 offset:13312
    s_add_u32 m0, s53, 90112
    s_nop 0
    buffer_load_dwordx4 v0, s[4:7], s57 offen offset:2048 sc1 lds
    v_mul_f32 v153, v50, v37
    v_mul_f32 v154, v50, v38
    v_mul_f32 v155, v50, v39
    v_fma_f32 v116, v51, v116, v152
    v_fma_f32 v117, v51, v117, v153
    v_mfma_f32_32x32x16_bf16 v[64:79], v[212:215], v[148:151], v[64:79]
    ds_read_b128 v[144:147], v1 offset:14336
    v_fma_f32 v118, v51, v118, v154
    v_fma_f32 v119, v51, v119, v155
    v_exp_f32 v152, v116
    v_exp_f32 v153, v117
    v_exp_f32 v154, v118
    v_exp_f32 v155, v119
    s_waitcnt lgkmcnt(3)
    v_mfma_f32_32x32x16_bf16 v[64:79], v[216:219], v[128:131], v[64:79]
    ds_read_b128 v[148:151], v1 offset:15360
    v_add_f32 v152, 1.0, v152
    v_add_f32 v153, 1.0, v153
    v_add_f32 v154, 1.0, v154
    v_add_f32 v155, 1.0, v155
    v_rcp_f32 v152, v152
    v_mfma_f32_32x32x16_bf16 v[64:79], v[220:223], v[132:135], v[64:79]
    ds_read_b128 v[128:131], v1 offset:16384
    v_rcp_f32 v153, v153
    v_rcp_f32 v154, v154
    v_rcp_f32 v155, v155
    v_mul_f32 v116, v116, v152
    v_mul_f32 v117, v117, v153
    s_waitcnt lgkmcnt(3)
    v_mfma_f32_32x32x16_bf16 v[64:79], v[224:227], v[136:139], v[64:79]
    ds_read_b128 v[132:135], v1 offset:17408
    v_mul_f32 v118, v118, v154
    v_mul_f32 v119, v119, v155
    v_cvt_pk_bf16_f32 v162, v116, v117
    v_cvt_pk_bf16_f32 v163, v118, v119
    s_add_u32 s30, s50, 114688
    buffer_store_dwordx4 v[160:163], v0, s[4:7], s30 offen sc0 sc1
    v_mfma_f32_32x32x16_bf16 v[64:79], v[228:231], v[140:143], v[64:79]
    ds_read_b128 v[136:139], v1 offset:18432
    v_mul_f32 v152, v50, v40
    v_mul_f32 v153, v50, v41
    v_mul_f32 v154, v50, v42
    v_mul_f32 v155, v50, v43
    v_fma_f32 v120, v51, v120, v152
    v_fma_f32 v121, v51, v121, v153
    s_waitcnt lgkmcnt(3)
    v_mfma_f32_32x32x16_bf16 v[64:79], v[232:235], v[144:147], v[64:79]
    ds_read_b128 v[140:143], v1 offset:19456
    s_add_u32 s58, s51, 397312
    buffer_load_dwordx4 v[96:99], v5, s[4:7], s58 offen offset:0 sc1
    buffer_load_dwordx4 v[100:103], v5, s[4:7], s58 offen offset:512 sc1
    buffer_load_dwordx4 v[104:107], v5, s[4:7], s58 offen offset:1024 sc1
    buffer_load_dwordx4 v[108:111], v5, s[4:7], s58 offen offset:1536 sc1
    v_fma_f32 v122, v51, v122, v154
    v_fma_f32 v123, v51, v123, v155
    v_exp_f32 v152, v120
    v_exp_f32 v153, v121
    v_exp_f32 v154, v122
    v_mfma_f32_32x32x16_bf16 v[64:79], v[236:239], v[148:151], v[64:79]
    ds_read_b128 v[144:147], v1 offset:20480
    v_exp_f32 v155, v123
    v_add_f32 v152, 1.0, v152
    v_add_f32 v153, 1.0, v153
    v_add_f32 v154, 1.0, v154
    v_add_f32 v155, 1.0, v155
    s_waitcnt lgkmcnt(3)
    v_mfma_f32_32x32x16_bf16 v[64:79], v[240:243], v[128:131], v[64:79]
    ds_read_b128 v[148:151], v1 offset:21504
    v_rcp_f32 v152, v152
    v_rcp_f32 v153, v153
    v_rcp_f32 v154, v154
    v_rcp_f32 v155, v155
    v_mul_f32 v120, v120, v152
    v_mul_f32 v121, v121, v153
    v_mfma_f32_32x32x16_bf16 v[64:79], v[244:247], v[132:135], v[64:79]
    ds_read_b128 v[128:131], v1 offset:22528
    v_mul_f32 v122, v122, v154
    v_mul_f32 v123, v123, v155
    v_cvt_pk_bf16_f32 v164, v120, v121
    v_cvt_pk_bf16_f32 v165, v122, v123
    v_mul_f32 v152, v50, v44
    s_waitcnt lgkmcnt(3)
    v_mfma_f32_32x32x16_bf16 v[64:79], v[248:251], v[136:139], v[64:79]
    ds_read_b128 v[132:135], v1 offset:23552
    v_mul_f32 v153, v50, v45
    v_mul_f32 v154, v50, v46
    v_mul_f32 v155, v50, v47
    v_fma_f32 v124, v51, v124, v152
    v_fma_f32 v125, v51, v125, v153
    v_mfma_f32_32x32x16_bf16 v[64:79], v[252:255], v[140:143], v[64:79]
    ds_read_b128 v[136:139], v1 offset:24576
    v_fma_f32 v126, v51, v126, v154
    v_fma_f32 v127, v51, v127, v155
    v_exp_f32 v152, v124
    v_exp_f32 v153, v125
    v_exp_f32 v154, v126
    v_exp_f32 v155, v127
    s_waitcnt lgkmcnt(3)
    v_mfma_f32_32x32x16_bf16 v[64:79], a[224:227], v[144:147], v[64:79]
    ds_read_b128 v[140:143], v1 offset:25600
    v_add_f32 v152, 1.0, v152
    v_add_f32 v153, 1.0, v153
    v_add_f32 v154, 1.0, v154
    v_add_f32 v155, 1.0, v155
    v_rcp_f32 v152, v152
    v_mfma_f32_32x32x16_bf16 v[64:79], a[228:231], v[148:151], v[64:79]
    ds_read_b128 v[144:147], v1 offset:26624
    v_rcp_f32 v153, v153
    v_rcp_f32 v154, v154
    v_rcp_f32 v155, v155
    v_mul_f32 v124, v124, v152
    v_mul_f32 v125, v125, v153
    s_waitcnt lgkmcnt(3)
    v_mfma_f32_32x32x16_bf16 v[64:79], a[232:235], v[128:131], v[64:79]
    ds_read_b128 v[148:151], v1 offset:27648
    v_mul_f32 v126, v126, v154
    v_mul_f32 v127, v127, v155
    v_cvt_pk_bf16_f32 v166, v124, v125
    v_cvt_pk_bf16_f32 v167, v126, v127
    s_add_u32 s30, s50, 114688
    buffer_store_dwordx4 v[164:167], v0, s[4:7], s30 offen offset:1024 sc0 sc1
    v_mfma_f32_32x32x16_bf16 v[64:79], a[236:239], v[132:135], v[64:79]
    s_waitcnt vmcnt(6)
    s_barrier
    ds_read_b128 v[128:131], v1 offset:28672
    s_waitcnt lgkmcnt(3)
    v_mfma_f32_32x32x16_bf16 v[64:79], a[240:243], v[136:139], v[64:79]
    ds_read_b128 v[132:135], v1 offset:29696
    s_waitcnt vmcnt(1)
    v_add_f32 v58, v96, v98
    v_add_f32 v59, v97, v99
    v_add_f32 v60, v100, v102
    v_add_f32 v61, v101, v103
    v_mfma_f32_32x32x16_bf16 v[64:79], a[244:247], v[140:143], v[64:79]
    ds_read_b128 v[136:139], v1 offset:30720
    v_add_f32 v58, v58, v104
    v_add_f32 v59, v59, v105
    v_add_f32 v60, v60, v106
    v_add_f32 v61, v61, v107
    s_waitcnt lgkmcnt(3)
    v_mfma_f32_32x32x16_bf16 v[64:79], a[248:251], v[144:147], v[64:79]
    ds_read_b128 v[140:143], v1 offset:31744
    v_add_f32 v58, v58, v108
    v_add_f32 v59, v59, v109
    v_add_f32 v58, v58, v60
    v_mfma_f32_32x32x16_bf16 v[64:79], a[252:255], v[148:151], v[64:79]
    ds_read_b128 v[144:147], v1 offset:32768
    v_add_f32 v59, v59, v61
    v_mul_f32 v60, 0.002232142857142857, v58
    v_mul_f32 v59, 0.002232142857142857, v59
    v_fma_f32 v59, -v60, v60, v59
    s_waitcnt lgkmcnt(3)
    v_mfma_f32_32x32x16_bf16 v[80:95], v[176:179], v[128:131], 0
    ds_read_b128 v[148:151], v1 offset:33792
    v_max_f32 v59, 0, v59
    v_add_f32 v59, 0x3727c5ac, v59
    v_rsq_f32 v61, v59
    s_add_u32 s29, s3, 7
    v_mov_b32 v12, s29
    s_waitcnt vmcnt(0)
    buffer_store_dword v12, off, s[4:7], s34 sc0 sc1
    v_mfma_f32_32x32x16_bf16 v[80:95], v[180:183], v[132:135], v[80:95]
    ds_read_b128 v[128:131], v1 offset:34816
    v_mul_f32 v53, 0xbfb8aa3b, v61
    v_mul_f32 v52, v60, v53
    v_mov_b32 v55, v53
    v_sub_f32 v52, 0, v52
    s_waitcnt lgkmcnt(3)
    v_mfma_f32_32x32x16_bf16 v[80:95], v[184:187], v[136:139], v[80:95]
    ds_read_b128 v[132:135], v1 offset:35840
    v_permlane32_swap_b32 v53, v55
    v_mov_b32 v54, v52
    s_nop 1
    v_permlane32_swap_b32 v52, v54
    v_mfma_f32_32x32x16_bf16 v[80:95], v[188:191], v[140:143], v[80:95]
    ds_read_b128 v[136:139], v1 offset:36864
    s_waitcnt lgkmcnt(3)
    v_mfma_f32_32x32x16_bf16 v[80:95], v[192:195], v[144:147], v[80:95]
    ds_read_b128 v[140:143], v1 offset:37888
    v_mul_f32 v152, v52, v32
    v_mul_f32 v153, v52, v33
    v_mul_f32 v154, v52, v34
    v_mul_f32 v155, v52, v35
    v_fma_f32 v64, v53, v64, v152
    v_mfma_f32_32x32x16_bf16 v[80:95], v[196:199], v[148:151], v[80:95]
    ds_read_b128 v[144:147], v1 offset:38912
    v_fma_f32 v65, v53, v65, v153
    v_fma_f32 v66, v53, v66, v154
    v_fma_f32 v67, v53, v67, v155
    v_exp_f32 v152, v64
    s_waitcnt lgkmcnt(3)
    v_mfma_f32_32x32x16_bf16 v[80:95], v[200:203], v[128:131], v[80:95]
    ds_read_b128 v[148:151], v1 offset:39936
    v_exp_f32 v153, v65
    v_exp_f32 v154, v66
    v_exp_f32 v155, v67
    v_add_f32 v152, 1.0, v152
    v_add_f32 v153, 1.0, v153
    v_mfma_f32_32x32x16_bf16 v[80:95], v[204:207], v[132:135], v[80:95]
    ds_read_b128 v[128:131], v1 offset:40960
    v_add_f32 v154, 1.0, v154
    v_add_f32 v155, 1.0, v155
    v_rcp_f32 v152, v152
    v_rcp_f32 v153, v153
    buffer_load_dword v14, v9, s[4:7], 0 offen sc1
    s_waitcnt lgkmcnt(3)
    v_mfma_f32_32x32x16_bf16 v[80:95], v[208:211], v[136:139], v[80:95]
    ds_read_b128 v[132:135], v1 offset:41984
    v_rcp_f32 v154, v154
    v_rcp_f32 v155, v155
    v_mul_f32 v64, v64, v152
    v_mul_f32 v65, v65, v153
    v_mul_f32 v66, v66, v154
    v_mfma_f32_32x32x16_bf16 v[80:95], v[212:215], v[140:143], v[80:95]
    ds_read_b128 v[136:139], v1 offset:43008
    v_mul_f32 v67, v67, v155
    v_cvt_pk_bf16_f32 v160, v64, v65
    v_cvt_pk_bf16_f32 v161, v66, v67
    v_mul_f32 v152, v52, v36
    s_waitcnt lgkmcnt(3)
    v_mfma_f32_32x32x16_bf16 v[80:95], v[216:219], v[144:147], v[80:95]
    ds_read_b128 v[140:143], v1 offset:44032
    v_mul_f32 v153, v52, v37
    v_mul_f32 v154, v52, v38
    v_mul_f32 v155, v52, v39
    v_fma_f32 v68, v53, v68, v152
    v_mfma_f32_32x32x16_bf16 v[80:95], v[220:223], v[148:151], v[80:95]
    ds_read_b128 v[144:147], v1 offset:45056
    v_fma_f32 v69, v53, v69, v153
    v_fma_f32 v70, v53, v70, v154
    v_fma_f32 v71, v53, v71, v155
    v_exp_f32 v152, v68
    v_exp_f32 v153, v69
    s_waitcnt lgkmcnt(3)
    v_mfma_f32_32x32x16_bf16 v[80:95], v[224:227], v[128:131], v[80:95]
    ds_read_b128 v[148:151], v1 offset:46080
    v_exp_f32 v154, v70
    v_exp_f32 v155, v71
    v_add_f32 v152, 1.0, v152
    v_add_f32 v153, 1.0, v153
    v_mfma_f32_32x32x16_bf16 v[80:95], v[228:231], v[132:135], v[80:95]
    ds_read_b128 v[128:131], v1 offset:47104
    v_add_f32 v154, 1.0, v154
    v_add_f32 v155, 1.0, v155
    v_rcp_f32 v152, v152
    v_rcp_f32 v153, v153
    v_rcp_f32 v154, v154
    s_waitcnt lgkmcnt(3)
    v_mfma_f32_32x32x16_bf16 v[80:95], v[232:235], v[136:139], v[80:95]
    ds_read_b128 v[132:135], v1 offset:48128
    v_rcp_f32 v155, v155
    v_mul_f32 v68, v68, v152
    v_mul_f32 v69, v69, v153
    v_mul_f32 v70, v70, v154
    v_mfma_f32_32x32x16_bf16 v[80:95], v[236:239], v[140:143], v[80:95]
    ds_read_b128 v[136:139], v1 offset:49152
    v_mul_f32 v71, v71, v155
    v_cvt_pk_bf16_f32 v162, v68, v69
    v_cvt_pk_bf16_f32 v163, v70, v71
    s_add_u32 s30, s50, 229376
    buffer_store_dwordx4 v[160:163], v0, s[4:7], s30 offen sc0 sc1
    s_waitcnt vmcnt(1)
    s_add_u32 s40, s3, 7
    v_subrev_u32 v14, s40, v14
    v_cmp_gt_u32 vcc, 16, v14
    s_nop 0
    s_andn2_b64 s[40:41], s[38:39], vcc
    s_cbranch_scc1 Ls_spin_34
Ls_back_35:
    s_add_u32 s60, s49, 0
    buffer_load_dwordx4 v[168:171], v0, s[4:7], s60 offen offset:0 sc1
    s_waitcnt lgkmcnt(3)
    v_mfma_f32_32x32x16_bf16 v[80:95], v[240:243], v[144:147], v[80:95]
    ds_read_b128 v[140:143], v1 offset:50176
    v_mul_f32 v152, v52, v40
    v_mul_f32 v153, v52, v41
    v_mul_f32 v154, v52, v42
    v_mul_f32 v155, v52, v43
    v_fma_f32 v72, v53, v72, v152
    buffer_load_dwordx4 v[172:175], v0, s[4:7], s60 offen offset:1024 sc1
    v_mfma_f32_32x32x16_bf16 v[80:95], v[244:247], v[148:151], v[80:95]
    ds_read_b128 v[144:147], v1 offset:51200
    v_fma_f32 v73, v53, v73, v153
    v_fma_f32 v74, v53, v74, v154
    v_fma_f32 v75, v53, v75, v155
    v_exp_f32 v152, v72
    s_waitcnt lgkmcnt(3)
    v_mfma_f32_32x32x16_bf16 v[80:95], v[248:251], v[128:131], v[80:95]
    ds_read_b128 v[148:151], v1 offset:52224
    v_exp_f32 v153, v73
    v_exp_f32 v154, v74
    v_exp_f32 v155, v75
    v_add_f32 v152, 1.0, v152
    v_add_f32 v153, 1.0, v153
    buffer_load_dwordx4 v[156:159], v0, s[4:7], s60 offen offset:2048 sc1
    v_mfma_f32_32x32x16_bf16 v[80:95], v[252:255], v[132:135], v[80:95]
    ds_read_b128 v[128:131], v1 offset:53248
    v_add_f32 v154, 1.0, v154
    v_add_f32 v155, 1.0, v155
    v_rcp_f32 v152, v152
    v_rcp_f32 v153, v153
    s_waitcnt lgkmcnt(3)
    v_mfma_f32_32x32x16_bf16 v[80:95], a[224:227], v[136:139], v[80:95]
    ds_read_b128 v[132:135], v1 offset:54272
    v_rcp_f32 v154, v154
    v_rcp_f32 v155, v155
    v_mul_f32 v72, v72, v152
    v_mul_f32 v73, v73, v153
    v_mul_f32 v74, v74, v154
    v_mfma_f32_32x32x16_bf16 v[80:95], a[228:231], v[140:143], v[80:95]
    ds_read_b128 v[136:139], v1 offset:55296
    v_mul_f32 v75, v75, v155
    v_cvt_pk_bf16_f32 v164, v72, v73
    v_cvt_pk_bf16_f32 v165, v74, v75
    v_mul_f32 v152, v52, v44
    s_waitcnt lgkmcnt(3)
    v_mfma_f32_32x32x16_bf16 v[80:95], a[232:235], v[144:147], v[80:95]
    ds_read_b128 v[140:143], v1 offset:56320
    v_mul_f32 v153, v52, v45
    v_mul_f32 v154, v52, v46
    v_mul_f32 v155, v52, v47
    v_fma_f32 v76, v53, v76, v152
    buffer_load_dwordx4 v[144:147], v0, s[4:7], s60 offen offset:3072 sc1
    v_mfma_f32_32x32x16_bf16 v[80:95], a[236:239], v[148:151], v[80:95]
    v_fma_f32 v77, v53, v77, v153
    v_fma_f32 v78, v53, v78, v154
    v_fma_f32 v79, v53, v79, v155
    v_exp_f32 v152, v76
    v_exp_f32 v153, v77
    s_add_u32 s60, s49, 4096
    buffer_load_dwordx4 v[148:151], v0, s[4:7], s60 offen offset:0 sc1
    s_waitcnt lgkmcnt(2)
    v_mfma_f32_32x32x16_bf16 v[80:95], a[240:243], v[128:131], v[80:95]
    v_exp_f32 v154, v78
    v_exp_f32 v155, v79
    v_add_f32 v152, 1.0, v152
    v_add_f32 v153, 1.0, v153
    buffer_load_dwordx4 v[128:131], v0, s[4:7], s60 offen offset:1024 sc1
    v_mfma_f32_32x32x16_bf16 v[80:95], a[244:247], v[132:135], v[80:95]
    v_add_f32 v154, 1.0, v154
    v_add_f32 v155, 1.0, v155
    v_rcp_f32 v152, v152
    v_rcp_f32 v153, v153
    v_rcp_f32 v154, v154
    s_waitcnt lgkmcnt(0)
    v_mfma_f32_32x32x16_bf16 v[80:95], a[248:251], v[136:139], v[80:95]
    v_rcp_f32 v155, v155
    v_mul_f32 v76, v76, v152
    v_mul_f32 v77, v77, v153
    v_mul_f32 v78, v78, v154
    buffer_load_dwordx4 v[132:135], v0, s[4:7], s60 offen offset:2048 sc1
    v_mfma_f32_32x32x16_bf16 v[80:95], a[252:255], v[140:143], v[80:95]
    v_mul_f32 v79, v79, v155
    v_cvt_pk_bf16_f32 v166, v76, v77
    v_cvt_pk_bf16_f32 v167, v78, v79
    s_add_u32 s30, s50, 229376
    buffer_store_dwordx4 v[164:167], v0, s[4:7], s30 offen offset:1024 sc0 sc1
    s_waitcnt vmcnt(7)
    v_mfma_f32_32x32x16_bf16 v[96:111], a[0:3], v[168:171], 0
    buffer_load_dwordx4 v[136:139], v0, s[4:7], s60 offen offset:3072 sc1
    v_mfma_f32_32x32x16_bf16 v[112:127], a[4:7], v[168:171], 0
    v_mul_f32 v152, v54, v32
    v_mul_f32 v153, v54, v33
    v_mul_f32 v154, v54, v34
    v_mul_f32 v155, v54, v35
    v_fma_f32 v80, v55, v80, v152
    v_fma_f32 v81, v55, v81, v153
    v_fma_f32 v82, v55, v82, v154
    v_fma_f32 v83, v55, v83, v155
    v_exp_f32 v152, v80
    s_waitcnt vmcnt(7)
    v_mfma_f32_32x32x16_bf16 v[96:111], a[8:11], v[172:175], v[96:111]
    v_exp_f32 v153, v81
    v_exp_f32 v154, v82
    v_exp_f32 v155, v83
    v_add_f32 v152, 1.0, v152
    v_add_f32 v153, 1.0, v153
    v_add_f32 v154, 1.0, v154
    v_add_f32 v155, 1.0, v155
    v_rcp_f32 v152, v152
    s_add_u32 s60, s49, 8192
    buffer_load_dwordx4 v[140:143], v0, s[4:7], s60 offen offset:0 sc1
    v_mfma_f32_32x32x16_bf16 v[112:127], a[12:15], v[172:175], v[112:127]
    v_rcp_f32 v153, v153
    v_rcp_f32 v154, v154
    v_rcp_f32 v155, v155
    v_mul_f32 v80, v80, v152
    v_mul_f32 v81, v81, v153
    v_mul_f32 v82, v82, v154
    v_mul_f32 v83, v83, v155
    v_cvt_pk_bf16_f32 v160, v80, v81
    s_waitcnt vmcnt(7)
    v_mfma_f32_32x32x16_bf16 v[96:111], a[16:19], v[156:159], v[96:111]
    v_cvt_pk_bf16_f32 v161, v82, v83
    v_mul_f32 v152, v54, v36
    v_mul_f32 v153, v54, v37
    v_mul_f32 v154, v54, v38
    v_mul_f32 v155, v54, v39
    v_fma_f32 v84, v55, v84, v152
    v_fma_f32 v85, v55, v85, v153
    v_fma_f32 v86, v55, v86, v154
    buffer_load_dwordx4 v[168:171], v0, s[4:7], s60 offen offset:1024 sc1
    v_mfma_f32_32x32x16_bf16 v[112:127], a[20:23], v[156:159], v[112:127]
    v_fma_f32 v87, v55, v87, v155
    v_exp_f32 v152, v84
    v_exp_f32 v153, v85
    v_exp_f32 v154, v86
    v_exp_f32 v155, v87
    v_add_f32 v152, 1.0, v152
    v_add_f32 v153, 1.0, v153
    v_add_f32 v154, 1.0, v154
    s_waitcnt vmcnt(7)
    v_mfma_f32_32x32x16_bf16 v[96:111], a[24:27], v[144:147], v[96:111]
    v_add_f32 v155, 1.0, v155
    v_rcp_f32 v152, v152
    v_rcp_f32 v153, v153
    v_rcp_f32 v154, v154
    v_rcp_f32 v155, v155
    v_mul_f32 v84, v84, v152
    v_mul_f32 v85, v85, v153
    v_mul_f32 v86, v86, v154
    buffer_load_dwordx4 v[172:175], v0, s[4:7], s60 offen offset:2048 sc1
    v_mfma_f32_32x32x16_bf16 v[112:127], a[28:31], v[144:147], v[112:127]
    v_mul_f32 v87, v87, v155
    v_cvt_pk_bf16_f32 v162, v84, v85
    v_cvt_pk_bf16_f32 v163, v86, v87
    s_add_u32 s30, s50, 344064
    buffer_store_dwordx4 v[160:163], v0, s[4:7], s30 offen sc0 sc1
    v_mul_f32 v152, v54, v40
    v_mul_f32 v153, v54, v41
    v_mul_f32 v154, v54, v42
    v_mul_f32 v155, v54, v43
    v_fma_f32 v88, v55, v88, v152
    s_waitcnt vmcnt(8)
    v_mfma_f32_32x32x16_bf16 v[96:111], a[32:35], v[148:151], v[96:111]
    v_fma_f32 v89, v55, v89, v153
    v_fma_f32 v90, v55, v90, v154
    v_fma_f32 v91, v55, v91, v155
    v_exp_f32 v152, v88
    v_exp_f32 v153, v89
    v_exp_f32 v154, v90
    v_exp_f32 v155, v91
    v_add_f32 v152, 1.0, v152
    buffer_load_dwordx4 v[144:147], v0, s[4:7], s60 offen offset:3072 sc1
    v_mfma_f32_32x32x16_bf16 v[112:127], a[36:39], v[148:151], v[112:127]
    v_add_f32 v153, 1.0, v153
    v_add_f32 v154, 1.0, v154
    v_add_f32 v155, 1.0, v155
    v_rcp_f32 v152, v152
    v_rcp_f32 v153, v153
    v_rcp_f32 v154, v154
    v_rcp_f32 v155, v155
    v_mul_f32 v88, v88, v152
    s_waitcnt vmcnt(8)
    v_mfma_f32_32x32x16_bf16 v[96:111], a[40:43], v[128:131], v[96:111]
    v_mul_f32 v89, v89, v153
    v_mul_f32 v90, v90, v154
    v_mul_f32 v91, v91, v155
    v_cvt_pk_bf16_f32 v164, v88, v89
    v_cvt_pk_bf16_f32 v165, v90, v91
    v_mul_f32 v152, v54, v44
    v_mul_f32 v153, v54, v45
    v_mul_f32 v154, v54, v46
    s_add_u32 s60, s49, 12288
    buffer_load_dwordx4 v[148:151], v0, s[4:7], s60 offen offset:0 sc1
    v_mfma_f32_32x32x16_bf16 v[112:127], a[44:47], v[128:131], v[112:127]
    v_mul_f32 v155, v54, v47
    v_fma_f32 v92, v55, v92, v152
    v_fma_f32 v93, v55, v93, v153
    v_fma_f32 v94, v55, v94, v154
    v_fma_f32 v95, v55, v95, v155
    v_exp_f32 v152, v92
    v_exp_f32 v153, v93
    v_exp_f32 v154, v94
    s_waitcnt vmcnt(8)
    v_mfma_f32_32x32x16_bf16 v[96:111], a[48:51], v[132:135], v[96:111]
    v_exp_f32 v155, v95
    v_add_f32 v152, 1.0, v152
    v_add_f32 v153, 1.0, v153
    v_add_f32 v154, 1.0, v154
    v_add_f32 v155, 1.0, v155
    v_rcp_f32 v152, v152
    v_rcp_f32 v153, v153
    v_rcp_f32 v154, v154
    buffer_load_dwordx4 v[128:131], v0, s[4:7], s60 offen offset:1024 sc1
    v_mfma_f32_32x32x16_bf16 v[112:127], a[52:55], v[132:135], v[112:127]
    v_rcp_f32 v155, v155
    v_mul_f32 v92, v92, v152
    v_mul_f32 v93, v93, v153
    v_mul_f32 v94, v94, v154
    v_mul_f32 v95, v95, v155
    v_cvt_pk_bf16_f32 v166, v92, v93
    v_cvt_pk_bf16_f32 v167, v94, v95
    s_add_u32 s30, s50, 344064
    buffer_store_dwordx4 v[164:167], v0, s[4:7], s30 offen offset:1024 sc0 sc1
    s_waitcnt vmcnt(8)
    v_mfma_f32_32x32x16_bf16 v[96:111], a[56:59], v[136:139], v[96:111]
    buffer_load_dwordx4 v[132:135], v0, s[4:7], s60 offen offset:2048 sc1
    v_mfma_f32_32x32x16_bf16 v[112:127], a[60:63], v[136:139], v[112:127]
    s_waitcnt vmcnt(8)
    v_mfma_f32_32x32x16_bf16 v[96:111], a[64:67], v[140:143], v[96:111]
    buffer_load_dwordx4 v[136:139], v0, s[4:7], s60 offen offset:3072 sc1
    v_mfma_f32_32x32x16_bf16 v[112:127], a[68:71], v[140:143], v[112:127]
    s_waitcnt vmcnt(8)
    v_mfma_f32_32x32x16_bf16 v[96:111], a[72:75], v[168:171], v[96:111]
    s_add_u32 s60, s49, 16384
    buffer_load_dwordx4 v[140:143], v0, s[4:7], s60 offen offset:0 sc1
    v_mfma_f32_32x32x16_bf16 v[112:127], a[76:79], v[168:171], v[112:127]
    s_waitcnt vmcnt(8)
    v_mfma_f32_32x32x16_bf16 v[96:111], a[80:83], v[172:175], v[96:111]
    s_add_u32 s29, s3, 8
    v_mov_b32 v12, s29
    s_waitcnt vmcnt(3)
    buffer_store_dword v12, off, s[4:7], s34 sc0 sc1
    buffer_load_dwordx4 v[168:171], v0, s[4:7], s60 offen offset:1024 sc1
    v_mfma_f32_32x32x16_bf16 v[112:127], a[84:87], v[172:175], v[112:127]
    s_waitcnt vmcnt(8)
    v_mfma_f32_32x32x16_bf16 v[96:111], a[88:91], v[144:147], v[96:111]
    buffer_load_dwordx4 v[172:175], v0, s[4:7], s60 offen offset:2048 sc1
    v_mfma_f32_32x32x16_bf16 v[112:127], a[92:95], v[144:147], v[112:127]
    s_waitcnt vmcnt(8)
    v_mfma_f32_32x32x16_bf16 v[96:111], a[96:99], v[148:151], v[96:111]
    buffer_load_dwordx4 v[144:147], v0, s[4:7], s60 offen offset:3072 sc1
    v_mfma_f32_32x32x16_bf16 v[112:127], a[100:103], v[148:151], v[112:127]
    s_waitcnt vmcnt(8)
    v_mfma_f32_32x32x16_bf16 v[96:111], a[104:107], v[128:131], v[96:111]
    s_add_u32 s60, s49, 20480
    buffer_load_dwordx4 v[148:151], v0, s[4:7], s60 offen offset:0 sc1
    v_mfma_f32_32x32x16_bf16 v[112:127], a[108:111], v[128:131], v[112:127]
    s_waitcnt vmcnt(7)
    v_mfma_f32_32x32x16_bf16 v[96:111], a[112:115], v[132:135], v[96:111]
    buffer_load_dwordx4 v[128:131], v0, s[4:7], s60 offen offset:1024 sc1
    v_mfma_f32_32x32x16_bf16 v[112:127], a[116:119], v[132:135], v[112:127]
    s_waitcnt vmcnt(7)
    v_mfma_f32_32x32x16_bf16 v[96:111], a[120:123], v[136:139], v[96:111]
    buffer_load_dwordx4 v[132:135], v0, s[4:7], s60 offen offset:2048 sc1
    v_mfma_f32_32x32x16_bf16 v[112:127], a[124:127], v[136:139], v[112:127]
    buffer_load_dwordx4 v[136:139], v0, s[4:7], s60 offen offset:3072 sc1
    s_waitcnt vmcnt(8)
    v_mfma_f32_32x32x16_bf16 v[96:111], a[128:131], v[140:143], v[96:111]
    s_add_u32 s60, s49, 24576
    buffer_load_dwordx4 v[156:159], v0, s[4:7], s60 offen offset:0 sc1
    v_mfma_f32_32x32x16_bf16 v[112:127], a[132:135], v[140:143], v[112:127]
    buffer_load_dwordx4 v[140:143], v0, s[4:7], s60 offen offset:1024 sc1
    s_waitcnt vmcnt(8)
    v_mfma_f32_32x32x16_bf16 v[96:111], a[136:139], v[168:171], v[96:111]
    buffer_load_dwordx4 v[64:67], v0, s[4:7], s60 offen offset:2048 sc1
    v_mfma_f32_32x32x16_bf16 v[112:127], a[140:143], v[168:171], v[112:127]
    buffer_load_dwordx4 v[168:171], v0, s[4:7], s60 offen offset:3072 sc1
    s_waitcnt vmcnt(9)
    v_mfma_f32_32x32x16_bf16 v[96:111], a[144:147], v[172:175], v[96:111]
    buffer_load_dword v15, v9, s[4:7], 0 offen sc1
    v_mfma_f32_32x32x16_bf16 v[112:127], a[148:151], v[172:175], v[112:127]
    s_waitcnt vmcnt(9)
    v_mfma_f32_32x32x16_bf16 v[96:111], a[152:155], v[144:147], v[96:111]
    v_mfma_f32_32x32x16_bf16 v[112:127], a[156:159], v[144:147], v[112:127]
    s_waitcnt vmcnt(8)
    v_mfma_f32_32x32x16_bf16 v[96:111], a[160:163], v[148:151], v[96:111]
    v_mfma_f32_32x32x16_bf16 v[112:127], a[164:167], v[148:151], v[112:127]
    s_waitcnt vmcnt(7)
    v_mfma_f32_32x32x16_bf16 v[96:111], a[168:171], v[128:131], v[96:111]
    v_mfma_f32_32x32x16_bf16 v[112:127], a[172:175], v[128:131], v[112:127]
    s_waitcnt vmcnt(6)
    v_mfma_f32_32x32x16_bf16 v[96:111], a[176:179], v[132:135], v[96:111]
    s_waitcnt vmcnt(5)
    v_mfma_f32_32x32x16_bf16 v[96:111], a[184:187], v[136:139], v[96:111]
    s_waitcnt vmcnt(0)
    s_add_u32 s40, s3, 8
    v_subrev_u32 v15, s40, v15
    v_cmp_gt_u32 vcc, 16, v15
    s_nop 0
    s_andn2_b64 s[40:41], s[38:39], vcc
    s_cbranch_scc1 Ls_spin_37
Ls_back_38:
    s_add_u32 s60, s49, 229376
    buffer_load_dwordx4 v[128:131], v0, s[4:7], s60 offen offset:0 sc1
    buffer_load_dwordx4 v[144:147], v0, s[4:7], s60 offen offset:1024 sc1
    s_waitcnt vmcnt(6)
    v_mfma_f32_32x32x16_bf16 v[96:111], a[192:195], v[156:159], v[96:111]
    buffer_load_dwordx4 v[148:151], v0, s[4:7], s60 offen offset:2048 sc1
    s_waitcnt vmcnt(6)
    v_mfma_f32_32x32x16_bf16 v[96:111], a[200:203], v[140:143], v[96:111]
    s_waitcnt vmcnt(5)
    v_mfma_f32_32x32x16_bf16 v[96:111], a[208:211], v[64:67], v[96:111]
    buffer_load_dwordx4 v[172:175], v0, s[4:7], s60 offen offset:3072 sc1
    s_waitcnt vmcnt(5)
    v_mfma_f32_32x32x16_bf16 v[96:111], a[216:219], v[168:171], v[96:111]
    v_mfma_f32_32x32x16_bf16 v[112:127], a[180:183], v[132:135], v[112:127]
    s_add_u32 s60, s49, 233472
    buffer_load_dwordx4 v[132:135], v0, s[4:7], s60 offen offset:0 sc1
    v_mfma_f32_32x32x16_bf16 v[112:127], a[188:191], v[136:139], v[112:127]
    v_mfma_f32_32x32x16_bf16 v[112:127], a[196:199], v[156:159], v[112:127]
    buffer_load_dwordx4 v[136:139], v0, s[4:7], s60 offen offset:1024 sc1
    v_xor_b32 v58, 0, v6
    s_nop 4
    ds_write_b128 v58, v[96:99]
    v_mfma_f32_32x32x16_bf16 v[112:127], a[204:207], v[140:143], v[112:127]
    v_xor_b32 v59, 32, v6
    ds_write_b128 v59, v[100:103]
    v_mfma_f32_32x32x16_bf16 v[112:127], a[212:215], v[64:67], v[112:127]
    buffer_load_dwordx4 v[140:143], v0, s[4:7], s60 offen offset:2048 sc1
    v_xor_b32 v58, 64, v6
    ds_write_b128 v58, v[104:107]
    v_mfma_f32_32x32x16_bf16 v[112:127], a[220:223], v[168:171], v[112:127]
    v_xor_b32 v59, 96, v6
    ds_write_b128 v59, v[108:111]
    s_waitcnt vmcnt(6)
    v_mfma_f32_32x32x16_bf16 v[64:79], a[0:3], v[128:131], 0
    buffer_load_dwordx4 v[168:171], v0, s[4:7], s60 offen offset:3072 sc1
    v_mfma_f32_32x32x16_bf16 v[80:95], a[4:7], v[128:131], 0
    s_waitcnt vmcnt(6)
    v_mfma_f32_32x32x16_bf16 v[64:79], a[8:11], v[144:147], v[64:79]
    s_add_u32 s60, s49, 237568
    buffer_load_dwordx4 v[128:131], v0, s[4:7], s60 offen offset:0 sc1
    v_mfma_f32_32x32x16_bf16 v[80:95], a[12:15], v[144:147], v[80:95]
    v_xor_b32 v58, 128, v6
    s_nop 1
    ds_write_b128 v58, v[112:115]
    v_xor_b32 v59, 160, v6
    ds_write_b128 v59, v[116:119]
    s_waitcnt vmcnt(6)
    v_mfma_f32_32x32x16_bf16 v[64:79], a[16:19], v[148:151], v[64:79]
    buffer_load_dwordx4 v[144:147], v0, s[4:7], s60 offen offset:1024 sc1
    v_xor_b32 v58, 192, v6
    ds_write_b128 v58, v[120:123]
    v_mfma_f32_32x32x16_bf16 v[80:95], a[20:23], v[148:151], v[80:95]
    v_xor_b32 v59, 224, v6
    ds_write_b128 v59, v[124:127]
    s_waitcnt vmcnt(6)
    v_mfma_f32_32x32x16_bf16 v[64:79], a[24:27], v[172:175], v[64:79]
    buffer_load_dwordx4 v[148:151], v0, s[4:7], s60 offen offset:2048 sc1
    v_mfma_f32_32x32x16_bf16 v[80:95], a[28:31], v[172:175], v[80:95]
    s_waitcnt vmcnt(6)
    v_mfma_f32_32x32x16_bf16 v[64:79], a[32:35], v[132:135], v[64:79]
    buffer_load_dwordx4 v[172:175], v0, s[4:7], s60 offen offset:3072 sc1
    v_mfma_f32_32x32x16_bf16 v[80:95], a[36:39], v[132:135], v[80:95]
    s_waitcnt vmcnt(6)
    v_mfma_f32_32x32x16_bf16 v[64:79], a[40:43], v[136:139], v[64:79]
    s_add_u32 s60, s49, 241664
    buffer_load_dwordx4 v[132:135], v0, s[4:7], s60 offen offset:0 sc1
    v_mfma_f32_32x32x16_bf16 v[80:95], a[44:47], v[136:139], v[80:95]
    s_waitcnt lgkmcnt(0)
    s_barrier
    v_xor_b32 v58, 16, v7
    ds_read_b128 v[96:99], v7 offset:0
    ds_read_b128 v[100:103], v58 offset:0
    ds_read_b128 v[104:107], v7 offset:8192
    s_waitcnt vmcnt(6)
    v_mfma_f32_32x32x16_bf16 v[64:79], a[48:51], v[140:143], v[64:79]
    buffer_load_dwordx4 v[136:139], v0, s[4:7], s60 offen offset:1024 sc1
    ds_read_b128 v[108:111], v58 offset:8192
    ds_read_b128 v[112:115], v7 offset:16384
    ds_read_b128 v[116:119], v58 offset:16384
    ds_read_b128 v[120:123], v7 offset:24576
    ds_read_b128 v[124:127], v58 offset:24576
    v_mfma_f32_32x32x16_bf16 v[80:95], a[52:55], v[140:143], v[80:95]
    s_waitcnt vmcnt(6)
    v_mfma_f32_32x32x16_bf16 v[64:79], a[56:59], v[168:171], v[64:79]
    buffer_load_dwordx4 v[140:143], v0, s[4:7], s60 offen offset:2048 sc1
    v_lshlrev_b32 v160, 16, v16
    v_and_b32 v161, s46, v16
    v_lshlrev_b32 v162, 16, v17
    v_and_b32 v163, s46, v17
    v_lshlrev_b32 v164, 16, v18
    v_and_b32 v165, s46, v18
    v_lshlrev_b32 v166, 16, v19
    v_and_b32 v167, s46, v19
    s_waitcnt lgkmcnt(4)
    v_add_f32 v96, v96, v104
    v_mfma_f32_32x32x16_bf16 v[80:95], a[60:63], v[168:171], v[80:95]
    v_add_f32 v97, v97, v105
    v_add_f32 v98, v98, v106
    v_add_f32 v99, v99, v107
    v_add_f32 v100, v100, v108
    v_add_f32 v101, v101, v109
    v_add_f32 v102, v102, v110
    v_add_f32 v103, v103, v111
    s_waitcnt lgkmcnt(0)
    v_add_f32 v112, v112, v120
    v_add_f32 v113, v113, v121
    s_waitcnt vmcnt(6)
    v_mfma_f32_32x32x16_bf16 v[64:79], a[64:67], v[128:131], v[64:79]
    buffer_load_dwordx4 v[168:171], v0, s[4:7], s60 offen offset:3072 sc1
    v_add_f32 v114, v114, v122
    v_add_f32 v115, v115, v123
    v_add_f32 v116, v116, v124
    v_add_f32 v117, v117, v125
    v_add_f32 v118, v118, v126
    v_add_f32 v119, v119, v127
    v_add_f32 v96, v96, v112
    v_add_f32 v97, v97, v113
    v_add_f32 v98, v98, v114
    v_mfma_f32_32x32x16_bf16 v[80:95], a[68:71], v[128:131], v[80:95]
    v_add_f32 v99, v99, v115
    v_add_f32 v100, v100, v116
    v_add_f32 v101, v101, v117
    v_add_f32 v102, v102, v118
    v_add_f32 v103, v103, v119
    v_fmac_f32 v160, s61, v96
    v_fmac_f32 v161, s61, v97
    v_fmac_f32 v162, s61, v98
    v_fmac_f32 v163, s61, v99
    s_waitcnt vmcnt(6)
    v_mfma_f32_32x32x16_bf16 v[64:79], a[72:75], v[144:147], v[64:79]
    s_add_u32 s60, s49, 245760
    buffer_load_dwordx4 v[128:131], v0, s[4:7], s60 offen offset:0 sc1
    v_fmac_f32 v164, s61, v100
    v_fmac_f32 v165, s61, v101
    v_fmac_f32 v166, s61, v102
    v_fmac_f32 v167, s61, v103
    v_cvt_pk_bf16_f32 v16, v160, v161
    v_cvt_pk_bf16_f32 v17, v162, v163
    v_cvt_pk_bf16_f32 v18, v164, v165
    v_cvt_pk_bf16_f32 v19, v166, v167
    v_mfma_f32_32x32x16_bf16 v[80:95], a[76:79], v[144:147], v[80:95]
    s_waitcnt vmcnt(6)
    v_mfma_f32_32x32x16_bf16 v[64:79], a[80:83], v[148:151], v[64:79]
    buffer_load_dwordx4 v[144:147], v0, s[4:7], s60 offen offset:1024 sc1
    v_mfma_f32_32x32x16_bf16 v[80:95], a[84:87], v[148:151], v[80:95]
    s_waitcnt vmcnt(6)
    v_mfma_f32_32x32x16_bf16 v[64:79], a[88:91], v[172:175], v[64:79]
    buffer_load_dwordx4 v[148:151], v0, s[4:7], s60 offen offset:2048 sc1
    v_mfma_f32_32x32x16_bf16 v[80:95], a[92:95], v[172:175], v[80:95]
    s_waitcnt vmcnt(6)
    v_mfma_f32_32x32x16_bf16 v[64:79], a[96:99], v[132:135], v[64:79]
    buffer_load_dwordx4 v[172:175], v0, s[4:7], s60 offen offset:3072 sc1
    v_mfma_f32_32x32x16_bf16 v[80:95], a[100:103], v[132:135], v[80:95]
    s_waitcnt vmcnt(6)
    v_mfma_f32_32x32x16_bf16 v[64:79], a[104:107], v[136:139], v[64:79]
    s_add_u32 s60, s49, 249856
    buffer_load_dwordx4 v[132:135], v0, s[4:7], s60 offen offset:0 sc1
    v_mfma_f32_32x32x16_bf16 v[80:95], a[108:111], v[136:139], v[80:95]
    s_waitcnt vmcnt(6)
    v_mfma_f32_32x32x16_bf16 v[64:79], a[112:115], v[140:143], v[64:79]
    buffer_load_dwordx4 v[136:139], v0, s[4:7], s60 offen offset:1024 sc1
    s_barrier
    v_mfma_f32_32x32x16_bf16 v[80:95], a[116:119], v[140:143], v[80:95]
    s_waitcnt vmcnt(6)
    v_mfma_f32_32x32x16_bf16 v[64:79], a[120:123], v[168:171], v[64:79]
    buffer_load_dwordx4 v[140:143], v0, s[4:7], s60 offen offset:2048 sc1
    v_mfma_f32_32x32x16_bf16 v[80:95], a[124:127], v[168:171], v[80:95]
    buffer_load_dwordx4 v[168:171], v0, s[4:7], s60 offen offset:3072 sc1
    s_waitcnt vmcnt(7)
    v_mfma_f32_32x32x16_bf16 v[64:79], a[128:131], v[128:131], v[64:79]
    s_add_u32 s60, s49, 253952
    buffer_load_dwordx4 v[156:159], v0, s[4:7], s60 offen offset:0 sc1
    v_mfma_f32_32x32x16_bf16 v[80:95], a[132:135], v[128:131], v[80:95]
    buffer_load_dwordx4 v[128:131], v0, s[4:7], s60 offen offset:1024 sc1
    s_waitcnt vmcnt(8)
    v_mfma_f32_32x32x16_bf16 v[64:79], a[136:139], v[144:147], v[64:79]
    buffer_load_dwordx4 v[48:51], v0, s[4:7], s60 offen offset:2048 sc1
    v_mfma_f32_32x32x16_bf16 v[80:95], a[140:143], v[144:147], v[80:95]
    buffer_load_dwordx4 v[144:147], v0, s[4:7], s60 offen offset:3072 sc1
    s_waitcnt vmcnt(9)
    v_mfma_f32_32x32x16_bf16 v[64:79], a[144:147], v[148:151], v[64:79]
    v_mfma_f32_32x32x16_bf16 v[80:95], a[148:151], v[148:151], v[80:95]
    s_waitcnt vmcnt(8)
    v_mfma_f32_32x32x16_bf16 v[64:79], a[152:155], v[172:175], v[64:79]
    v_mfma_f32_32x32x16_bf16 v[80:95], a[156:159], v[172:175], v[80:95]
    s_waitcnt vmcnt(7)
    v_mfma_f32_32x32x16_bf16 v[64:79], a[160:163], v[132:135], v[64:79]
    v_mfma_f32_32x32x16_bf16 v[80:95], a[164:167], v[132:135], v[80:95]
    s_waitcnt vmcnt(6)
    v_mfma_f32_32x32x16_bf16 v[64:79], a[168:171], v[136:139], v[64:79]
    v_mfma_f32_32x32x16_bf16 v[80:95], a[172:175], v[136:139], v[80:95]
    s_waitcnt vmcnt(5)
    v_mfma_f32_32x32x16_bf16 v[64:79], a[176:179], v[140:143], v[64:79]
    s_waitcnt vmcnt(4)
    v_mfma_f32_32x32x16_bf16 v[64:79], a[184:187], v[168:171], v[64:79]
    s_waitcnt vmcnt(3)
    v_mfma_f32_32x32x16_bf16 v[64:79], a[192:195], v[156:159], v[64:79]
    s_mov_b32 s29, 0
    buffer_store_dwordx4 v[16:19], v8, s[12:15], s29 offen
    s_waitcnt vmcnt(3)
    v_mfma_f32_32x32x16_bf16 v[64:79], a[200:203], v[128:131], v[64:79]
    s_waitcnt vmcnt(2)
    v_mfma_f32_32x32x16_bf16 v[64:79], a[208:211], v[48:51], v[64:79]
    s_waitcnt vmcnt(1)
    v_mfma_f32_32x32x16_bf16 v[64:79], a[216:219], v[144:147], v[64:79]
    v_mfma_f32_32x32x16_bf16 v[80:95], a[180:183], v[140:143], v[80:95]
    v_mfma_f32_32x32x16_bf16 v[80:95], a[188:191], v[168:171], v[80:95]
    v_mfma_f32_32x32x16_bf16 v[80:95], a[196:199], v[156:159], v[80:95]
    v_xor_b32 v58, 0, v6
    s_nop 7
    ds_write_b128 v58, v[64:67]
    v_mfma_f32_32x32x16_bf16 v[80:95], a[204:207], v[128:131], v[80:95]
    v_xor_b32 v59, 32, v6
    ds_write_b128 v59, v[68:71]
    v_mfma_f32_32x32x16_bf16 v[80:95], a[212:215], v[48:51], v[80:95]
    v_xor_b32 v58, 64, v6
    ds_write_b128 v58, v[72:75]
    v_mfma_f32_32x32x16_bf16 v[80:95], a[220:223], v[144:147], v[80:95]
    v_xor_b32 v59, 96, v6
    ds_write_b128 v59, v[76:79]
    v_xor_b32 v58, 128, v6
    s_nop 8
    ds_write_b128 v58, v[80:83]
    v_xor_b32 v59, 160, v6
    ds_write_b128 v59, v[84:87]
    v_xor_b32 v58, 192, v6
    ds_write_b128 v58, v[88:91]
    v_xor_b32 v59, 224, v6
    ds_write_b128 v59, v[92:95]
    s_waitcnt lgkmcnt(0)
    s_barrier
    v_xor_b32 v58, 16, v7
    ds_read_b128 v[64:67], v7 offset:0
    ds_read_b128 v[68:71], v58 offset:0
    ds_read_b128 v[72:75], v7 offset:8192
    ds_read_b128 v[76:79], v58 offset:8192
    ds_read_b128 v[80:83], v7 offset:16384
    ds_read_b128 v[84:87], v58 offset:16384
    ds_read_b128 v[88:91], v7 offset:24576
    ds_read_b128 v[92:95], v58 offset:24576
    v_lshlrev_b32 v160, 16, v20
    v_and_b32 v161, s46, v20
    v_lshlrev_b32 v162, 16, v21
    v_and_b32 v163, s46, v21
    v_lshlrev_b32 v164, 16, v22
    v_and_b32 v165, s46, v22
    v_lshlrev_b32 v166, 16, v23
    v_and_b32 v167, s46, v23
    s_waitcnt lgkmcnt(4)
    v_add_f32 v64, v64, v72
    v_add_f32 v65, v65, v73
    v_add_f32 v66, v66, v74
    v_add_f32 v67, v67, v75
    v_add_f32 v68, v68, v76
    v_add_f32 v69, v69, v77
    v_add_f32 v70, v70, v78
    v_add_f32 v71, v71, v79
    s_waitcnt lgkmcnt(0)
    v_add_f32 v80, v80, v88
    v_add_f32 v81, v81, v89
    v_add_f32 v82, v82, v90
    v_add_f32 v83, v83, v91
    v_add_f32 v84, v84, v92
    v_add_f32 v85, v85, v93
    v_add_f32 v86, v86, v94
    v_add_f32 v87, v87, v95
    v_add_f32 v64, v64, v80
    v_add_f32 v65, v65, v81
    v_add_f32 v66, v66, v82
    v_add_f32 v67, v67, v83
    v_add_f32 v68, v68, v84
    v_add_f32 v69, v69, v85
    v_add_f32 v70, v70, v86
    v_add_f32 v71, v71, v87
    v_fmac_f32 v160, s61, v64
    v_fmac_f32 v161, s61, v65
    v_fmac_f32 v162, s61, v66
    v_fmac_f32 v163, s61, v67
    v_fmac_f32 v164, s61, v68
    v_fmac_f32 v165, s61, v69
    v_fmac_f32 v166, s61, v70
    v_fmac_f32 v167, s61, v71
    v_cvt_pk_bf16_f32 v20, v160, v161
    v_cvt_pk_bf16_f32 v21, v162, v163
    v_cvt_pk_bf16_f32 v22, v164, v165
    v_cvt_pk_bf16_f32 v23, v166, v167
    s_mov_b32 s29, 57344
    buffer_store_dwordx4 v[20:23], v8, s[12:15], s29 offen
L_end_fars:
    s_endpgm
Ls_yspin_1:
    s_mov_b32 s55, 0
Ls_yloop_3:
    v_lshlrev_b32 v159, 3, v0
    v_and_b32 v159, 0xf80, v159
    buffer_load_dword v14, v159, s[4:7], s97 offen sc1
    s_waitcnt vmcnt(0)
    s_add_u32 s40, s3, 1
    v_cmp_ne_u32 vcc, s40, v14
    s_add_u32 s55, s55, 1
    s_and_b64 s[40:41], vcc, exec
    s_cbranch_scc0 Ls_yback_2
    s_cmp_lt_u32 s55, 262144
    s_cbranch_scc1 Ls_yloop_3
    s_branch Ls_yback_2
Ls_sspin_4:
    s_mov_b32 s55, 0
Ls_sloop_6:
    buffer_load_dwordx3 v[96:98], v2, s[4:7], s33 offen sc1
    s_waitcnt vmcnt(0)
    s_add_u32 s40, s3, 1
    v_cmp_eq_u32 vcc, s40, v98
    s_add_u32 s55, s55, 1
    s_andn2_b64 s[40:41], exec, vcc
    s_cbranch_scc0 Ls_sback_5
    s_cmp_lt_u32 s55, 262144
    s_cbranch_scc1 Ls_sloop_6
    s_branch Ls_sback_5
Ls_sspin_7:
    s_mov_b32 s55, 0
Ls_sloop_9:
    buffer_load_dwordx3 v[120:122], v2, s[4:7], s99 offen sc1
    s_waitcnt vmcnt(0)
    s_add_u32 s40, s3, 1
    v_cmp_eq_u32 vcc, s40, v122
    s_add_u32 s55, s55, 1
    s_andn2_b64 s[40:41], exec, vcc
    s_cbranch_scc0 Ls_sback_8
    s_cmp_lt_u32 s55, 262144
    s_cbranch_scc1 Ls_sloop_9
    s_branch Ls_sback_8
Ls_spin_10:
    s_mov_b32 s55, 0
Ls_loop_12:
    buffer_load_dword v13, v9, s[4:7], 0 offen sc1
    s_waitcnt vmcnt(0)
    s_add_u32 s40, s3, 1
    v_subrev_u32 v13, s40, v13
    v_cmp_gt_u32 vcc, 16, v13
    s_add_u32 s55, s55, 1
    s_andn2_b64 s[40:41], s[36:37], vcc
    s_cbranch_scc0 Ls_back_11
    s_cmp_lt_u32 s55, 262144
    s_cbranch_scc1 Ls_loop_12
    s_branch Ls_back_11
Ls_spin_13:
    s_mov_b32 s55, 0
Ls_loop_15:
    buffer_load_dword v13, v9, s[4:7], 0 offen sc1
    s_waitcnt vmcnt(0)
    s_add_u32 s40, s3, 2
    v_subrev_u32 v13, s40, v13
    v_cmp_gt_u32 vcc, 16, v13
    s_add_u32 s55, s55, 1
    s_andn2_b64 s[40:41], s[36:37], vcc
    s_cbranch_scc0 Ls_back_14
    s_cmp_lt_u32 s55, 262144
    s_cbranch_scc1 Ls_loop_15
    s_branch Ls_back_14
Ls_spin_16:
    s_mov_b32 s55, 0
Ls_loop_18:
    buffer_load_dword v14, v9, s[4:7], 0 offen sc1
    s_waitcnt vmcnt(0)
    s_add_u32 s40, s3, 3
    v_subrev_u32 v14, s40, v14
    v_cmp_gt_u32 vcc, 16, v14
    s_add_u32 s55, s55, 1
    s_andn2_b64 s[40:41], s[38:39], vcc
    s_cbranch_scc0 Ls_back_17
    s_cmp_lt_u32 s55, 262144
    s_cbranch_scc1 Ls_loop_18
    s_branch Ls_back_17
Ls_spin_19:
    s_mov_b32 s55, 0
Ls_loop_21:
    buffer_load_dword v15, v9, s[4:7], 0 offen sc1
    s_waitcnt vmcnt(0)
    s_add_u32 s40, s3, 4
    v_subrev_u32 v15, s40, v15
    v_cmp_gt_u32 vcc, 16, v15
    s_add_u32 s55, s55, 1
    s_andn2_b64 s[40:41], s[38:39], vcc
    s_cbranch_scc0 Ls_back_20
    s_cmp_lt_u32 s55, 262144
    s_cbranch_scc1 Ls_loop_21
    s_branch Ls_back_20
Ls_sspin_22:
    s_mov_b32 s55, 0
Ls_sloop_24:
    buffer_load_dwordx3 v[96:98], v2, s[4:7], s33 offen sc1
    s_waitcnt vmcnt(0)
    s_add_u32 s40, s3, 2
    v_cmp_eq_u32 vcc, s40, v98
    s_add_u32 s55, s55, 1
    s_andn2_b64 s[40:41], exec, vcc
    s_cbranch_scc0 Ls_sback_23
    s_cmp_lt_u32 s55, 262144
    s_cbranch_scc1 Ls_sloop_24
    s_branch Ls_sback_23
Ls_spin_25:
    s_mov_b32 s55, 0
Ls_loop_27:
    buffer_load_dword v13, v9, s[4:7], 0 offen sc1
    s_waitcnt vmcnt(0)
    s_add_u32 s40, s3, 5
    v_subrev_u32 v13, s40, v13
    v_cmp_gt_u32 vcc, 16, v13
    s_add_u32 s55, s55, 1
    s_andn2_b64 s[40:41], s[36:37], vcc
    s_cbranch_scc0 Ls_back_26
    s_cmp_lt_u32 s55, 262144
    s_cbranch_scc1 Ls_loop_27
    s_branch Ls_back_26
Ls_sspin_28:
    s_mov_b32 s55, 0
Ls_sloop_30:
    buffer_load_dwordx3 v[64:66], v2, s[4:7], s33 offen sc1
    s_waitcnt vmcnt(0)
    s_add_u32 s40, s3, 2
    v_cmp_eq_u32 vcc, s40, v66
    s_add_u32 s55, s55, 1
    s_andn2_b64 s[40:41], exec, vcc
    s_cbranch_scc0 Ls_sback_29
    s_cmp_lt_u32 s55, 262144
    s_cbranch_scc1 Ls_sloop_30
    s_branch Ls_sback_29
Ls_spin_31:
    s_mov_b32 s55, 0
Ls_loop_33:
    buffer_load_dword v13, v9, s[4:7], 0 offen sc1
    s_waitcnt vmcnt(0)
    s_add_u32 s40, s3, 6
    v_subrev_u32 v13, s40, v13
    v_cmp_gt_u32 vcc, 16, v13
    s_add_u32 s55, s55, 1
    s_andn2_b64 s[40:41], s[36:37], vcc
    s_cbranch_scc0 Ls_back_32
    s_cmp_lt_u32 s55, 262144
    s_cbranch_scc1 Ls_loop_33
    s_branch Ls_back_32
Ls_spin_34:
    s_mov_b32 s55, 0
Ls_loop_36:
    buffer_load_dword v14, v9, s[4:7], 0 offen sc1
    s_waitcnt vmcnt(0)
    s_add_u32 s40, s3, 7
    v_subrev_u32 v14, s40, v14
    v_cmp_gt_u32 vcc, 16, v14
    s_add_u32 s55, s55, 1
    s_andn2_b64 s[40:41], s[38:39], vcc
    s_cbranch_scc0 Ls_back_35
    s_cmp_lt_u32 s55, 262144
    s_cbranch_scc1 Ls_loop_36
    s_branch Ls_back_35
Ls_spin_37:
    s_mov_b32 s55, 0
Ls_loop_39:
    buffer_load_dword v15, v9, s[4:7], 0 offen sc1
    s_waitcnt vmcnt(0)
    s_add_u32 s40, s3, 8
    v_subrev_u32 v15, s40, v15
    v_cmp_gt_u32 vcc, 16, v15
    s_add_u32 s55, s55, 1
    s_andn2_b64 s[40:41], s[38:39], vcc
    s_cbranch_scc0 Ls_back_38
    s_cmp_lt_u32 s55, 262144
    s_cbranch_scc1 Ls_loop_39
    s_branch Ls_back_38
L_end:
    s_endpgm
.section .rodata,"a"
.p2align 6
.amdhsa_kernel interleave_layers__ssm_conv_h3__dense_activation_silu__prompt_kernel
  .amdhsa_next_free_vgpr 512
  .amdhsa_next_free_sgpr 102
  .amdhsa_accum_offset 256
  .amdhsa_group_segment_fixed_size 0
  .amdhsa_kernarg_size 96
  .amdhsa_user_sgpr_count 2
  .amdhsa_user_sgpr_kernarg_segment_ptr 1
  .amdhsa_system_sgpr_workgroup_id_x 1
  .amdhsa_float_denorm_mode_32 3
.end_amdhsa_kernel
.text
```
